```python
import torch

def _softmax(x, axis=-1):
    return torch.softmax(x, dim=axis)

def _gelu(x):
    return torch.nn.functional.gelu(x, approximate='tanh')

def _silu(x):
    return torch.nn.functional.silu(x)

def _sigmoid(x):
    return torch.sigmoid(x)

def _layernorm(x, axis=-1, eps=1e-05):
    m = x.mean(dim=axis, keepdim=True)
    v = x.var(dim=axis, keepdim=True, unbiased=False)
    return (x - m) / torch.sqrt(v + eps)

def _scatter_add(tgt, idx, src, axis=0):
    return tgt.clone().index_add_(axis, idx, src)

def _segment_sum(src, seg, n):
    out = torch.zeros((n,) + src.shape[1:], dtype=src.dtype)
    return out.index_add_(0, seg, src)

def _pad(x, pw):
    flat = tuple((v for pair in reversed(pw) for v in pair))
    return torch.nn.functional.pad(x, flat)
kernel_name = 'parallel_sum__memory_aug_recurrent_mem_tr__mixer_gmlp__prompt'

def setup_inputs():

    _w = lambda a: (lambda t: t.to(torch.bfloat16) if t.is_floating_point() else t)(torch.as_tensor(a))

    def _A_setup():
        B, S, Dm = (1, 2048, 512)
        H, Dh = (32, 128)
        M, seg = (8, 32)
        seg = min(seg, S)
        S = S // seg * seg
        return {'x': _w((lambda *s: torch.randn(*s, dtype=torch.bfloat16) * 0.05)(B, S, Dm)), 'mem0': _w((lambda *s: torch.randn(*s, dtype=torch.bfloat16) * 1.6)(B, M, Dm)), 'Wq': _w((lambda *s: torch.randn(*s, dtype=torch.bfloat16) * 0.8)(Dm, H, Dh) * Dm ** (-0.5)), 'Wk': _w((lambda *s: torch.randn(*s, dtype=torch.bfloat16) * 0.8)(Dm, H, Dh) * Dm ** (-0.5)), 'Wv': _w((lambda *s: torch.randn(*s, dtype=torch.bfloat16) * 1.6)(Dm, H, Dh) * Dm ** (-0.5)), 'Wo': _w((lambda *s: torch.randn(*s, dtype=torch.bfloat16) * 1.6)(H, Dh, Dm) * (H * Dh) ** (-0.5)), 'seg_len': seg}
    _A_in = _A_setup()

    def _B_setup():
        B, S, D, F = (1, 2048, 512, 1792)
        Fh = F // 2
        return {'x': _w((lambda *s: torch.randn(*s, dtype=torch.bfloat16) * 0.05)(B, S, D)), 'w_in': _w((lambda *s: torch.randn(*s, dtype=torch.bfloat16) * 0.2)(D, 2 * Fh)), 'w_sp': _w(0.01 * (lambda *s: torch.randn(*s, dtype=torch.bfloat16) * 0.2)(S, S)), 'b_sp': _w(1.0 + 0.01 * (lambda *s: torch.randn(*s, dtype=torch.bfloat16) * 0.05)(S)), 'w_out': _w((lambda *s: torch.randn(*s, dtype=torch.bfloat16) * 0.05)(Fh, D))}
    _B_in = _B_setup()
    return {'A_x': _A_in['x'], 'A_mem0': _A_in['mem0'], 'A_Wq': _A_in['Wq'], 'A_Wk': _A_in['Wk'], 'A_Wv': _A_in['Wv'], 'A_Wo': _A_in['Wo'], 'A_seg_len': _A_in['seg_len'], 'B_x': _B_in['x'], 'B_w_in': _B_in['w_in'], 'B_w_sp': _B_in['w_sp'], 'B_b_sp': _B_in['b_sp'], 'B_w_out': _B_in['w_out']}

def reference(A_x, A_mem0, A_Wq, A_Wk, A_Wv, A_Wo, A_seg_len, B_x, B_w_in, B_w_sp, B_b_sp, B_w_out):

    def _A_ref(x, mem0, Wq, Wk, Wv, Wo, seg_len):
        B, S, Dm = x.shape
        H, Dh = (Wq.shape[1], Wq.shape[2])
        M = mem0.shape[1]
        scale = Dh ** (-0.5)
        n_seg = S // seg_len
        L = M + seg_len
        idx = torch.arange(L)
        mask = (idx[:, None] < M) | (idx[:, None] >= idx[None, :])
        mem = mem0
        outs = []
        for s in range(n_seg):
            xs = x[:, s * seg_len:(s + 1) * seg_len, :].clone()
            h = torch.concatenate([mem, xs], axis=1)
            q = torch.einsum('btd,dhe->bhte', h, Wq)
            k = torch.einsum('btd,dhe->bhte', h, Wk)
            v = torch.einsum('btd,dhe->bhte', h, Wv)
            scores = torch.einsum('bhqe,bhke->bhqk', q, k) * scale
            scores = torch.where(mask[None, None], scores, -1000000000.0)
            p = _softmax(scores, axis=-1)
            o = torch.einsum('bhqk,bhke->bhqe', p, v)
            o = torch.einsum('bhte,hed->btd', o, Wo)
            mem = o[:, :M, :].clone()
            outs.append(o[:, M:, :])
        return torch.concatenate(outs, axis=1)

    def _B_ref(x, w_in, w_sp, b_sp, w_out):
        B, S, D = x.shape
        F = w_in.shape[-1]
        Fh = F // 2
        z = _gelu(torch.einsum('bsd,df->bsf', x, w_in))
        z1 = z[..., :Fh].clone()
        z2 = _layernorm(z[..., Fh:], axis=-1)
        g = torch.einsum('ts,bsf->btf', w_sp, z2) + b_sp[None, :, None]
        return torch.einsum('bsf,fd->bsd', z1 * g, w_out)
    x = A_x
    xn = _layernorm(x, axis=-1)
    return x + _A_ref(xn, A_mem0, A_Wq, A_Wk, A_Wv, A_Wo, A_seg_len) + _B_ref(xn, B_w_in, B_w_sp, B_b_sp, B_w_out)
```

```asm
; @launch grid=(256,1,1) block=(256,1,1) lds=163840
.amdgcn_target "amdgcn-amd-amdhsa--gfx950"
.text
.globl parallel_sum__memory_aug_recurrent_mem_tr__mixer_gmlp__prompt_kernel
.p2align 8
.type parallel_sum__memory_aug_recurrent_mem_tr__mixer_gmlp__prompt_kernel,@function
parallel_sum__memory_aug_recurrent_mem_tr__mixer_gmlp__prompt_kernel:
  s_cmp_ge_u32 s2, 256
  s_cbranch_scc1 L_end
  s_load_dwordx4 s[32:35], s[0:1], 104
  s_getreg_b32 s28, hwreg(HW_REG_XCC_ID)
  s_and_b32 s28, s28, 15
  v_lshrrev_b32 v1, 6, v0
  v_mov_b32 v17, 0
  v_readfirstlane_b32 s29, v1
  s_waitcnt lgkmcnt(0)
  s_mov_b32 s8, s32
  s_mov_b32 s9, s33
  s_mov_b32 s10, 256
  s_mov_b32 s11, 0x20000
  s_mov_b32 s4, s34
  s_mov_b32 s5, s35
  s_mov_b32 s6, 268435456
  s_mov_b32 s7, 0x20000
  s_cmp_lg_u32 s28, 3
  s_cbranch_scc1 L_worker
L_tryrole:
  s_load_dwordx2 s[36:37], s[0:1], 40
  s_cmp_lg_u32 s29, 0
  s_cbranch_scc1 L_ar_1
  v_mov_b32 v17, 1
  v_mov_b32 v21, 0
  s_mov_b64 exec, 1
  buffer_atomic_add v17, v21, s[8:11], 0 offen sc0
  s_mov_b64 exec, -1
L_ar_1:
  s_waitcnt vmcnt(0) lgkmcnt(0)
  s_cmp_lg_u32 s29, 0
  v_mov_b32 v21, 0
  s_cbranch_scc1 L_bt_2
  s_mov_b64 exec, 1
  ds_write_b32 v21, v17
  s_mov_b64 exec, -1
  s_waitcnt lgkmcnt(0)
L_bt_2:
  s_barrier
  ds_read_b32 v22, v21
  s_waitcnt lgkmcnt(0)
  v_readfirstlane_b32 s30, v22
  s_barrier
  s_cmp_lt_u32 s30, 32
  s_cbranch_scc1 L_chain
  s_waitcnt vmcnt(0)
  s_branch L_worker_noq
L_worker:
  s_mov_b32 s70, 1
  s_branch L_winit
L_worker_noq:
  s_mov_b32 s70, 0
L_winit:
  s_mov_b32 s12, s4
  s_mov_b32 s13, s5
  s_mov_b32 s14, 268435456
  s_mov_b32 s15, 0x20000
  s_mov_b32 s16, s4
  s_mov_b32 s17, s5
  s_mov_b32 s18, 268435456
  s_mov_b32 s19, 0x20000
  s_mov_b32 s20, s4
  s_mov_b32 s21, s5
  s_mov_b32 s22, 268435456
  s_mov_b32 s23, 0x20000
  s_mov_b32 s24, s4
  s_mov_b32 s25, s5
  s_mov_b32 s26, 268435456
  s_mov_b32 s27, 0x20000
  v_and_b32 v1, 63, v0
  v_mov_b32 v20, 0
  s_lshr_b32 s59, s29, 1
  s_and_b32 s60, s29, 1
  v_and_b32 v21, 31, v1
  v_lshrrev_b32 v22, 5, v1
  v_bfe_u32 v23, v1, 1, 3
  v_xor_b32 v22, v22, v23
  v_lshlrev_b32 v24, 7, v21
  v_lshl_add_u32 v24, v22, 4, v24
  s_lshl_b32 s31, s59, 13
  v_add_u32 v5, s31, v24
  v_xor_b32 v6, 32, v5
  v_xor_b32 v7, 64, v5
  v_xor_b32 v8, 96, v5
  v_bfe_u32 v21, v1, 4, 1
  v_lshrrev_b32 v22, 5, v1
  v_bfe_u32 v23, v1, 2, 2
  v_and_b32 v24, 1, v1
  v_bfe_u32 v25, v1, 1, 1
  v_lshl_add_u32 v25, v24, 1, v25
  v_lshl_add_u32 v25, v21, 2, v25
  v_lshl_add_u32 v26, v22, 3, v23
  v_lshlrev_b32 v26, 8, v26
  v_lshl_add_u32 v26, v25, 3, v26
  s_lshl_b32 s31, s60, 1
  v_xor_b32 v27, s31, v23
  v_lshl_add_u32 v9, v27, 6, v26
  v_add_u32 v9, 16384, v9
  v_xor_b32 v10, 64, v9
  s_mov_b32 s75, 0
  s_getpc_b64 s[100:101]
L_pc:
  s_add_u32 s100, s100, task_table-L_pc
  s_addc_u32 s101, s101, 0
  s_cmp_gt_u32 s28, 3
  s_cselect_b32 s31, 1, 0
  s_sub_u32 s98, s28, s31
  s_min_u32 s98, s98, 6
  s_mov_b32 s96, 1
  s_mov_b32 s91, 0
  s_mov_b32 s53, 0
  s_mov_b32 s57, -1
  s_mov_b32 s97, s98
L_claim:
  s_lshl_b32 s31, s96, 4
  s_load_dwordx4 s[36:39], s[100:101], s31
  s_cmp_ge_u32 s96, 2
  s_cbranch_scc1 L_claimw
  s_lshl_b32 s32, s97, 2
  s_waitcnt lgkmcnt(0)
  s_add_u32 s58, s32, s39
  s_cmp_lg_u32 s29, 0
  s_cbranch_scc1 L_ar_3
  v_mov_b32 v17, 1
  v_mov_b32 v21, 0
  s_mov_b64 exec, 1
  buffer_atomic_add v17, v21, s[8:11], s58 offen sc0
  s_mov_b64 exec, -1
L_ar_3:
  s_branch L_claimx
L_claimw:
  s_lshl_b32 s32, s97, 7
  s_waitcnt lgkmcnt(0)
  s_add_u32 s58, s32, s39
  s_cmp_lg_u32 s29, 0
  s_cbranch_scc1 L_ar_4
  v_mov_b32 v17, 1
  v_mov_b32 v21, 0
  s_mov_b64 exec, 1
  buffer_atomic_add v17, v21, s[4:7], s58 offen sc0
  s_mov_b64 exec, -1
L_ar_4:
L_claimx:
  s_waitcnt vmcnt(0)
  s_cmp_lg_u32 s29, 0
  v_mov_b32 v21, 0
  s_cbranch_scc1 L_bt_5
  s_mov_b64 exec, 1
  ds_write_b32 v21, v17
  s_mov_b64 exec, -1
  s_waitcnt lgkmcnt(0)
L_bt_5:
  s_barrier
  ds_read_b32 v22, v21
  s_waitcnt lgkmcnt(0)
  v_readfirstlane_b32 s40, v22
  s_barrier
  s_cmp_lt_u32 s40, s37
  s_cbranch_scc1 L_got
  s_cmp_eq_u32 s96, 0
  s_cbranch_scc1 L_lndone
  s_cmp_eq_u32 s53, 0
  s_cbranch_scc1 L_toln
  s_cmp_eq_u32 s75, 1
  s_cbranch_scc1 L_iw_6
  s_mov_b32 s58, 128
  s_cmp_lg_u32 s29, 0
  s_cbranch_scc1 L_wfx_8
  s_mov_b32 s32, 0
  s_mov_b64 exec, 1
L_wf_7:
  buffer_load_dword v21, v20, s[8:11], s58 offen sc1
  s_add_u32 s32, s32, 1
  s_waitcnt vmcnt(0)
  v_readfirstlane_b32 s31, v21
  s_cmp_gt_u32 s32, 0x40000
  s_cbranch_scc1 L_wfx_8
  s_cmp_ge_u32 s31, 1
  s_cbranch_scc1 L_wfx_8
  s_sleep 2
  s_branch L_wf_7
L_wfx_8:
  s_mov_b64 exec, -1
  s_barrier
  s_mov_b32 s75, 1
L_iw_6:
  s_cmp_eq_u32 s36, 1
  s_cbranch_scc1 L_nextph
  s_lshl_b32 s31, s96, 7
  s_add_u32 s31, s31, 40960
  v_lshlrev_b32 v21, 2, v1
  v_and_b32 v21, 31, v21
  buffer_load_dword v22, v21, s[4:7], s31 offen sc1
  s_waitcnt vmcnt(0)
  v_cmp_eq_u32 vcc, 0, v22
  s_lshl_b32 s31, 1, s36
  s_sub_u32 s31, s31, 1
  s_lshl_b32 s32, 1, s97
  s_or_b32 s91, s91, s32
  s_andn2_b32 s31, s31, s91
  s_and_b32 s31, s31, vcc_lo
  v_mov_b32 v24, s31
  s_cmp_lg_u32 s29, 0
  v_mov_b32 v21, 0
  s_cbranch_scc1 L_bt_9
  s_mov_b64 exec, 1
  ds_write_b32 v21, v24
  s_mov_b64 exec, -1
  s_waitcnt lgkmcnt(0)
L_bt_9:
  s_barrier
  ds_read_b32 v22, v21
  s_waitcnt lgkmcnt(0)
  v_readfirstlane_b32 s32, v22
  s_barrier
  s_cmp_eq_u32 s32, 0
  s_cbranch_scc1 L_nextph
  s_lshr_b32 s31, s32, s97
  s_lshl_b32 s31, s31, s97
  s_cmp_lg_u32 s31, 0
  s_cselect_b32 s31, s31, s32
  s_ff1_i32_b32 s97, s31
  s_branch L_claim
L_nextph:
  s_mov_b32 s91, 0
  s_add_u32 s96, s96, 1
  s_cmp_ge_u32 s96, 5
  s_cbranch_scc1 L_wdone
  s_bitcmp1_b32 s96, 0
  s_cselect_b32 s97, s98, 0
  s_cmp_lg_u32 s96, 2
  s_cbranch_scc1 L_claim
  s_cmp_eq_u32 s70, 1
  s_cbranch_scc1 L_chk
  s_branch L_claim
L_got:
  s_add_u32 s31, s40, 1
  s_cmp_lg_u32 s31, s37
  s_cbranch_scc1 L_got2
  s_cmp_eq_u32 s36, 1
  s_cbranch_scc1 L_got2
  s_cmp_eq_u32 s75, 1
  s_cbranch_scc1 L_iw_10
  s_mov_b32 s58, 128
  s_cmp_lg_u32 s29, 0
  s_cbranch_scc1 L_wfx_12
  s_mov_b32 s32, 0
  s_mov_b64 exec, 1
L_wf_11:
  buffer_load_dword v21, v20, s[8:11], s58 offen sc1
  s_add_u32 s32, s32, 1
  s_waitcnt vmcnt(0)
  v_readfirstlane_b32 s31, v21
  s_cmp_gt_u32 s32, 0x40000
  s_cbranch_scc1 L_wfx_12
  s_cmp_ge_u32 s31, 1
  s_cbranch_scc1 L_wfx_12
  s_sleep 2
  s_branch L_wf_11
L_wfx_12:
  s_mov_b64 exec, -1
  s_barrier
  s_mov_b32 s75, 1
L_iw_10:
  s_lshl_b32 s31, s96, 7
  s_lshl_b32 s32, s97, 2
  s_add_u32 s31, s31, s32
  s_add_u32 s31, s31, 40960
  v_mov_b32 v21, 1
  s_mov_b64 exec, 1
  buffer_store_dword v21, v20, s[4:7], s31 offen sc1
  s_mov_b64 exec, -1
L_got2:
  s_mul_i32 s31, s97, s37
  s_add_u32 s31, s31, s38
  s_add_u32 s40, s40, s31
L_got3:
  s_lshl_b32 s31, s40, 2
  s_load_dword s41, s[100:101], s31
L_nopf:
  s_waitcnt lgkmcnt(0)
  s_and_b32 s49, s41, 15
  s_bfe_u32 s42, s41, 0x80004
  s_bfe_u32 s43, s41, 0x8000c
  s_bfe_u32 s82, s41, 0x40014
  s_mov_b32 s94, 0
  s_mov_b32 s95, 256
  s_cmp_eq_u32 s53, 1
  s_cbranch_scc1 L_disp
  s_cmp_lg_u32 s96, 1
  s_cbranch_scc1 L_disp
  s_and_b32 s31, s41, 0xfff
  s_cmp_eq_u32 s31, 11
  s_cbranch_scc1 L_disp
  s_mov_b32 s57, s40
L_toln:
  s_mov_b32 s48, s97
  s_mov_b32 s96, 0
  s_mov_b32 s97, 0
  s_branch L_claim
L_lndone:
  s_mov_b32 s53, 1
  s_mov_b32 s96, 1
  s_mov_b32 s97, s48
  s_cmp_eq_u32 s57, -1
  s_cbranch_scc1 L_claim
  s_mov_b32 s40, s57
  s_branch L_got3
L_disp:
  s_cmp_eq_u32 s49, 10
  s_cbranch_scc1 L_done
  s_cmp_eq_u32 s49, 7
  s_cbranch_scc1 L_ln1
  s_cmp_eq_u32 s49, 11
  s_cbranch_scc1 L_g1
  s_cmp_eq_u32 s75, 1
  s_cbranch_scc1 L_iw_13
  s_mov_b32 s58, 128
  s_cmp_lg_u32 s29, 0
  s_cbranch_scc1 L_wfx_15
  s_mov_b32 s32, 0
  s_mov_b64 exec, 1
L_wf_14:
  buffer_load_dword v21, v20, s[8:11], s58 offen sc1
  s_add_u32 s32, s32, 1
  s_waitcnt vmcnt(0)
  v_readfirstlane_b32 s31, v21
  s_cmp_gt_u32 s32, 0x40000
  s_cbranch_scc1 L_wfx_15
  s_cmp_ge_u32 s31, 1
  s_cbranch_scc1 L_wfx_15
  s_sleep 2
  s_branch L_wf_14
L_wfx_15:
  s_mov_b64 exec, -1
  s_barrier
  s_mov_b32 s75, 1
L_iw_13:
  s_cmp_eq_u32 s49, 8
  s_cbranch_scc1 L_ln2
  s_cmp_eq_u32 s49, 3
  s_cbranch_scc1 L_sp
  s_cmp_eq_u32 s49, 4
  s_cbranch_scc1 L_ob
  s_cmp_eq_u32 s49, 9
  s_cbranch_scc1 L_att
  s_branch L_g3
L_ln1:
  s_cmp_lg_u32 s29, 0
  s_cbranch_scc1 L_ln1b
  v_mov_b32 v24, 0
  v_mov_b32 v25, 0
  v_mov_b32 v26, 0
  v_mov_b32 v27, 0
  v_lshlrev_b32 v21, 4, v1
  v_lshlrev_b32 v22, 13, v1
  s_mul_i32 s31, s42, 336
  s_add_u32 s31, s31, 0
  s_lshl_b32 s32, s42, 17
  s_add_u32 s32, s32, 134223872
  s_mov_b64 exec, 0x1fffff
  buffer_store_dwordx4 v[24:27], v21, s[4:7], s31 offen sc1
  s_mov_b64 exec, 0xffff
  buffer_store_dword v24, v22, s[4:7], s32 offen sc1
  s_mov_b64 exec, -1
L_ln1b:
  s_load_dwordx2 s[32:33], s[0:1], 0
  s_waitcnt lgkmcnt(0)
  s_mov_b32 s12, s32
  s_mov_b32 s13, s33
  s_mov_b32 s14, 2097152
  s_mov_b32 s15, 0x20000
  s_lshl_b32 s46, s42, 14
  s_add_u32 s56, s46, 2097152
  v_lshrrev_b32 v21, 4, v1
  v_and_b32 v22, 15, v1
  s_lshl_b32 s31, s29, 2
  v_add_u32 v21, s31, v21
  s_mov_b32 s31, 1024
  v_mul_lo_u32 v21, v21, s31
  v_lshl_add_u32 v23, v22, 4, v21
  buffer_load_dwordx4 v[64:67], v23, s[12:15], s46 offen offset:0
  buffer_load_dwordx4 v[68:71], v23, s[12:15], s46 offen offset:256
  buffer_load_dwordx4 v[72:75], v23, s[12:15], s46 offen offset:512
  buffer_load_dwordx4 v[76:79], v23, s[12:15], s46 offen offset:768
  s_waitcnt vmcnt(0)
  v_lshlrev_b32 v96, 16, v64
  v_and_b32 v97, 0xffff0000, v64
  v_lshlrev_b32 v98, 16, v65
  v_and_b32 v99, 0xffff0000, v65
  v_lshlrev_b32 v100, 16, v66
  v_and_b32 v101, 0xffff0000, v66
  v_lshlrev_b32 v102, 16, v67
  v_and_b32 v103, 0xffff0000, v67
  v_lshlrev_b32 v104, 16, v68
  v_and_b32 v105, 0xffff0000, v68
  v_lshlrev_b32 v106, 16, v69
  v_and_b32 v107, 0xffff0000, v69
  v_lshlrev_b32 v108, 16, v70
  v_and_b32 v109, 0xffff0000, v70
  v_lshlrev_b32 v110, 16, v71
  v_and_b32 v111, 0xffff0000, v71
  v_lshlrev_b32 v112, 16, v72
  v_and_b32 v113, 0xffff0000, v72
  v_lshlrev_b32 v114, 16, v73
  v_and_b32 v115, 0xffff0000, v73
  v_lshlrev_b32 v116, 16, v74
  v_and_b32 v117, 0xffff0000, v74
  v_lshlrev_b32 v118, 16, v75
  v_and_b32 v119, 0xffff0000, v75
  v_lshlrev_b32 v120, 16, v76
  v_and_b32 v121, 0xffff0000, v76
  v_lshlrev_b32 v122, 16, v77
  v_and_b32 v123, 0xffff0000, v77
  v_lshlrev_b32 v124, 16, v78
  v_and_b32 v125, 0xffff0000, v78
  v_lshlrev_b32 v126, 16, v79
  v_and_b32 v127, 0xffff0000, v79
  v_add_f32 v24, v96, v97
  v_add_f32 v24, v24, v98
  v_add_f32 v24, v24, v99
  v_add_f32 v24, v24, v100
  v_add_f32 v24, v24, v101
  v_add_f32 v24, v24, v102
  v_add_f32 v24, v24, v103
  v_add_f32 v24, v24, v104
  v_add_f32 v24, v24, v105
  v_add_f32 v24, v24, v106
  v_add_f32 v24, v24, v107
  v_add_f32 v24, v24, v108
  v_add_f32 v24, v24, v109
  v_add_f32 v24, v24, v110
  v_add_f32 v24, v24, v111
  v_add_f32 v24, v24, v112
  v_add_f32 v24, v24, v113
  v_add_f32 v24, v24, v114
  v_add_f32 v24, v24, v115
  v_add_f32 v24, v24, v116
  v_add_f32 v24, v24, v117
  v_add_f32 v24, v24, v118
  v_add_f32 v24, v24, v119
  v_add_f32 v24, v24, v120
  v_add_f32 v24, v24, v121
  v_add_f32 v24, v24, v122
  v_add_f32 v24, v24, v123
  v_add_f32 v24, v24, v124
  v_add_f32 v24, v24, v125
  v_add_f32 v24, v24, v126
  v_add_f32 v24, v24, v127
  s_nop 1
  v_add_f32_dpp v24, v24, v24 row_ror:8 row_mask:0xf bank_mask:0xf
  s_nop 1
  v_add_f32_dpp v24, v24, v24 row_ror:4 row_mask:0xf bank_mask:0xf
  s_nop 1
  v_add_f32_dpp v24, v24, v24 row_ror:2 row_mask:0xf bank_mask:0xf
  s_nop 1
  v_add_f32_dpp v24, v24, v24 row_ror:1 row_mask:0xf bank_mask:0xf
  v_mul_f32 v24, 0x3b000000, v24
  v_sub_f32 v26, v96, v24
  v_mul_f32 v25, v26, v26
  v_sub_f32 v26, v97, v24
  v_fmac_f32 v25, v26, v26
  v_sub_f32 v26, v98, v24
  v_fmac_f32 v25, v26, v26
  v_sub_f32 v26, v99, v24
  v_fmac_f32 v25, v26, v26
  v_sub_f32 v26, v100, v24
  v_fmac_f32 v25, v26, v26
  v_sub_f32 v26, v101, v24
  v_fmac_f32 v25, v26, v26
  v_sub_f32 v26, v102, v24
  v_fmac_f32 v25, v26, v26
  v_sub_f32 v26, v103, v24
  v_fmac_f32 v25, v26, v26
  v_sub_f32 v26, v104, v24
  v_fmac_f32 v25, v26, v26
  v_sub_f32 v26, v105, v24
  v_fmac_f32 v25, v26, v26
  v_sub_f32 v26, v106, v24
  v_fmac_f32 v25, v26, v26
  v_sub_f32 v26, v107, v24
  v_fmac_f32 v25, v26, v26
  v_sub_f32 v26, v108, v24
  v_fmac_f32 v25, v26, v26
  v_sub_f32 v26, v109, v24
  v_fmac_f32 v25, v26, v26
  v_sub_f32 v26, v110, v24
  v_fmac_f32 v25, v26, v26
  v_sub_f32 v26, v111, v24
  v_fmac_f32 v25, v26, v26
  v_sub_f32 v26, v112, v24
  v_fmac_f32 v25, v26, v26
  v_sub_f32 v26, v113, v24
  v_fmac_f32 v25, v26, v26
  v_sub_f32 v26, v114, v24
  v_fmac_f32 v25, v26, v26
  v_sub_f32 v26, v115, v24
  v_fmac_f32 v25, v26, v26
  v_sub_f32 v26, v116, v24
  v_fmac_f32 v25, v26, v26
  v_sub_f32 v26, v117, v24
  v_fmac_f32 v25, v26, v26
  v_sub_f32 v26, v118, v24
  v_fmac_f32 v25, v26, v26
  v_sub_f32 v26, v119, v24
  v_fmac_f32 v25, v26, v26
  v_sub_f32 v26, v120, v24
  v_fmac_f32 v25, v26, v26
  v_sub_f32 v26, v121, v24
  v_fmac_f32 v25, v26, v26
  v_sub_f32 v26, v122, v24
  v_fmac_f32 v25, v26, v26
  v_sub_f32 v26, v123, v24
  v_fmac_f32 v25, v26, v26
  v_sub_f32 v26, v124, v24
  v_fmac_f32 v25, v26, v26
  v_sub_f32 v26, v125, v24
  v_fmac_f32 v25, v26, v26
  v_sub_f32 v26, v126, v24
  v_fmac_f32 v25, v26, v26
  v_sub_f32 v26, v127, v24
  v_fmac_f32 v25, v26, v26
  s_nop 1
  v_add_f32_dpp v25, v25, v25 row_ror:8 row_mask:0xf bank_mask:0xf
  s_nop 1
  v_add_f32_dpp v25, v25, v25 row_ror:4 row_mask:0xf bank_mask:0xf
  s_nop 1
  v_add_f32_dpp v25, v25, v25 row_ror:2 row_mask:0xf bank_mask:0xf
  s_nop 1
  v_add_f32_dpp v25, v25, v25 row_ror:1 row_mask:0xf bank_mask:0xf
  v_mul_f32 v25, 0x3b000000, v25
  v_cvt_pk_bf16_f32 v24, v24, v25
  v_and_b32 v25, 0xffff0000, v24
  v_lshlrev_b32 v24, 16, v24
  v_add_f32 v25, 0x3727c5ac, v25
  v_cvt_pk_bf16_f32 v25, v25, v25
  v_and_b32 v25, 0xffff0000, v25
  v_sqrt_f32 v25, v25
  s_nop 0
  v_cvt_pk_bf16_f32 v25, v25, v25
  v_and_b32 v25, 0xffff0000, v25
  v_rcp_f32 v27, v25
  s_nop 0
  v_sub_f32 v96, v96, v24
  v_sub_f32 v97, v97, v24
  v_cvt_pk_bf16_f32 v26, v96, v97
  v_lshlrev_b32 v96, 16, v26
  v_and_b32 v97, 0xffff0000, v26
  v_mul_f32 v28, v96, v27
  v_mul_f32 v29, v97, v27
  v_fma_f32 v96, -v28, v25, v96
  v_fma_f32 v97, -v29, v25, v97
  v_fmac_f32 v28, v96, v27
  v_fmac_f32 v29, v97, v27
  v_cvt_pk_bf16_f32 v64, v28, v29
  v_sub_f32 v98, v98, v24
  v_sub_f32 v99, v99, v24
  v_cvt_pk_bf16_f32 v26, v98, v99
  v_lshlrev_b32 v98, 16, v26
  v_and_b32 v99, 0xffff0000, v26
  v_mul_f32 v28, v98, v27
  v_mul_f32 v29, v99, v27
  v_fma_f32 v98, -v28, v25, v98
  v_fma_f32 v99, -v29, v25, v99
  v_fmac_f32 v28, v98, v27
  v_fmac_f32 v29, v99, v27
  v_cvt_pk_bf16_f32 v65, v28, v29
  v_sub_f32 v100, v100, v24
  v_sub_f32 v101, v101, v24
  v_cvt_pk_bf16_f32 v26, v100, v101
  v_lshlrev_b32 v100, 16, v26
  v_and_b32 v101, 0xffff0000, v26
  v_mul_f32 v28, v100, v27
  v_mul_f32 v29, v101, v27
  v_fma_f32 v100, -v28, v25, v100
  v_fma_f32 v101, -v29, v25, v101
  v_fmac_f32 v28, v100, v27
  v_fmac_f32 v29, v101, v27
  v_cvt_pk_bf16_f32 v66, v28, v29
  v_sub_f32 v102, v102, v24
  v_sub_f32 v103, v103, v24
  v_cvt_pk_bf16_f32 v26, v102, v103
  v_lshlrev_b32 v102, 16, v26
  v_and_b32 v103, 0xffff0000, v26
  v_mul_f32 v28, v102, v27
  v_mul_f32 v29, v103, v27
  v_fma_f32 v102, -v28, v25, v102
  v_fma_f32 v103, -v29, v25, v103
  v_fmac_f32 v28, v102, v27
  v_fmac_f32 v29, v103, v27
  v_cvt_pk_bf16_f32 v67, v28, v29
  v_sub_f32 v104, v104, v24
  v_sub_f32 v105, v105, v24
  v_cvt_pk_bf16_f32 v26, v104, v105
  v_lshlrev_b32 v104, 16, v26
  v_and_b32 v105, 0xffff0000, v26
  v_mul_f32 v28, v104, v27
  v_mul_f32 v29, v105, v27
  v_fma_f32 v104, -v28, v25, v104
  v_fma_f32 v105, -v29, v25, v105
  v_fmac_f32 v28, v104, v27
  v_fmac_f32 v29, v105, v27
  v_cvt_pk_bf16_f32 v68, v28, v29
  v_sub_f32 v106, v106, v24
  v_sub_f32 v107, v107, v24
  v_cvt_pk_bf16_f32 v26, v106, v107
  v_lshlrev_b32 v106, 16, v26
  v_and_b32 v107, 0xffff0000, v26
  v_mul_f32 v28, v106, v27
  v_mul_f32 v29, v107, v27
  v_fma_f32 v106, -v28, v25, v106
  v_fma_f32 v107, -v29, v25, v107
  v_fmac_f32 v28, v106, v27
  v_fmac_f32 v29, v107, v27
  v_cvt_pk_bf16_f32 v69, v28, v29
  v_sub_f32 v108, v108, v24
  v_sub_f32 v109, v109, v24
  v_cvt_pk_bf16_f32 v26, v108, v109
  v_lshlrev_b32 v108, 16, v26
  v_and_b32 v109, 0xffff0000, v26
  v_mul_f32 v28, v108, v27
  v_mul_f32 v29, v109, v27
  v_fma_f32 v108, -v28, v25, v108
  v_fma_f32 v109, -v29, v25, v109
  v_fmac_f32 v28, v108, v27
  v_fmac_f32 v29, v109, v27
  v_cvt_pk_bf16_f32 v70, v28, v29
  v_sub_f32 v110, v110, v24
  v_sub_f32 v111, v111, v24
  v_cvt_pk_bf16_f32 v26, v110, v111
  v_lshlrev_b32 v110, 16, v26
  v_and_b32 v111, 0xffff0000, v26
  v_mul_f32 v28, v110, v27
  v_mul_f32 v29, v111, v27
  v_fma_f32 v110, -v28, v25, v110
  v_fma_f32 v111, -v29, v25, v111
  v_fmac_f32 v28, v110, v27
  v_fmac_f32 v29, v111, v27
  v_cvt_pk_bf16_f32 v71, v28, v29
  v_sub_f32 v112, v112, v24
  v_sub_f32 v113, v113, v24
  v_cvt_pk_bf16_f32 v26, v112, v113
  v_lshlrev_b32 v112, 16, v26
  v_and_b32 v113, 0xffff0000, v26
  v_mul_f32 v28, v112, v27
  v_mul_f32 v29, v113, v27
  v_fma_f32 v112, -v28, v25, v112
  v_fma_f32 v113, -v29, v25, v113
  v_fmac_f32 v28, v112, v27
  v_fmac_f32 v29, v113, v27
  v_cvt_pk_bf16_f32 v72, v28, v29
  v_sub_f32 v114, v114, v24
  v_sub_f32 v115, v115, v24
  v_cvt_pk_bf16_f32 v26, v114, v115
  v_lshlrev_b32 v114, 16, v26
  v_and_b32 v115, 0xffff0000, v26
  v_mul_f32 v28, v114, v27
  v_mul_f32 v29, v115, v27
  v_fma_f32 v114, -v28, v25, v114
  v_fma_f32 v115, -v29, v25, v115
  v_fmac_f32 v28, v114, v27
  v_fmac_f32 v29, v115, v27
  v_cvt_pk_bf16_f32 v73, v28, v29
  v_sub_f32 v116, v116, v24
  v_sub_f32 v117, v117, v24
  v_cvt_pk_bf16_f32 v26, v116, v117
  v_lshlrev_b32 v116, 16, v26
  v_and_b32 v117, 0xffff0000, v26
  v_mul_f32 v28, v116, v27
  v_mul_f32 v29, v117, v27
  v_fma_f32 v116, -v28, v25, v116
  v_fma_f32 v117, -v29, v25, v117
  v_fmac_f32 v28, v116, v27
  v_fmac_f32 v29, v117, v27
  v_cvt_pk_bf16_f32 v74, v28, v29
  v_sub_f32 v118, v118, v24
  v_sub_f32 v119, v119, v24
  v_cvt_pk_bf16_f32 v26, v118, v119
  v_lshlrev_b32 v118, 16, v26
  v_and_b32 v119, 0xffff0000, v26
  v_mul_f32 v28, v118, v27
  v_mul_f32 v29, v119, v27
  v_fma_f32 v118, -v28, v25, v118
  v_fma_f32 v119, -v29, v25, v119
  v_fmac_f32 v28, v118, v27
  v_fmac_f32 v29, v119, v27
  v_cvt_pk_bf16_f32 v75, v28, v29
  v_sub_f32 v120, v120, v24
  v_sub_f32 v121, v121, v24
  v_cvt_pk_bf16_f32 v26, v120, v121
  v_lshlrev_b32 v120, 16, v26
  v_and_b32 v121, 0xffff0000, v26
  v_mul_f32 v28, v120, v27
  v_mul_f32 v29, v121, v27
  v_fma_f32 v120, -v28, v25, v120
  v_fma_f32 v121, -v29, v25, v121
  v_fmac_f32 v28, v120, v27
  v_fmac_f32 v29, v121, v27
  v_cvt_pk_bf16_f32 v76, v28, v29
  v_sub_f32 v122, v122, v24
  v_sub_f32 v123, v123, v24
  v_cvt_pk_bf16_f32 v26, v122, v123
  v_lshlrev_b32 v122, 16, v26
  v_and_b32 v123, 0xffff0000, v26
  v_mul_f32 v28, v122, v27
  v_mul_f32 v29, v123, v27
  v_fma_f32 v122, -v28, v25, v122
  v_fma_f32 v123, -v29, v25, v123
  v_fmac_f32 v28, v122, v27
  v_fmac_f32 v29, v123, v27
  v_cvt_pk_bf16_f32 v77, v28, v29
  v_sub_f32 v124, v124, v24
  v_sub_f32 v125, v125, v24
  v_cvt_pk_bf16_f32 v26, v124, v125
  v_lshlrev_b32 v124, 16, v26
  v_and_b32 v125, 0xffff0000, v26
  v_mul_f32 v28, v124, v27
  v_mul_f32 v29, v125, v27
  v_fma_f32 v124, -v28, v25, v124
  v_fma_f32 v125, -v29, v25, v125
  v_fmac_f32 v28, v124, v27
  v_fmac_f32 v29, v125, v27
  v_cvt_pk_bf16_f32 v78, v28, v29
  v_sub_f32 v126, v126, v24
  v_sub_f32 v127, v127, v24
  v_cvt_pk_bf16_f32 v26, v126, v127
  v_lshlrev_b32 v126, 16, v26
  v_and_b32 v127, 0xffff0000, v26
  v_mul_f32 v28, v126, v27
  v_mul_f32 v29, v127, v27
  v_fma_f32 v126, -v28, v25, v126
  v_fma_f32 v127, -v29, v25, v127
  v_fmac_f32 v28, v126, v27
  v_fmac_f32 v29, v127, v27
  v_cvt_pk_bf16_f32 v79, v28, v29
  buffer_store_dwordx4 v[64:67], v23, s[4:7], s56 offen offset:0 sc1
  buffer_store_dwordx4 v[68:71], v23, s[4:7], s56 offen offset:256 sc1
  buffer_store_dwordx4 v[72:75], v23, s[4:7], s56 offen offset:512 sc1
  buffer_store_dwordx4 v[76:79], v23, s[4:7], s56 offen offset:768 sc1
  s_waitcnt vmcnt(0)
  s_barrier
  s_cmp_lg_u32 s29, 0
  s_cbranch_scc1 L_ls_16
  s_lshr_b32 s31, s42, 4
  s_lshl_b32 s31, s31, 2
  s_add_u32 s32, s31, 96
  s_add_u32 s33, s31, 132
  v_mov_b32 v21, 1
  v_mov_b32 v22, 12
  v_mov_b32 v23, 128
  v_mov_b32 v24, 127
  v_mov_b32 v25, 1
  v_writelane_b32 v22, s32, 1
  v_writelane_b32 v23, s33, 1
  v_writelane_b32 v24, 15, 1
  s_mov_b64 exec, 3
  buffer_atomic_add v21, v22, s[8:11], 0 offen sc0
  s_waitcnt vmcnt(0)
  v_cmp_eq_u32 vcc, v24, v21
  s_and_b64 exec, exec, vcc
  s_cbranch_execz L_ls_16x
  buffer_store_dword v25, v23, s[8:11], 0 offen sc1
L_ls_16x:
  s_mov_b64 exec, -1
L_ls_16:
  s_branch L_done
L_ln2:
  s_load_dwordx2 s[32:33], s[0:1], 72
  s_waitcnt lgkmcnt(0)
  s_mov_b32 s12, s32
  s_mov_b32 s13, s33
  s_mov_b32 s14, 8388608
  s_mov_b32 s15, 0x20000
  s_lshl_b32 s33, s42, 16
  s_add_u32 s34, s33, 32768
  v_lshlrev_b32 v252, 7, v0
  buffer_load_dword v250, v252, s[12:15], s33 offen
  buffer_load_dword v251, v252, s[12:15], s34 offen
  s_mov_b32 s41, s42
  s_lshr_b32 s58, s41, 3
  s_lshl_b32 s58, s58, 7
  s_add_u32 s58, s58, 30720
  s_cmp_lg_u32 s29, 0
  s_cbranch_scc1 L_wfx_18
  s_mov_b32 s32, 0
  s_mov_b64 exec, 1
L_wf_17:
  buffer_load_dword v21, v20, s[4:7], s58 offen sc1
  s_add_u32 s32, s32, 1
  s_waitcnt vmcnt(0)
  v_readfirstlane_b32 s31, v21
  s_cmp_gt_u32 s32, 0x40000
  s_cbranch_scc1 L_wfx_18
  s_cmp_ge_u32 s31, 1
  s_cbranch_scc1 L_wfx_18
  s_sleep 8
  s_branch L_wf_17
L_wfx_18:
  s_mov_b64 exec, -1
  s_barrier
  s_mul_i32 s46, s41, 28672
  s_add_u32 s56, s46, 92274688
  s_add_u32 s46, s46, 88080384
  v_lshrrev_b32 v21, 4, v1
  v_and_b32 v22, 15, v1
  s_lshl_b32 s31, s29, 2
  v_add_u32 v21, s31, v21
  s_mov_b32 s31, 1792
  v_mul_lo_u32 v21, v21, s31
  v_lshl_add_u32 v23, v22, 4, v21
  buffer_load_dwordx4 v[64:67], v23, s[4:7], s46 offen offset:0 sc1
  buffer_load_dwordx4 v[68:71], v23, s[4:7], s46 offen offset:256 sc1
  buffer_load_dwordx4 v[72:75], v23, s[4:7], s46 offen offset:512 sc1
  buffer_load_dwordx4 v[76:79], v23, s[4:7], s46 offen offset:768 sc1
  buffer_load_dwordx4 v[80:83], v23, s[4:7], s46 offen offset:1024 sc1
  buffer_load_dwordx4 v[84:87], v23, s[4:7], s46 offen offset:1280 sc1
  buffer_load_dwordx4 v[88:91], v23, s[4:7], s46 offen offset:1536 sc1
  s_waitcnt vmcnt(0)
  v_lshlrev_b32 v96, 16, v64
  v_and_b32 v97, 0xffff0000, v64
  v_lshlrev_b32 v98, 16, v65
  v_and_b32 v99, 0xffff0000, v65
  v_lshlrev_b32 v100, 16, v66
  v_and_b32 v101, 0xffff0000, v66
  v_lshlrev_b32 v102, 16, v67
  v_and_b32 v103, 0xffff0000, v67
  v_lshlrev_b32 v104, 16, v68
  v_and_b32 v105, 0xffff0000, v68
  v_lshlrev_b32 v106, 16, v69
  v_and_b32 v107, 0xffff0000, v69
  v_lshlrev_b32 v108, 16, v70
  v_and_b32 v109, 0xffff0000, v70
  v_lshlrev_b32 v110, 16, v71
  v_and_b32 v111, 0xffff0000, v71
  v_lshlrev_b32 v112, 16, v72
  v_and_b32 v113, 0xffff0000, v72
  v_lshlrev_b32 v114, 16, v73
  v_and_b32 v115, 0xffff0000, v73
  v_lshlrev_b32 v116, 16, v74
  v_and_b32 v117, 0xffff0000, v74
  v_lshlrev_b32 v118, 16, v75
  v_and_b32 v119, 0xffff0000, v75
  v_lshlrev_b32 v120, 16, v76
  v_and_b32 v121, 0xffff0000, v76
  v_lshlrev_b32 v122, 16, v77
  v_and_b32 v123, 0xffff0000, v77
  v_lshlrev_b32 v124, 16, v78
  v_and_b32 v125, 0xffff0000, v78
  v_lshlrev_b32 v126, 16, v79
  v_and_b32 v127, 0xffff0000, v79
  v_lshlrev_b32 v128, 16, v80
  v_and_b32 v129, 0xffff0000, v80
  v_lshlrev_b32 v130, 16, v81
  v_and_b32 v131, 0xffff0000, v81
  v_lshlrev_b32 v132, 16, v82
  v_and_b32 v133, 0xffff0000, v82
  v_lshlrev_b32 v134, 16, v83
  v_and_b32 v135, 0xffff0000, v83
  v_lshlrev_b32 v136, 16, v84
  v_and_b32 v137, 0xffff0000, v84
  v_lshlrev_b32 v138, 16, v85
  v_and_b32 v139, 0xffff0000, v85
  v_lshlrev_b32 v140, 16, v86
  v_and_b32 v141, 0xffff0000, v86
  v_lshlrev_b32 v142, 16, v87
  v_and_b32 v143, 0xffff0000, v87
  v_lshlrev_b32 v144, 16, v88
  v_and_b32 v145, 0xffff0000, v88
  v_lshlrev_b32 v146, 16, v89
  v_and_b32 v147, 0xffff0000, v89
  v_lshlrev_b32 v148, 16, v90
  v_and_b32 v149, 0xffff0000, v90
  v_lshlrev_b32 v150, 16, v91
  v_and_b32 v151, 0xffff0000, v91
  v_add_f32 v24, v96, v97
  v_add_f32 v24, v24, v98
  v_add_f32 v24, v24, v99
  v_add_f32 v24, v24, v100
  v_add_f32 v24, v24, v101
  v_add_f32 v24, v24, v102
  v_add_f32 v24, v24, v103
  v_add_f32 v24, v24, v104
  v_add_f32 v24, v24, v105
  v_add_f32 v24, v24, v106
  v_add_f32 v24, v24, v107
  v_add_f32 v24, v24, v108
  v_add_f32 v24, v24, v109
  v_add_f32 v24, v24, v110
  v_add_f32 v24, v24, v111
  v_add_f32 v24, v24, v112
  v_add_f32 v24, v24, v113
  v_add_f32 v24, v24, v114
  v_add_f32 v24, v24, v115
  v_add_f32 v24, v24, v116
  v_add_f32 v24, v24, v117
  v_add_f32 v24, v24, v118
  v_add_f32 v24, v24, v119
  v_add_f32 v24, v24, v120
  v_add_f32 v24, v24, v121
  v_add_f32 v24, v24, v122
  v_add_f32 v24, v24, v123
  v_add_f32 v24, v24, v124
  v_add_f32 v24, v24, v125
  v_add_f32 v24, v24, v126
  v_add_f32 v24, v24, v127
  v_add_f32 v24, v24, v128
  v_add_f32 v24, v24, v129
  v_add_f32 v24, v24, v130
  v_add_f32 v24, v24, v131
  v_add_f32 v24, v24, v132
  v_add_f32 v24, v24, v133
  v_add_f32 v24, v24, v134
  v_add_f32 v24, v24, v135
  v_add_f32 v24, v24, v136
  v_add_f32 v24, v24, v137
  v_add_f32 v24, v24, v138
  v_add_f32 v24, v24, v139
  v_add_f32 v24, v24, v140
  v_add_f32 v24, v24, v141
  v_add_f32 v24, v24, v142
  v_add_f32 v24, v24, v143
  v_add_f32 v24, v24, v144
  v_add_f32 v24, v24, v145
  v_add_f32 v24, v24, v146
  v_add_f32 v24, v24, v147
  v_add_f32 v24, v24, v148
  v_add_f32 v24, v24, v149
  v_add_f32 v24, v24, v150
  v_add_f32 v24, v24, v151
  s_nop 1
  v_add_f32_dpp v24, v24, v24 row_ror:8 row_mask:0xf bank_mask:0xf
  s_nop 1
  v_add_f32_dpp v24, v24, v24 row_ror:4 row_mask:0xf bank_mask:0xf
  s_nop 1
  v_add_f32_dpp v24, v24, v24 row_ror:2 row_mask:0xf bank_mask:0xf
  s_nop 1
  v_add_f32_dpp v24, v24, v24 row_ror:1 row_mask:0xf bank_mask:0xf
  v_mul_f32 v24, 0x3a924925, v24
  v_sub_f32 v26, v96, v24
  v_mul_f32 v25, v26, v26
  v_sub_f32 v26, v97, v24
  v_fmac_f32 v25, v26, v26
  v_sub_f32 v26, v98, v24
  v_fmac_f32 v25, v26, v26
  v_sub_f32 v26, v99, v24
  v_fmac_f32 v25, v26, v26
  v_sub_f32 v26, v100, v24
  v_fmac_f32 v25, v26, v26
  v_sub_f32 v26, v101, v24
  v_fmac_f32 v25, v26, v26
  v_sub_f32 v26, v102, v24
  v_fmac_f32 v25, v26, v26
  v_sub_f32 v26, v103, v24
  v_fmac_f32 v25, v26, v26
  v_sub_f32 v26, v104, v24
  v_fmac_f32 v25, v26, v26
  v_sub_f32 v26, v105, v24
  v_fmac_f32 v25, v26, v26
  v_sub_f32 v26, v106, v24
  v_fmac_f32 v25, v26, v26
  v_sub_f32 v26, v107, v24
  v_fmac_f32 v25, v26, v26
  v_sub_f32 v26, v108, v24
  v_fmac_f32 v25, v26, v26
  v_sub_f32 v26, v109, v24
  v_fmac_f32 v25, v26, v26
  v_sub_f32 v26, v110, v24
  v_fmac_f32 v25, v26, v26
  v_sub_f32 v26, v111, v24
  v_fmac_f32 v25, v26, v26
  v_sub_f32 v26, v112, v24
  v_fmac_f32 v25, v26, v26
  v_sub_f32 v26, v113, v24
  v_fmac_f32 v25, v26, v26
  v_sub_f32 v26, v114, v24
  v_fmac_f32 v25, v26, v26
  v_sub_f32 v26, v115, v24
  v_fmac_f32 v25, v26, v26
  v_sub_f32 v26, v116, v24
  v_fmac_f32 v25, v26, v26
  v_sub_f32 v26, v117, v24
  v_fmac_f32 v25, v26, v26
  v_sub_f32 v26, v118, v24
  v_fmac_f32 v25, v26, v26
  v_sub_f32 v26, v119, v24
  v_fmac_f32 v25, v26, v26
  v_sub_f32 v26, v120, v24
  v_fmac_f32 v25, v26, v26
  v_sub_f32 v26, v121, v24
  v_fmac_f32 v25, v26, v26
  v_sub_f32 v26, v122, v24
  v_fmac_f32 v25, v26, v26
  v_sub_f32 v26, v123, v24
  v_fmac_f32 v25, v26, v26
  v_sub_f32 v26, v124, v24
  v_fmac_f32 v25, v26, v26
  v_sub_f32 v26, v125, v24
  v_fmac_f32 v25, v26, v26
  v_sub_f32 v26, v126, v24
  v_fmac_f32 v25, v26, v26
  v_sub_f32 v26, v127, v24
  v_fmac_f32 v25, v26, v26
  v_sub_f32 v26, v128, v24
  v_fmac_f32 v25, v26, v26
  v_sub_f32 v26, v129, v24
  v_fmac_f32 v25, v26, v26
  v_sub_f32 v26, v130, v24
  v_fmac_f32 v25, v26, v26
  v_sub_f32 v26, v131, v24
  v_fmac_f32 v25, v26, v26
  v_sub_f32 v26, v132, v24
  v_fmac_f32 v25, v26, v26
  v_sub_f32 v26, v133, v24
  v_fmac_f32 v25, v26, v26
  v_sub_f32 v26, v134, v24
  v_fmac_f32 v25, v26, v26
  v_sub_f32 v26, v135, v24
  v_fmac_f32 v25, v26, v26
  v_sub_f32 v26, v136, v24
  v_fmac_f32 v25, v26, v26
  v_sub_f32 v26, v137, v24
  v_fmac_f32 v25, v26, v26
  v_sub_f32 v26, v138, v24
  v_fmac_f32 v25, v26, v26
  v_sub_f32 v26, v139, v24
  v_fmac_f32 v25, v26, v26
  v_sub_f32 v26, v140, v24
  v_fmac_f32 v25, v26, v26
  v_sub_f32 v26, v141, v24
  v_fmac_f32 v25, v26, v26
  v_sub_f32 v26, v142, v24
  v_fmac_f32 v25, v26, v26
  v_sub_f32 v26, v143, v24
  v_fmac_f32 v25, v26, v26
  v_sub_f32 v26, v144, v24
  v_fmac_f32 v25, v26, v26
  v_sub_f32 v26, v145, v24
  v_fmac_f32 v25, v26, v26
  v_sub_f32 v26, v146, v24
  v_fmac_f32 v25, v26, v26
  v_sub_f32 v26, v147, v24
  v_fmac_f32 v25, v26, v26
  v_sub_f32 v26, v148, v24
  v_fmac_f32 v25, v26, v26
  v_sub_f32 v26, v149, v24
  v_fmac_f32 v25, v26, v26
  v_sub_f32 v26, v150, v24
  v_fmac_f32 v25, v26, v26
  v_sub_f32 v26, v151, v24
  v_fmac_f32 v25, v26, v26
  s_nop 1
  v_add_f32_dpp v25, v25, v25 row_ror:8 row_mask:0xf bank_mask:0xf
  s_nop 1
  v_add_f32_dpp v25, v25, v25 row_ror:4 row_mask:0xf bank_mask:0xf
  s_nop 1
  v_add_f32_dpp v25, v25, v25 row_ror:2 row_mask:0xf bank_mask:0xf
  s_nop 1
  v_add_f32_dpp v25, v25, v25 row_ror:1 row_mask:0xf bank_mask:0xf
  v_mul_f32 v25, 0x3a924925, v25
  v_cvt_pk_bf16_f32 v24, v24, v25
  v_and_b32 v25, 0xffff0000, v24
  v_lshlrev_b32 v24, 16, v24
  v_add_f32 v25, 0x3727c5ac, v25
  v_cvt_pk_bf16_f32 v25, v25, v25
  v_and_b32 v25, 0xffff0000, v25
  v_sqrt_f32 v25, v25
  s_nop 0
  v_cvt_pk_bf16_f32 v25, v25, v25
  v_and_b32 v25, 0xffff0000, v25
  v_rcp_f32 v27, v25
  s_nop 0
  v_sub_f32 v96, v96, v24
  v_sub_f32 v97, v97, v24
  v_cvt_pk_bf16_f32 v26, v96, v97
  v_lshlrev_b32 v96, 16, v26
  v_and_b32 v97, 0xffff0000, v26
  v_mul_f32 v28, v96, v27
  v_mul_f32 v29, v97, v27
  v_fma_f32 v96, -v28, v25, v96
  v_fma_f32 v97, -v29, v25, v97
  v_fmac_f32 v28, v96, v27
  v_fmac_f32 v29, v97, v27
  v_cvt_pk_bf16_f32 v64, v28, v29
  v_sub_f32 v98, v98, v24
  v_sub_f32 v99, v99, v24
  v_cvt_pk_bf16_f32 v26, v98, v99
  v_lshlrev_b32 v98, 16, v26
  v_and_b32 v99, 0xffff0000, v26
  v_mul_f32 v28, v98, v27
  v_mul_f32 v29, v99, v27
  v_fma_f32 v98, -v28, v25, v98
  v_fma_f32 v99, -v29, v25, v99
  v_fmac_f32 v28, v98, v27
  v_fmac_f32 v29, v99, v27
  v_cvt_pk_bf16_f32 v65, v28, v29
  v_sub_f32 v100, v100, v24
  v_sub_f32 v101, v101, v24
  v_cvt_pk_bf16_f32 v26, v100, v101
  v_lshlrev_b32 v100, 16, v26
  v_and_b32 v101, 0xffff0000, v26
  v_mul_f32 v28, v100, v27
  v_mul_f32 v29, v101, v27
  v_fma_f32 v100, -v28, v25, v100
  v_fma_f32 v101, -v29, v25, v101
  v_fmac_f32 v28, v100, v27
  v_fmac_f32 v29, v101, v27
  v_cvt_pk_bf16_f32 v66, v28, v29
  v_sub_f32 v102, v102, v24
  v_sub_f32 v103, v103, v24
  v_cvt_pk_bf16_f32 v26, v102, v103
  v_lshlrev_b32 v102, 16, v26
  v_and_b32 v103, 0xffff0000, v26
  v_mul_f32 v28, v102, v27
  v_mul_f32 v29, v103, v27
  v_fma_f32 v102, -v28, v25, v102
  v_fma_f32 v103, -v29, v25, v103
  v_fmac_f32 v28, v102, v27
  v_fmac_f32 v29, v103, v27
  v_cvt_pk_bf16_f32 v67, v28, v29
  v_sub_f32 v104, v104, v24
  v_sub_f32 v105, v105, v24
  v_cvt_pk_bf16_f32 v26, v104, v105
  v_lshlrev_b32 v104, 16, v26
  v_and_b32 v105, 0xffff0000, v26
  v_mul_f32 v28, v104, v27
  v_mul_f32 v29, v105, v27
  v_fma_f32 v104, -v28, v25, v104
  v_fma_f32 v105, -v29, v25, v105
  v_fmac_f32 v28, v104, v27
  v_fmac_f32 v29, v105, v27
  v_cvt_pk_bf16_f32 v68, v28, v29
  v_sub_f32 v106, v106, v24
  v_sub_f32 v107, v107, v24
  v_cvt_pk_bf16_f32 v26, v106, v107
  v_lshlrev_b32 v106, 16, v26
  v_and_b32 v107, 0xffff0000, v26
  v_mul_f32 v28, v106, v27
  v_mul_f32 v29, v107, v27
  v_fma_f32 v106, -v28, v25, v106
  v_fma_f32 v107, -v29, v25, v107
  v_fmac_f32 v28, v106, v27
  v_fmac_f32 v29, v107, v27
  v_cvt_pk_bf16_f32 v69, v28, v29
  v_sub_f32 v108, v108, v24
  v_sub_f32 v109, v109, v24
  v_cvt_pk_bf16_f32 v26, v108, v109
  v_lshlrev_b32 v108, 16, v26
  v_and_b32 v109, 0xffff0000, v26
  v_mul_f32 v28, v108, v27
  v_mul_f32 v29, v109, v27
  v_fma_f32 v108, -v28, v25, v108
  v_fma_f32 v109, -v29, v25, v109
  v_fmac_f32 v28, v108, v27
  v_fmac_f32 v29, v109, v27
  v_cvt_pk_bf16_f32 v70, v28, v29
  v_sub_f32 v110, v110, v24
  v_sub_f32 v111, v111, v24
  v_cvt_pk_bf16_f32 v26, v110, v111
  v_lshlrev_b32 v110, 16, v26
  v_and_b32 v111, 0xffff0000, v26
  v_mul_f32 v28, v110, v27
  v_mul_f32 v29, v111, v27
  v_fma_f32 v110, -v28, v25, v110
  v_fma_f32 v111, -v29, v25, v111
  v_fmac_f32 v28, v110, v27
  v_fmac_f32 v29, v111, v27
  v_cvt_pk_bf16_f32 v71, v28, v29
  v_sub_f32 v112, v112, v24
  v_sub_f32 v113, v113, v24
  v_cvt_pk_bf16_f32 v26, v112, v113
  v_lshlrev_b32 v112, 16, v26
  v_and_b32 v113, 0xffff0000, v26
  v_mul_f32 v28, v112, v27
  v_mul_f32 v29, v113, v27
  v_fma_f32 v112, -v28, v25, v112
  v_fma_f32 v113, -v29, v25, v113
  v_fmac_f32 v28, v112, v27
  v_fmac_f32 v29, v113, v27
  v_cvt_pk_bf16_f32 v72, v28, v29
  v_sub_f32 v114, v114, v24
  v_sub_f32 v115, v115, v24
  v_cvt_pk_bf16_f32 v26, v114, v115
  v_lshlrev_b32 v114, 16, v26
  v_and_b32 v115, 0xffff0000, v26
  v_mul_f32 v28, v114, v27
  v_mul_f32 v29, v115, v27
  v_fma_f32 v114, -v28, v25, v114
  v_fma_f32 v115, -v29, v25, v115
  v_fmac_f32 v28, v114, v27
  v_fmac_f32 v29, v115, v27
  v_cvt_pk_bf16_f32 v73, v28, v29
  v_sub_f32 v116, v116, v24
  v_sub_f32 v117, v117, v24
  v_cvt_pk_bf16_f32 v26, v116, v117
  v_lshlrev_b32 v116, 16, v26
  v_and_b32 v117, 0xffff0000, v26
  v_mul_f32 v28, v116, v27
  v_mul_f32 v29, v117, v27
  v_fma_f32 v116, -v28, v25, v116
  v_fma_f32 v117, -v29, v25, v117
  v_fmac_f32 v28, v116, v27
  v_fmac_f32 v29, v117, v27
  v_cvt_pk_bf16_f32 v74, v28, v29
  v_sub_f32 v118, v118, v24
  v_sub_f32 v119, v119, v24
  v_cvt_pk_bf16_f32 v26, v118, v119
  v_lshlrev_b32 v118, 16, v26
  v_and_b32 v119, 0xffff0000, v26
  v_mul_f32 v28, v118, v27
  v_mul_f32 v29, v119, v27
  v_fma_f32 v118, -v28, v25, v118
  v_fma_f32 v119, -v29, v25, v119
  v_fmac_f32 v28, v118, v27
  v_fmac_f32 v29, v119, v27
  v_cvt_pk_bf16_f32 v75, v28, v29
  v_sub_f32 v120, v120, v24
  v_sub_f32 v121, v121, v24
  v_cvt_pk_bf16_f32 v26, v120, v121
  v_lshlrev_b32 v120, 16, v26
  v_and_b32 v121, 0xffff0000, v26
  v_mul_f32 v28, v120, v27
  v_mul_f32 v29, v121, v27
  v_fma_f32 v120, -v28, v25, v120
  v_fma_f32 v121, -v29, v25, v121
  v_fmac_f32 v28, v120, v27
  v_fmac_f32 v29, v121, v27
  v_cvt_pk_bf16_f32 v76, v28, v29
  v_sub_f32 v122, v122, v24
  v_sub_f32 v123, v123, v24
  v_cvt_pk_bf16_f32 v26, v122, v123
  v_lshlrev_b32 v122, 16, v26
  v_and_b32 v123, 0xffff0000, v26
  v_mul_f32 v28, v122, v27
  v_mul_f32 v29, v123, v27
  v_fma_f32 v122, -v28, v25, v122
  v_fma_f32 v123, -v29, v25, v123
  v_fmac_f32 v28, v122, v27
  v_fmac_f32 v29, v123, v27
  v_cvt_pk_bf16_f32 v77, v28, v29
  v_sub_f32 v124, v124, v24
  v_sub_f32 v125, v125, v24
  v_cvt_pk_bf16_f32 v26, v124, v125
  v_lshlrev_b32 v124, 16, v26
  v_and_b32 v125, 0xffff0000, v26
  v_mul_f32 v28, v124, v27
  v_mul_f32 v29, v125, v27
  v_fma_f32 v124, -v28, v25, v124
  v_fma_f32 v125, -v29, v25, v125
  v_fmac_f32 v28, v124, v27
  v_fmac_f32 v29, v125, v27
  v_cvt_pk_bf16_f32 v78, v28, v29
  v_sub_f32 v126, v126, v24
  v_sub_f32 v127, v127, v24
  v_cvt_pk_bf16_f32 v26, v126, v127
  v_lshlrev_b32 v126, 16, v26
  v_and_b32 v127, 0xffff0000, v26
  v_mul_f32 v28, v126, v27
  v_mul_f32 v29, v127, v27
  v_fma_f32 v126, -v28, v25, v126
  v_fma_f32 v127, -v29, v25, v127
  v_fmac_f32 v28, v126, v27
  v_fmac_f32 v29, v127, v27
  v_cvt_pk_bf16_f32 v79, v28, v29
  v_sub_f32 v128, v128, v24
  v_sub_f32 v129, v129, v24
  v_cvt_pk_bf16_f32 v26, v128, v129
  v_lshlrev_b32 v128, 16, v26
  v_and_b32 v129, 0xffff0000, v26
  v_mul_f32 v28, v128, v27
  v_mul_f32 v29, v129, v27
  v_fma_f32 v128, -v28, v25, v128
  v_fma_f32 v129, -v29, v25, v129
  v_fmac_f32 v28, v128, v27
  v_fmac_f32 v29, v129, v27
  v_cvt_pk_bf16_f32 v80, v28, v29
  v_sub_f32 v130, v130, v24
  v_sub_f32 v131, v131, v24
  v_cvt_pk_bf16_f32 v26, v130, v131
  v_lshlrev_b32 v130, 16, v26
  v_and_b32 v131, 0xffff0000, v26
  v_mul_f32 v28, v130, v27
  v_mul_f32 v29, v131, v27
  v_fma_f32 v130, -v28, v25, v130
  v_fma_f32 v131, -v29, v25, v131
  v_fmac_f32 v28, v130, v27
  v_fmac_f32 v29, v131, v27
  v_cvt_pk_bf16_f32 v81, v28, v29
  v_sub_f32 v132, v132, v24
  v_sub_f32 v133, v133, v24
  v_cvt_pk_bf16_f32 v26, v132, v133
  v_lshlrev_b32 v132, 16, v26
  v_and_b32 v133, 0xffff0000, v26
  v_mul_f32 v28, v132, v27
  v_mul_f32 v29, v133, v27
  v_fma_f32 v132, -v28, v25, v132
  v_fma_f32 v133, -v29, v25, v133
  v_fmac_f32 v28, v132, v27
  v_fmac_f32 v29, v133, v27
  v_cvt_pk_bf16_f32 v82, v28, v29
  v_sub_f32 v134, v134, v24
  v_sub_f32 v135, v135, v24
  v_cvt_pk_bf16_f32 v26, v134, v135
  v_lshlrev_b32 v134, 16, v26
  v_and_b32 v135, 0xffff0000, v26
  v_mul_f32 v28, v134, v27
  v_mul_f32 v29, v135, v27
  v_fma_f32 v134, -v28, v25, v134
  v_fma_f32 v135, -v29, v25, v135
  v_fmac_f32 v28, v134, v27
  v_fmac_f32 v29, v135, v27
  v_cvt_pk_bf16_f32 v83, v28, v29
  v_sub_f32 v136, v136, v24
  v_sub_f32 v137, v137, v24
  v_cvt_pk_bf16_f32 v26, v136, v137
  v_lshlrev_b32 v136, 16, v26
  v_and_b32 v137, 0xffff0000, v26
  v_mul_f32 v28, v136, v27
  v_mul_f32 v29, v137, v27
  v_fma_f32 v136, -v28, v25, v136
  v_fma_f32 v137, -v29, v25, v137
  v_fmac_f32 v28, v136, v27
  v_fmac_f32 v29, v137, v27
  v_cvt_pk_bf16_f32 v84, v28, v29
  v_sub_f32 v138, v138, v24
  v_sub_f32 v139, v139, v24
  v_cvt_pk_bf16_f32 v26, v138, v139
  v_lshlrev_b32 v138, 16, v26
  v_and_b32 v139, 0xffff0000, v26
  v_mul_f32 v28, v138, v27
  v_mul_f32 v29, v139, v27
  v_fma_f32 v138, -v28, v25, v138
  v_fma_f32 v139, -v29, v25, v139
  v_fmac_f32 v28, v138, v27
  v_fmac_f32 v29, v139, v27
  v_cvt_pk_bf16_f32 v85, v28, v29
  v_sub_f32 v140, v140, v24
  v_sub_f32 v141, v141, v24
  v_cvt_pk_bf16_f32 v26, v140, v141
  v_lshlrev_b32 v140, 16, v26
  v_and_b32 v141, 0xffff0000, v26
  v_mul_f32 v28, v140, v27
  v_mul_f32 v29, v141, v27
  v_fma_f32 v140, -v28, v25, v140
  v_fma_f32 v141, -v29, v25, v141
  v_fmac_f32 v28, v140, v27
  v_fmac_f32 v29, v141, v27
  v_cvt_pk_bf16_f32 v86, v28, v29
  v_sub_f32 v142, v142, v24
  v_sub_f32 v143, v143, v24
  v_cvt_pk_bf16_f32 v26, v142, v143
  v_lshlrev_b32 v142, 16, v26
  v_and_b32 v143, 0xffff0000, v26
  v_mul_f32 v28, v142, v27
  v_mul_f32 v29, v143, v27
  v_fma_f32 v142, -v28, v25, v142
  v_fma_f32 v143, -v29, v25, v143
  v_fmac_f32 v28, v142, v27
  v_fmac_f32 v29, v143, v27
  v_cvt_pk_bf16_f32 v87, v28, v29
  v_sub_f32 v144, v144, v24
  v_sub_f32 v145, v145, v24
  v_cvt_pk_bf16_f32 v26, v144, v145
  v_lshlrev_b32 v144, 16, v26
  v_and_b32 v145, 0xffff0000, v26
  v_mul_f32 v28, v144, v27
  v_mul_f32 v29, v145, v27
  v_fma_f32 v144, -v28, v25, v144
  v_fma_f32 v145, -v29, v25, v145
  v_fmac_f32 v28, v144, v27
  v_fmac_f32 v29, v145, v27
  v_cvt_pk_bf16_f32 v88, v28, v29
  v_sub_f32 v146, v146, v24
  v_sub_f32 v147, v147, v24
  v_cvt_pk_bf16_f32 v26, v146, v147
  v_lshlrev_b32 v146, 16, v26
  v_and_b32 v147, 0xffff0000, v26
  v_mul_f32 v28, v146, v27
  v_mul_f32 v29, v147, v27
  v_fma_f32 v146, -v28, v25, v146
  v_fma_f32 v147, -v29, v25, v147
  v_fmac_f32 v28, v146, v27
  v_fmac_f32 v29, v147, v27
  v_cvt_pk_bf16_f32 v89, v28, v29
  v_sub_f32 v148, v148, v24
  v_sub_f32 v149, v149, v24
  v_cvt_pk_bf16_f32 v26, v148, v149
  v_lshlrev_b32 v148, 16, v26
  v_and_b32 v149, 0xffff0000, v26
  v_mul_f32 v28, v148, v27
  v_mul_f32 v29, v149, v27
  v_fma_f32 v148, -v28, v25, v148
  v_fma_f32 v149, -v29, v25, v149
  v_fmac_f32 v28, v148, v27
  v_fmac_f32 v29, v149, v27
  v_cvt_pk_bf16_f32 v90, v28, v29
  v_sub_f32 v150, v150, v24
  v_sub_f32 v151, v151, v24
  v_cvt_pk_bf16_f32 v26, v150, v151
  v_lshlrev_b32 v150, 16, v26
  v_and_b32 v151, 0xffff0000, v26
  v_mul_f32 v28, v150, v27
  v_mul_f32 v29, v151, v27
  v_fma_f32 v150, -v28, v25, v150
  v_fma_f32 v151, -v29, v25, v151
  v_fmac_f32 v28, v150, v27
  v_fmac_f32 v29, v151, v27
  v_cvt_pk_bf16_f32 v91, v28, v29
  buffer_store_dwordx4 v[64:67], v23, s[4:7], s56 offen offset:0 sc1
  buffer_store_dwordx4 v[68:71], v23, s[4:7], s56 offen offset:256 sc1
  buffer_store_dwordx4 v[72:75], v23, s[4:7], s56 offen offset:512 sc1
  buffer_store_dwordx4 v[76:79], v23, s[4:7], s56 offen offset:768 sc1
  buffer_store_dwordx4 v[80:83], v23, s[4:7], s56 offen offset:1024 sc1
  buffer_store_dwordx4 v[84:87], v23, s[4:7], s56 offen offset:1280 sc1
  buffer_store_dwordx4 v[88:91], v23, s[4:7], s56 offen offset:1536 sc1
  s_mov_b32 s58, 16384
  s_mov_b32 s68, 34816
  s_waitcnt vmcnt(0)
  s_barrier
  s_cmp_lg_u32 s29, 0
  s_cbranch_scc1 L_sg_19
  v_mov_b32 v21, 1
  s_mov_b64 exec, 1
  buffer_atomic_add v21, v20, s[4:7], s58 offen sc0
  s_waitcnt vmcnt(0)
  v_cmp_eq_u32 vcc, 127, v21
  v_mov_b32 v21, 1
  s_and_b64 exec, exec, vcc
  s_cbranch_execz L_sg_19x
  buffer_store_dword v21, v20, s[4:7], s68 offen sc1
L_sg_19x:
  s_mov_b64 exec, -1
L_sg_19:
  s_branch L_done
L_g1:
  s_lshr_b32 s31, s41, 20
  s_lshl_b32 s31, s31, 4
  s_add_u32 s31, s31, 4832
  s_load_dwordx4 s[24:27], s[100:101], s31
  s_load_dwordx4 s[32:35], s[0:1], 16
  s_load_dwordx2 s[36:37], s[0:1], 32
  s_load_dwordx2 s[38:39], s[0:1], 64
  v_lshrrev_b32 v21, 3, v1
  v_lshlrev_b32 v21, 10, v21
  v_and_b32 v22, 7, v1
  v_lshrrev_b32 v23, 4, v1
  v_xor_b32 v22, v22, v23
  v_lshl_add_u32 v28, v22, 4, v21
  v_xor_b32 v29, 64, v28
  s_lshl_b32 s54, s42, 18
  s_lshl_b32 s31, s29, 16
  s_add_u32 s54, s54, s31
  s_add_u32 s54, s54, 2097152
  s_lshl_b32 s52, s29, 15
  s_lshl_b32 s31, s59, 13
  s_sub_u32 s31, s52, s31
  v_add_u32 v11, s31, v5
  v_add_u32 v12, s31, v6
  v_add_u32 v13, s31, v7
  v_add_u32 v14, s31, v8
  v_lshrrev_b32 v21, 4, v1
  v_and_b32 v23, 15, v1
  v_lshlrev_b32 v22, 2, v21
  v_xor_b32 v23, v23, v22
  v_lshlrev_b32 v23, 4, v23
  v_lshl_add_u32 v2, v21, 13, v23
  v_mul_u32_u24 v22, 3584, v21
  v_add_u32 v3, v22, v23
  s_lshl_b32 s31, s60, 7
  v_xor_b32 v24, s31, v9
  v_add_u32 v24, 49152, v24
  v_xor_b32 v25, 64, v24
  v_xor_b32 v26, 128, v24
  v_xor_b32 v27, 192, v24
  s_waitcnt lgkmcnt(0)
  s_mov_b32 s20, s32
  s_mov_b32 s21, s33
  s_mov_b32 s12, s34
  s_mov_b32 s13, s35
  s_mov_b32 s14, s36
  s_mov_b32 s15, s37
  s_mov_b32 s22, s38
  s_mov_b32 s23, s39
  s_and_b32 s31, s24, 15
  s_bfe_u32 s32, s24, 0x8000c
  s_mov_b32 s16, s12
  s_mov_b32 s17, s13
  s_cmp_eq_u32 s31, 6
  s_cselect_b32 s16, s14, s16
  s_cselect_b32 s17, s15, s17
  s_cmp_eq_u32 s31, 1
  s_cselect_b32 s16, s20, s16
  s_cselect_b32 s17, s21, s17
  s_mov_b32 s18, 0x400000
  s_mov_b32 s45, 8192
  s_cmp_eq_u32 s31, 2
  s_cselect_b32 s16, s22, s16
  s_cselect_b32 s17, s23, s17
  s_cselect_b32 s18, 1835008, s18
  s_cselect_b32 s45, 3584, s45
  s_cselect_b64 vcc, -1, 0
  s_mov_b32 s19, 0x20000
  v_cndmask_b32 v4, v2, v3, vcc
  s_lshl_b32 s72, s45, 2
  s_lshl_b32 s33, s45, 4
  s_mul_i32 s33, s33, s29
  s_lshl_b32 s55, s32, 8
  s_add_u32 s55, s55, s33
  s_lshl_b32 s51, s29, 12
  s_add_u32 s51, s51, 65536
  s_mov_b32 s50, 65536
  s_mov_b32 s93, 0
  s_mov_b32 s87, 0
  s_add_u32 m0, s51, 65536
  s_mov_b32 s63, s55
  buffer_load_dwordx4 v4, s[16:19], s63 offen lds
  s_add_u32 m0, s51, 66560
  s_add_u32 s63, s63, s72
  buffer_load_dwordx4 v4, s[16:19], s63 offen lds
  s_add_u32 m0, s51, 67584
  s_add_u32 s63, s63, s72
  buffer_load_dwordx4 v4, s[16:19], s63 offen lds
  s_add_u32 m0, s51, 68608
  s_add_u32 s63, s63, s72
  buffer_load_dwordx4 v4, s[16:19], s63 offen lds
  s_lshl_b32 s31, s45, 6
  s_add_u32 s55, s55, s31
  s_add_u32 s51, s51, 16384
  s_cmp_ge_u32 s51, 98304
  s_cselect_b32 s31, 98304, 0
  s_sub_u32 s51, s51, s31
  s_add_u32 m0, s51, 65536
  s_mov_b32 s63, s55
  buffer_load_dwordx4 v4, s[16:19], s63 offen lds
  s_add_u32 m0, s51, 66560
  s_add_u32 s63, s63, s72
  buffer_load_dwordx4 v4, s[16:19], s63 offen lds
  s_add_u32 m0, s51, 67584
  s_add_u32 s63, s63, s72
  buffer_load_dwordx4 v4, s[16:19], s63 offen lds
  s_add_u32 m0, s51, 68608
  s_add_u32 s63, s63, s72
  buffer_load_dwordx4 v4, s[16:19], s63 offen lds
  s_lshl_b32 s31, s45, 6
  s_add_u32 s55, s55, s31
  s_add_u32 s51, s51, 16384
  s_cmp_ge_u32 s51, 98304
  s_cselect_b32 s31, 98304, 0
  s_sub_u32 s51, s51, s31
  s_cmp_eq_u32 s75, 1
  s_cbranch_scc1 L_lw_20
  s_lshl_b32 s58, s42, 2
  s_add_u32 s58, s58, 132
  s_cmp_lg_u32 s29, 0
  s_cbranch_scc1 L_wfx_22
  s_mov_b32 s32, 0
  s_mov_b64 exec, 1
L_wf_21:
  buffer_load_dword v21, v20, s[8:11], s58 offen sc1
  s_add_u32 s32, s32, 1
  s_waitcnt vmcnt(0)
  v_readfirstlane_b32 s31, v21
  s_cmp_gt_u32 s32, 0x40000
  s_cbranch_scc1 L_wfx_22
  s_cmp_ge_u32 s31, 1
  s_cbranch_scc1 L_wfx_22
  s_sleep 2
  s_branch L_wf_21
L_wfx_22:
  s_mov_b64 exec, -1
  s_barrier
L_lw_20:
  s_add_u32 m0, s52, 0
  s_add_u32 s62, s54, 0
  buffer_load_dwordx4 v28, s[4:7], s62 offen sc1 lds
  s_add_u32 m0, s52, 1024
  s_add_u32 s62, s54, 8192
  buffer_load_dwordx4 v29, s[4:7], s62 offen sc1 lds
  s_add_u32 m0, s52, 2048
  s_add_u32 s62, s54, 16384
  buffer_load_dwordx4 v28, s[4:7], s62 offen sc1 lds
  s_add_u32 m0, s52, 3072
  s_add_u32 s62, s54, 24576
  buffer_load_dwordx4 v29, s[4:7], s62 offen sc1 lds
  s_add_u32 m0, s52, 4096
  s_add_u32 s62, s54, 32768
  buffer_load_dwordx4 v28, s[4:7], s62 offen sc1 lds
  s_add_u32 m0, s52, 5120
  s_add_u32 s62, s54, 40960
  buffer_load_dwordx4 v29, s[4:7], s62 offen sc1 lds
  s_add_u32 m0, s52, 6144
  s_add_u32 s62, s54, 49152
  buffer_load_dwordx4 v28, s[4:7], s62 offen sc1 lds
  s_add_u32 m0, s52, 7168
  s_add_u32 s62, s54, 57344
  buffer_load_dwordx4 v29, s[4:7], s62 offen sc1 lds
  s_add_u32 m0, s52, 8192
  s_add_u32 s62, s54, 128
  buffer_load_dwordx4 v28, s[4:7], s62 offen sc1 lds
  s_add_u32 m0, s52, 9216
  s_add_u32 s62, s54, 8320
  buffer_load_dwordx4 v29, s[4:7], s62 offen sc1 lds
  s_add_u32 m0, s52, 10240
  s_add_u32 s62, s54, 16512
  buffer_load_dwordx4 v28, s[4:7], s62 offen sc1 lds
  s_add_u32 m0, s52, 11264
  s_add_u32 s62, s54, 24704
  buffer_load_dwordx4 v29, s[4:7], s62 offen sc1 lds
  s_add_u32 m0, s52, 12288
  s_add_u32 s62, s54, 32896
  buffer_load_dwordx4 v28, s[4:7], s62 offen sc1 lds
  s_add_u32 m0, s52, 13312
  s_add_u32 s62, s54, 41088
  buffer_load_dwordx4 v29, s[4:7], s62 offen sc1 lds
  s_add_u32 m0, s52, 14336
  s_add_u32 s62, s54, 49280
  buffer_load_dwordx4 v28, s[4:7], s62 offen sc1 lds
  s_add_u32 m0, s52, 15360
  s_add_u32 s62, s54, 57472
  buffer_load_dwordx4 v29, s[4:7], s62 offen sc1 lds
  s_add_u32 m0, s52, 16384
  s_add_u32 s62, s54, 256
  buffer_load_dwordx4 v28, s[4:7], s62 offen sc1 lds
  s_add_u32 m0, s52, 17408
  s_add_u32 s62, s54, 8448
  buffer_load_dwordx4 v29, s[4:7], s62 offen sc1 lds
  s_add_u32 m0, s52, 18432
  s_add_u32 s62, s54, 16640
  buffer_load_dwordx4 v28, s[4:7], s62 offen sc1 lds
  s_add_u32 m0, s52, 19456
  s_add_u32 s62, s54, 24832
  buffer_load_dwordx4 v29, s[4:7], s62 offen sc1 lds
  s_add_u32 m0, s52, 20480
  s_add_u32 s62, s54, 33024
  buffer_load_dwordx4 v28, s[4:7], s62 offen sc1 lds
  s_add_u32 m0, s52, 21504
  s_add_u32 s62, s54, 41216
  buffer_load_dwordx4 v29, s[4:7], s62 offen sc1 lds
  s_add_u32 m0, s52, 22528
  s_add_u32 s62, s54, 49408
  buffer_load_dwordx4 v28, s[4:7], s62 offen sc1 lds
  s_add_u32 m0, s52, 23552
  s_add_u32 s62, s54, 57600
  buffer_load_dwordx4 v29, s[4:7], s62 offen sc1 lds
  s_add_u32 m0, s52, 24576
  s_add_u32 s62, s54, 384
  buffer_load_dwordx4 v28, s[4:7], s62 offen sc1 lds
  s_add_u32 m0, s52, 25600
  s_add_u32 s62, s54, 8576
  buffer_load_dwordx4 v29, s[4:7], s62 offen sc1 lds
  s_add_u32 m0, s52, 26624
  s_add_u32 s62, s54, 16768
  buffer_load_dwordx4 v28, s[4:7], s62 offen sc1 lds
  s_add_u32 m0, s52, 27648
  s_add_u32 s62, s54, 24960
  buffer_load_dwordx4 v29, s[4:7], s62 offen sc1 lds
  s_add_u32 m0, s52, 28672
  s_add_u32 s62, s54, 33152
  buffer_load_dwordx4 v28, s[4:7], s62 offen sc1 lds
  s_add_u32 m0, s52, 29696
  s_add_u32 s62, s54, 41344
  buffer_load_dwordx4 v29, s[4:7], s62 offen sc1 lds
  s_add_u32 m0, s52, 30720
  s_add_u32 s62, s54, 49536
  buffer_load_dwordx4 v28, s[4:7], s62 offen sc1 lds
  s_add_u32 m0, s52, 31744
  s_add_u32 s62, s54, 57728
  buffer_load_dwordx4 v29, s[4:7], s62 offen sc1 lds
  s_waitcnt vmcnt(24)
  ds_read_b128 a[0:3], v11 offset:0
  ds_read_b128 a[128:131], v11 offset:4096
  ds_read_b128 a[4:7], v12 offset:0
  ds_read_b128 a[132:135], v12 offset:4096
  ds_read_b128 a[8:11], v13 offset:0
  ds_read_b128 a[136:139], v13 offset:4096
  ds_read_b128 a[12:15], v14 offset:0
  ds_read_b128 a[140:143], v14 offset:4096
  s_waitcnt lgkmcnt(0)
  s_add_u32 m0, s52, 0
  s_add_u32 s62, s54, 512
  buffer_load_dwordx4 v28, s[4:7], s62 offen sc1 lds
  s_add_u32 m0, s52, 1024
  s_add_u32 s62, s54, 8704
  buffer_load_dwordx4 v29, s[4:7], s62 offen sc1 lds
  s_add_u32 m0, s52, 2048
  s_add_u32 s62, s54, 16896
  buffer_load_dwordx4 v28, s[4:7], s62 offen sc1 lds
  s_add_u32 m0, s52, 3072
  s_add_u32 s62, s54, 25088
  buffer_load_dwordx4 v29, s[4:7], s62 offen sc1 lds
  s_add_u32 m0, s52, 4096
  s_add_u32 s62, s54, 33280
  buffer_load_dwordx4 v28, s[4:7], s62 offen sc1 lds
  s_add_u32 m0, s52, 5120
  s_add_u32 s62, s54, 41472
  buffer_load_dwordx4 v29, s[4:7], s62 offen sc1 lds
  s_add_u32 m0, s52, 6144
  s_add_u32 s62, s54, 49664
  buffer_load_dwordx4 v28, s[4:7], s62 offen sc1 lds
  s_add_u32 m0, s52, 7168
  s_add_u32 s62, s54, 57856
  buffer_load_dwordx4 v29, s[4:7], s62 offen sc1 lds
  s_waitcnt vmcnt(24)
  ds_read_b128 a[16:19], v11 offset:8192
  ds_read_b128 a[144:147], v11 offset:12288
  ds_read_b128 a[20:23], v12 offset:8192
  ds_read_b128 a[148:151], v12 offset:12288
  ds_read_b128 a[24:27], v13 offset:8192
  ds_read_b128 a[152:155], v13 offset:12288
  ds_read_b128 a[28:31], v14 offset:8192
  ds_read_b128 a[156:159], v14 offset:12288
  s_waitcnt lgkmcnt(0)
  s_add_u32 m0, s52, 8192
  s_add_u32 s62, s54, 640
  buffer_load_dwordx4 v28, s[4:7], s62 offen sc1 lds
  s_add_u32 m0, s52, 9216
  s_add_u32 s62, s54, 8832
  buffer_load_dwordx4 v29, s[4:7], s62 offen sc1 lds
  s_add_u32 m0, s52, 10240
  s_add_u32 s62, s54, 17024
  buffer_load_dwordx4 v28, s[4:7], s62 offen sc1 lds
  s_add_u32 m0, s52, 11264
  s_add_u32 s62, s54, 25216
  buffer_load_dwordx4 v29, s[4:7], s62 offen sc1 lds
  s_add_u32 m0, s52, 12288
  s_add_u32 s62, s54, 33408
  buffer_load_dwordx4 v28, s[4:7], s62 offen sc1 lds
  s_add_u32 m0, s52, 13312
  s_add_u32 s62, s54, 41600
  buffer_load_dwordx4 v29, s[4:7], s62 offen sc1 lds
  s_add_u32 m0, s52, 14336
  s_add_u32 s62, s54, 49792
  buffer_load_dwordx4 v28, s[4:7], s62 offen sc1 lds
  s_add_u32 m0, s52, 15360
  s_add_u32 s62, s54, 57984
  buffer_load_dwordx4 v29, s[4:7], s62 offen sc1 lds
  s_waitcnt vmcnt(24)
  ds_read_b128 a[32:35], v11 offset:16384
  ds_read_b128 a[160:163], v11 offset:20480
  ds_read_b128 a[36:39], v12 offset:16384
  ds_read_b128 a[164:167], v12 offset:20480
  ds_read_b128 a[40:43], v13 offset:16384
  ds_read_b128 a[168:171], v13 offset:20480
  ds_read_b128 a[44:47], v14 offset:16384
  ds_read_b128 a[172:175], v14 offset:20480
  s_waitcnt lgkmcnt(0)
  s_add_u32 m0, s52, 16384
  s_add_u32 s62, s54, 768
  buffer_load_dwordx4 v28, s[4:7], s62 offen sc1 lds
  s_add_u32 m0, s52, 17408
  s_add_u32 s62, s54, 8960
  buffer_load_dwordx4 v29, s[4:7], s62 offen sc1 lds
  s_add_u32 m0, s52, 18432
  s_add_u32 s62, s54, 17152
  buffer_load_dwordx4 v28, s[4:7], s62 offen sc1 lds
  s_add_u32 m0, s52, 19456
  s_add_u32 s62, s54, 25344
  buffer_load_dwordx4 v29, s[4:7], s62 offen sc1 lds
  s_add_u32 m0, s52, 20480
  s_add_u32 s62, s54, 33536
  buffer_load_dwordx4 v28, s[4:7], s62 offen sc1 lds
  s_add_u32 m0, s52, 21504
  s_add_u32 s62, s54, 41728
  buffer_load_dwordx4 v29, s[4:7], s62 offen sc1 lds
  s_add_u32 m0, s52, 22528
  s_add_u32 s62, s54, 49920
  buffer_load_dwordx4 v28, s[4:7], s62 offen sc1 lds
  s_add_u32 m0, s52, 23552
  s_add_u32 s62, s54, 58112
  buffer_load_dwordx4 v29, s[4:7], s62 offen sc1 lds
  s_waitcnt vmcnt(24)
  ds_read_b128 a[48:51], v11 offset:24576
  ds_read_b128 a[176:179], v11 offset:28672
  ds_read_b128 a[52:55], v12 offset:24576
  ds_read_b128 a[180:183], v12 offset:28672
  ds_read_b128 a[56:59], v13 offset:24576
  ds_read_b128 a[184:187], v13 offset:28672
  ds_read_b128 a[60:63], v14 offset:24576
  ds_read_b128 a[188:191], v14 offset:28672
  s_waitcnt lgkmcnt(0)
  s_add_u32 m0, s52, 24576
  s_add_u32 s62, s54, 896
  buffer_load_dwordx4 v28, s[4:7], s62 offen sc1 lds
  s_add_u32 m0, s52, 25600
  s_add_u32 s62, s54, 9088
  buffer_load_dwordx4 v29, s[4:7], s62 offen sc1 lds
  s_add_u32 m0, s52, 26624
  s_add_u32 s62, s54, 17280
  buffer_load_dwordx4 v28, s[4:7], s62 offen sc1 lds
  s_add_u32 m0, s52, 27648
  s_add_u32 s62, s54, 25472
  buffer_load_dwordx4 v29, s[4:7], s62 offen sc1 lds
  s_add_u32 m0, s52, 28672
  s_add_u32 s62, s54, 33664
  buffer_load_dwordx4 v28, s[4:7], s62 offen sc1 lds
  s_add_u32 m0, s52, 29696
  s_add_u32 s62, s54, 41856
  buffer_load_dwordx4 v29, s[4:7], s62 offen sc1 lds
  s_add_u32 m0, s52, 30720
  s_add_u32 s62, s54, 50048
  buffer_load_dwordx4 v28, s[4:7], s62 offen sc1 lds
  s_add_u32 m0, s52, 31744
  s_add_u32 s62, s54, 58240
  buffer_load_dwordx4 v29, s[4:7], s62 offen sc1 lds
  s_waitcnt vmcnt(24)
  ds_read_b128 a[64:67], v11 offset:0
  ds_read_b128 a[192:195], v11 offset:4096
  ds_read_b128 a[68:71], v12 offset:0
  ds_read_b128 a[196:199], v12 offset:4096
  ds_read_b128 a[72:75], v13 offset:0
  ds_read_b128 a[200:203], v13 offset:4096
  ds_read_b128 a[76:79], v14 offset:0
  ds_read_b128 a[204:207], v14 offset:4096
  s_waitcnt vmcnt(16)
  ds_read_b128 a[80:83], v11 offset:8192
  ds_read_b128 a[208:211], v11 offset:12288
  ds_read_b128 a[84:87], v12 offset:8192
  ds_read_b128 a[212:215], v12 offset:12288
  ds_read_b128 a[88:91], v13 offset:8192
  ds_read_b128 a[216:219], v13 offset:12288
  ds_read_b128 a[92:95], v14 offset:8192
  ds_read_b128 a[220:223], v14 offset:12288
  s_waitcnt vmcnt(8)
  ds_read_b128 a[96:99], v11 offset:16384
  ds_read_b128 a[224:227], v11 offset:20480
  ds_read_b128 a[100:103], v12 offset:16384
  ds_read_b128 a[228:231], v12 offset:20480
  ds_read_b128 a[104:107], v13 offset:16384
  ds_read_b128 a[232:235], v13 offset:20480
  ds_read_b128 a[108:111], v14 offset:16384
  ds_read_b128 a[236:239], v14 offset:20480
  s_waitcnt vmcnt(0)
  ds_read_b128 a[112:115], v11 offset:24576
  ds_read_b128 a[240:243], v11 offset:28672
  ds_read_b128 a[116:119], v12 offset:24576
  ds_read_b128 a[244:247], v12 offset:28672
  ds_read_b128 a[120:123], v13 offset:24576
  ds_read_b128 a[248:251], v13 offset:28672
  ds_read_b128 a[124:127], v14 offset:24576
  ds_read_b128 a[252:255], v14 offset:28672
  s_waitcnt lgkmcnt(0)
  s_barrier
  s_cmp_eq_u32 s75, 1
  s_cbranch_scc1 L_iw_23
  s_mov_b32 s58, 128
  s_cmp_lg_u32 s29, 0
  s_cbranch_scc1 L_wfx_25
  s_mov_b32 s32, 0
  s_mov_b64 exec, 1
L_wf_24:
  buffer_load_dword v21, v20, s[8:11], s58 offen sc1
  s_add_u32 s32, s32, 1
  s_waitcnt vmcnt(0)
  v_readfirstlane_b32 s31, v21
  s_cmp_gt_u32 s32, 0x40000
  s_cbranch_scc1 L_wfx_25
  s_cmp_ge_u32 s31, 1
  s_cbranch_scc1 L_wfx_25
  s_sleep 2
  s_branch L_wf_24
L_wfx_25:
  s_mov_b64 exec, -1
  s_barrier
  s_mov_b32 s75, 1
L_iw_23:
  s_add_u32 m0, s51, 65536
  s_mov_b32 s63, s55
  buffer_load_dwordx4 v4, s[16:19], s63 offen lds
  s_add_u32 m0, s51, 66560
  s_add_u32 s63, s63, s72
  buffer_load_dwordx4 v4, s[16:19], s63 offen lds
  s_add_u32 m0, s51, 67584
  s_add_u32 s63, s63, s72
  buffer_load_dwordx4 v4, s[16:19], s63 offen lds
  s_add_u32 m0, s51, 68608
  s_add_u32 s63, s63, s72
  buffer_load_dwordx4 v4, s[16:19], s63 offen lds
  s_lshl_b32 s31, s45, 6
  s_add_u32 s55, s55, s31
  s_add_u32 s51, s51, 16384
  s_cmp_ge_u32 s51, 98304
  s_cselect_b32 s31, 98304, 0
  s_sub_u32 s51, s51, s31
  s_add_u32 m0, s51, 65536
  s_mov_b32 s63, s55
  buffer_load_dwordx4 v4, s[16:19], s63 offen lds
  s_add_u32 m0, s51, 66560
  s_add_u32 s63, s63, s72
  buffer_load_dwordx4 v4, s[16:19], s63 offen lds
  s_add_u32 m0, s51, 67584
  s_add_u32 s63, s63, s72
  buffer_load_dwordx4 v4, s[16:19], s63 offen lds
  s_add_u32 m0, s51, 68608
  s_add_u32 s63, s63, s72
  buffer_load_dwordx4 v4, s[16:19], s63 offen lds
  s_lshl_b32 s31, s45, 6
  s_add_u32 s55, s55, s31
  s_add_u32 s51, s51, 16384
  s_cmp_ge_u32 s51, 98304
  s_cselect_b32 s31, 98304, 0
  s_sub_u32 s51, s51, s31
  s_add_u32 m0, s51, 65536
  s_mov_b32 s63, s55
  buffer_load_dwordx4 v4, s[16:19], s63 offen lds
  s_add_u32 m0, s51, 66560
  s_add_u32 s63, s63, s72
  buffer_load_dwordx4 v4, s[16:19], s63 offen lds
  s_add_u32 m0, s51, 67584
  s_add_u32 s63, s63, s72
  buffer_load_dwordx4 v4, s[16:19], s63 offen lds
  s_add_u32 m0, s51, 68608
  s_add_u32 s63, s63, s72
  buffer_load_dwordx4 v4, s[16:19], s63 offen lds
  s_lshl_b32 s31, s45, 6
  s_add_u32 s55, s55, s31
  s_add_u32 s51, s51, 16384
  s_cmp_ge_u32 s51, 98304
  s_cselect_b32 s31, 98304, 0
  s_sub_u32 s51, s51, s31
L_g1t:
  s_mov_b32 s41, s24
  s_mov_b32 s43, s25
  s_mov_b32 s24, s25
  s_mov_b32 s25, s26
  s_mov_b32 s26, s27
  s_mov_b32 s27, 10
  s_and_b32 s49, s41, 15
  s_cmp_eq_u32 s49, 6
  s_cbranch_scc1 L_g1v
  s_cmp_lg_u32 s93, 0
  s_cbranch_scc1 L_g1w_26
  s_waitcnt vmcnt(16)
L_g1w_26:
  s_waitcnt vmcnt(32)
  s_barrier
  v_add_u32 v11, s50, v24
  v_add_u32 v12, s50, v25
  v_add_u32 v13, s50, v26
  v_add_u32 v14, s50, v27
  ds_read_b64_tr_b16 v[32:33], v11 offset:0
  ds_read_b64_tr_b16 v[34:35], v11 offset:1024
  ds_read_b64_tr_b16 v[36:37], v12 offset:0
  ds_read_b64_tr_b16 v[38:39], v12 offset:1024
  ds_read_b64_tr_b16 v[40:41], v13 offset:0
  ds_read_b64_tr_b16 v[42:43], v13 offset:1024
  ds_read_b64_tr_b16 v[44:45], v14 offset:0
  ds_read_b64_tr_b16 v[46:47], v14 offset:1024
  s_add_u32 s50, s50, 16384
  s_cmp_ge_u32 s50, 98304
  s_cselect_b32 s31, 98304, 0
  s_sub_u32 s50, s50, s31
  ds_read_b64_tr_b16 v[48:49], v11 offset:4096
  ds_read_b64_tr_b16 v[50:51], v11 offset:5120
  ds_read_b64_tr_b16 v[52:53], v12 offset:4096
  ds_read_b64_tr_b16 v[54:55], v12 offset:5120
  ds_read_b64_tr_b16 v[56:57], v13 offset:4096
  ds_read_b64_tr_b16 v[58:59], v13 offset:5120
  ds_read_b64_tr_b16 v[60:61], v14 offset:4096
  ds_read_b64_tr_b16 v[62:63], v14 offset:5120
  s_waitcnt lgkmcnt(8)
  v_mfma_f32_32x32x16_bf16 v[128:143], v[32:35], a[0:3], 0
  v_mfma_f32_32x32x16_bf16 v[192:207], v[32:35], a[128:131], 0
  v_mfma_f32_32x32x16_bf16 v[144:159], v[36:39], a[0:3], 0
  v_mfma_f32_32x32x16_bf16 v[208:223], v[36:39], a[128:131], 0
  s_add_u32 m0, s51, 65536
  s_mov_b32 s63, s55
  buffer_load_dwordx4 v4, s[16:19], s63 offen lds
  v_mfma_f32_32x32x16_bf16 v[160:175], v[40:43], a[0:3], 0
  v_mfma_f32_32x32x16_bf16 v[224:239], v[40:43], a[128:131], 0
  v_mfma_f32_32x32x16_bf16 v[176:191], v[44:47], a[0:3], 0
  v_mfma_f32_32x32x16_bf16 v[240:255], v[44:47], a[128:131], 0
  ds_read_b64_tr_b16 v[32:33], v11 offset:8192
  ds_read_b64_tr_b16 v[34:35], v11 offset:9216
  ds_read_b64_tr_b16 v[36:37], v12 offset:8192
  ds_read_b64_tr_b16 v[38:39], v12 offset:9216
  ds_read_b64_tr_b16 v[40:41], v13 offset:8192
  ds_read_b64_tr_b16 v[42:43], v13 offset:9216
  ds_read_b64_tr_b16 v[44:45], v14 offset:8192
  ds_read_b64_tr_b16 v[46:47], v14 offset:9216
  s_waitcnt lgkmcnt(8)
  v_mfma_f32_32x32x16_bf16 v[128:143], v[48:51], a[4:7], v[128:143]
  v_mfma_f32_32x32x16_bf16 v[192:207], v[48:51], a[132:135], v[192:207]
  v_mfma_f32_32x32x16_bf16 v[144:159], v[52:55], a[4:7], v[144:159]
  v_mfma_f32_32x32x16_bf16 v[208:223], v[52:55], a[132:135], v[208:223]
  s_add_u32 m0, s51, 66560
  s_add_u32 s63, s63, s72
  buffer_load_dwordx4 v4, s[16:19], s63 offen lds
  v_mfma_f32_32x32x16_bf16 v[160:175], v[56:59], a[4:7], v[160:175]
  v_mfma_f32_32x32x16_bf16 v[224:239], v[56:59], a[132:135], v[224:239]
  v_mfma_f32_32x32x16_bf16 v[176:191], v[60:63], a[4:7], v[176:191]
  v_mfma_f32_32x32x16_bf16 v[240:255], v[60:63], a[132:135], v[240:255]
  ds_read_b64_tr_b16 v[48:49], v11 offset:12288
  ds_read_b64_tr_b16 v[50:51], v11 offset:13312
  ds_read_b64_tr_b16 v[52:53], v12 offset:12288
  ds_read_b64_tr_b16 v[54:55], v12 offset:13312
  ds_read_b64_tr_b16 v[56:57], v13 offset:12288
  ds_read_b64_tr_b16 v[58:59], v13 offset:13312
  ds_read_b64_tr_b16 v[60:61], v14 offset:12288
  ds_read_b64_tr_b16 v[62:63], v14 offset:13312
  s_waitcnt lgkmcnt(8)
  v_mfma_f32_32x32x16_bf16 v[128:143], v[32:35], a[8:11], v[128:143]
  v_mfma_f32_32x32x16_bf16 v[192:207], v[32:35], a[136:139], v[192:207]
  v_mfma_f32_32x32x16_bf16 v[144:159], v[36:39], a[8:11], v[144:159]
  v_mfma_f32_32x32x16_bf16 v[208:223], v[36:39], a[136:139], v[208:223]
  s_add_u32 m0, s51, 67584
  s_add_u32 s63, s63, s72
  buffer_load_dwordx4 v4, s[16:19], s63 offen lds
  v_mfma_f32_32x32x16_bf16 v[160:175], v[40:43], a[8:11], v[160:175]
  v_mfma_f32_32x32x16_bf16 v[224:239], v[40:43], a[136:139], v[224:239]
  v_mfma_f32_32x32x16_bf16 v[176:191], v[44:47], a[8:11], v[176:191]
  v_mfma_f32_32x32x16_bf16 v[240:255], v[44:47], a[136:139], v[240:255]
  s_waitcnt lgkmcnt(0)
  v_mfma_f32_32x32x16_bf16 v[128:143], v[48:51], a[12:15], v[128:143]
  v_mfma_f32_32x32x16_bf16 v[192:207], v[48:51], a[140:143], v[192:207]
  v_mfma_f32_32x32x16_bf16 v[144:159], v[52:55], a[12:15], v[144:159]
  v_mfma_f32_32x32x16_bf16 v[208:223], v[52:55], a[140:143], v[208:223]
  s_add_u32 m0, s51, 68608
  s_add_u32 s63, s63, s72
  buffer_load_dwordx4 v4, s[16:19], s63 offen lds
  s_lshl_b32 s31, s45, 6
  s_add_u32 s55, s55, s31
  s_add_u32 s51, s51, 16384
  s_cmp_ge_u32 s51, 98304
  s_cselect_b32 s31, 98304, 0
  s_sub_u32 s51, s51, s31
  v_mfma_f32_32x32x16_bf16 v[160:175], v[56:59], a[12:15], v[160:175]
  v_mfma_f32_32x32x16_bf16 v[224:239], v[56:59], a[140:143], v[224:239]
  v_mfma_f32_32x32x16_bf16 v[176:191], v[60:63], a[12:15], v[176:191]
  v_mfma_f32_32x32x16_bf16 v[240:255], v[60:63], a[140:143], v[240:255]
  s_cmp_lg_u32 s93, 0
  s_cbranch_scc1 L_g1w_27
  s_waitcnt vmcnt(16)
L_g1w_27:
  s_waitcnt vmcnt(32)
  s_barrier
  v_add_u32 v11, s50, v24
  v_add_u32 v12, s50, v25
  v_add_u32 v13, s50, v26
  v_add_u32 v14, s50, v27
  ds_read_b64_tr_b16 v[32:33], v11 offset:0
  ds_read_b64_tr_b16 v[34:35], v11 offset:1024
  ds_read_b64_tr_b16 v[36:37], v12 offset:0
  ds_read_b64_tr_b16 v[38:39], v12 offset:1024
  ds_read_b64_tr_b16 v[40:41], v13 offset:0
  ds_read_b64_tr_b16 v[42:43], v13 offset:1024
  ds_read_b64_tr_b16 v[44:45], v14 offset:0
  ds_read_b64_tr_b16 v[46:47], v14 offset:1024
  s_add_u32 s50, s50, 16384
  s_cmp_ge_u32 s50, 98304
  s_cselect_b32 s31, 98304, 0
  s_sub_u32 s50, s50, s31
  ds_read_b64_tr_b16 v[48:49], v11 offset:4096
  ds_read_b64_tr_b16 v[50:51], v11 offset:5120
  ds_read_b64_tr_b16 v[52:53], v12 offset:4096
  ds_read_b64_tr_b16 v[54:55], v12 offset:5120
  ds_read_b64_tr_b16 v[56:57], v13 offset:4096
  ds_read_b64_tr_b16 v[58:59], v13 offset:5120
  ds_read_b64_tr_b16 v[60:61], v14 offset:4096
  ds_read_b64_tr_b16 v[62:63], v14 offset:5120
  s_waitcnt lgkmcnt(8)
  v_mfma_f32_32x32x16_bf16 v[128:143], v[32:35], a[16:19], v[128:143]
  v_mfma_f32_32x32x16_bf16 v[192:207], v[32:35], a[144:147], v[192:207]
  v_mfma_f32_32x32x16_bf16 v[144:159], v[36:39], a[16:19], v[144:159]
  v_mfma_f32_32x32x16_bf16 v[208:223], v[36:39], a[144:147], v[208:223]
  s_add_u32 m0, s51, 65536
  s_mov_b32 s63, s55
  buffer_load_dwordx4 v4, s[16:19], s63 offen lds
  v_mfma_f32_32x32x16_bf16 v[160:175], v[40:43], a[16:19], v[160:175]
  v_mfma_f32_32x32x16_bf16 v[224:239], v[40:43], a[144:147], v[224:239]
  v_mfma_f32_32x32x16_bf16 v[176:191], v[44:47], a[16:19], v[176:191]
  v_mfma_f32_32x32x16_bf16 v[240:255], v[44:47], a[144:147], v[240:255]
  ds_read_b64_tr_b16 v[32:33], v11 offset:8192
  ds_read_b64_tr_b16 v[34:35], v11 offset:9216
  ds_read_b64_tr_b16 v[36:37], v12 offset:8192
  ds_read_b64_tr_b16 v[38:39], v12 offset:9216
  ds_read_b64_tr_b16 v[40:41], v13 offset:8192
  ds_read_b64_tr_b16 v[42:43], v13 offset:9216
  ds_read_b64_tr_b16 v[44:45], v14 offset:8192
  ds_read_b64_tr_b16 v[46:47], v14 offset:9216
  s_waitcnt lgkmcnt(8)
  v_mfma_f32_32x32x16_bf16 v[128:143], v[48:51], a[20:23], v[128:143]
  v_mfma_f32_32x32x16_bf16 v[192:207], v[48:51], a[148:151], v[192:207]
  v_mfma_f32_32x32x16_bf16 v[144:159], v[52:55], a[20:23], v[144:159]
  v_mfma_f32_32x32x16_bf16 v[208:223], v[52:55], a[148:151], v[208:223]
  s_add_u32 m0, s51, 66560
  s_add_u32 s63, s63, s72
  buffer_load_dwordx4 v4, s[16:19], s63 offen lds
  v_mfma_f32_32x32x16_bf16 v[160:175], v[56:59], a[20:23], v[160:175]
  v_mfma_f32_32x32x16_bf16 v[224:239], v[56:59], a[148:151], v[224:239]
  v_mfma_f32_32x32x16_bf16 v[176:191], v[60:63], a[20:23], v[176:191]
  v_mfma_f32_32x32x16_bf16 v[240:255], v[60:63], a[148:151], v[240:255]
  ds_read_b64_tr_b16 v[48:49], v11 offset:12288
  ds_read_b64_tr_b16 v[50:51], v11 offset:13312
  ds_read_b64_tr_b16 v[52:53], v12 offset:12288
  ds_read_b64_tr_b16 v[54:55], v12 offset:13312
  ds_read_b64_tr_b16 v[56:57], v13 offset:12288
  ds_read_b64_tr_b16 v[58:59], v13 offset:13312
  ds_read_b64_tr_b16 v[60:61], v14 offset:12288
  ds_read_b64_tr_b16 v[62:63], v14 offset:13312
  s_waitcnt lgkmcnt(8)
  v_mfma_f32_32x32x16_bf16 v[128:143], v[32:35], a[24:27], v[128:143]
  v_mfma_f32_32x32x16_bf16 v[192:207], v[32:35], a[152:155], v[192:207]
  v_mfma_f32_32x32x16_bf16 v[144:159], v[36:39], a[24:27], v[144:159]
  v_mfma_f32_32x32x16_bf16 v[208:223], v[36:39], a[152:155], v[208:223]
  s_add_u32 m0, s51, 67584
  s_add_u32 s63, s63, s72
  buffer_load_dwordx4 v4, s[16:19], s63 offen lds
  v_mfma_f32_32x32x16_bf16 v[160:175], v[40:43], a[24:27], v[160:175]
  v_mfma_f32_32x32x16_bf16 v[224:239], v[40:43], a[152:155], v[224:239]
  v_mfma_f32_32x32x16_bf16 v[176:191], v[44:47], a[24:27], v[176:191]
  v_mfma_f32_32x32x16_bf16 v[240:255], v[44:47], a[152:155], v[240:255]
  s_waitcnt lgkmcnt(0)
  v_mfma_f32_32x32x16_bf16 v[128:143], v[48:51], a[28:31], v[128:143]
  v_mfma_f32_32x32x16_bf16 v[192:207], v[48:51], a[156:159], v[192:207]
  v_mfma_f32_32x32x16_bf16 v[144:159], v[52:55], a[28:31], v[144:159]
  v_mfma_f32_32x32x16_bf16 v[208:223], v[52:55], a[156:159], v[208:223]
  s_add_u32 m0, s51, 68608
  s_add_u32 s63, s63, s72
  buffer_load_dwordx4 v4, s[16:19], s63 offen lds
  s_lshl_b32 s31, s45, 6
  s_add_u32 s55, s55, s31
  s_add_u32 s51, s51, 16384
  s_cmp_ge_u32 s51, 98304
  s_cselect_b32 s31, 98304, 0
  s_sub_u32 s51, s51, s31
  v_mfma_f32_32x32x16_bf16 v[160:175], v[56:59], a[28:31], v[160:175]
  v_mfma_f32_32x32x16_bf16 v[224:239], v[56:59], a[156:159], v[224:239]
  v_mfma_f32_32x32x16_bf16 v[176:191], v[60:63], a[28:31], v[176:191]
  v_mfma_f32_32x32x16_bf16 v[240:255], v[60:63], a[156:159], v[240:255]
  s_cmp_eq_u32 s93, 0
  s_cbranch_scc1 L_g1w_28
  s_waitcnt vmcnt(8)
L_g1w_28:
  s_waitcnt vmcnt(16)
  s_barrier
  v_add_u32 v11, s50, v24
  v_add_u32 v12, s50, v25
  v_add_u32 v13, s50, v26
  v_add_u32 v14, s50, v27
  ds_read_b64_tr_b16 v[32:33], v11 offset:0
  ds_read_b64_tr_b16 v[34:35], v11 offset:1024
  ds_read_b64_tr_b16 v[36:37], v12 offset:0
  ds_read_b64_tr_b16 v[38:39], v12 offset:1024
  ds_read_b64_tr_b16 v[40:41], v13 offset:0
  ds_read_b64_tr_b16 v[42:43], v13 offset:1024
  ds_read_b64_tr_b16 v[44:45], v14 offset:0
  ds_read_b64_tr_b16 v[46:47], v14 offset:1024
  s_cmp_eq_u32 s93, 0
  s_cbranch_scc1 L_ps_29
  s_mov_b32 s31, s93
  s_mov_b32 s87, s68
  s_mov_b32 s83, s86
  s_mov_b32 s93, 0
  s_cmp_lg_u32 s29, 0
  s_cbranch_scc1 L_ps_29
  v_mov_b32 v17, 1
  v_mul_lo_u32 v22, v1, s90
  v_add_u32 v22, s88, v22
  v_writelane_b32 v22, s85, 0
  s_mov_b32 exec_lo, s31
  s_mov_b32 exec_hi, 0
  buffer_atomic_add v17, v22, s[4:7], 0 offen sc0
  s_mov_b64 exec, -1
L_ps_29:
  s_add_u32 s50, s50, 16384
  s_cmp_ge_u32 s50, 98304
  s_cselect_b32 s31, 98304, 0
  s_sub_u32 s50, s50, s31
  ds_read_b64_tr_b16 v[48:49], v11 offset:4096
  ds_read_b64_tr_b16 v[50:51], v11 offset:5120
  ds_read_b64_tr_b16 v[52:53], v12 offset:4096
  ds_read_b64_tr_b16 v[54:55], v12 offset:5120
  ds_read_b64_tr_b16 v[56:57], v13 offset:4096
  ds_read_b64_tr_b16 v[58:59], v13 offset:5120
  ds_read_b64_tr_b16 v[60:61], v14 offset:4096
  ds_read_b64_tr_b16 v[62:63], v14 offset:5120
  s_waitcnt lgkmcnt(8)
  v_mfma_f32_32x32x16_bf16 v[128:143], v[32:35], a[32:35], v[128:143]
  v_mfma_f32_32x32x16_bf16 v[192:207], v[32:35], a[160:163], v[192:207]
  v_mfma_f32_32x32x16_bf16 v[144:159], v[36:39], a[32:35], v[144:159]
  v_mfma_f32_32x32x16_bf16 v[208:223], v[36:39], a[160:163], v[208:223]
  s_add_u32 m0, s51, 65536
  s_mov_b32 s63, s55
  buffer_load_dwordx4 v4, s[16:19], s63 offen lds
  v_mfma_f32_32x32x16_bf16 v[160:175], v[40:43], a[32:35], v[160:175]
  v_mfma_f32_32x32x16_bf16 v[224:239], v[40:43], a[160:163], v[224:239]
  v_mfma_f32_32x32x16_bf16 v[176:191], v[44:47], a[32:35], v[176:191]
  v_mfma_f32_32x32x16_bf16 v[240:255], v[44:47], a[160:163], v[240:255]
  ds_read_b64_tr_b16 v[32:33], v11 offset:8192
  ds_read_b64_tr_b16 v[34:35], v11 offset:9216
  ds_read_b64_tr_b16 v[36:37], v12 offset:8192
  ds_read_b64_tr_b16 v[38:39], v12 offset:9216
  ds_read_b64_tr_b16 v[40:41], v13 offset:8192
  ds_read_b64_tr_b16 v[42:43], v13 offset:9216
  ds_read_b64_tr_b16 v[44:45], v14 offset:8192
  ds_read_b64_tr_b16 v[46:47], v14 offset:9216
  s_waitcnt lgkmcnt(8)
  v_mfma_f32_32x32x16_bf16 v[128:143], v[48:51], a[36:39], v[128:143]
  v_mfma_f32_32x32x16_bf16 v[192:207], v[48:51], a[164:167], v[192:207]
  v_mfma_f32_32x32x16_bf16 v[144:159], v[52:55], a[36:39], v[144:159]
  v_mfma_f32_32x32x16_bf16 v[208:223], v[52:55], a[164:167], v[208:223]
  s_add_u32 m0, s51, 66560
  s_add_u32 s63, s63, s72
  buffer_load_dwordx4 v4, s[16:19], s63 offen lds
  v_mfma_f32_32x32x16_bf16 v[160:175], v[56:59], a[36:39], v[160:175]
  v_mfma_f32_32x32x16_bf16 v[224:239], v[56:59], a[164:167], v[224:239]
  v_mfma_f32_32x32x16_bf16 v[176:191], v[60:63], a[36:39], v[176:191]
  v_mfma_f32_32x32x16_bf16 v[240:255], v[60:63], a[164:167], v[240:255]
  ds_read_b64_tr_b16 v[48:49], v11 offset:12288
  ds_read_b64_tr_b16 v[50:51], v11 offset:13312
  ds_read_b64_tr_b16 v[52:53], v12 offset:12288
  ds_read_b64_tr_b16 v[54:55], v12 offset:13312
  ds_read_b64_tr_b16 v[56:57], v13 offset:12288
  ds_read_b64_tr_b16 v[58:59], v13 offset:13312
  ds_read_b64_tr_b16 v[60:61], v14 offset:12288
  ds_read_b64_tr_b16 v[62:63], v14 offset:13312
  s_waitcnt lgkmcnt(8)
  v_mfma_f32_32x32x16_bf16 v[128:143], v[32:35], a[40:43], v[128:143]
  v_mfma_f32_32x32x16_bf16 v[192:207], v[32:35], a[168:171], v[192:207]
  v_mfma_f32_32x32x16_bf16 v[144:159], v[36:39], a[40:43], v[144:159]
  v_mfma_f32_32x32x16_bf16 v[208:223], v[36:39], a[168:171], v[208:223]
  s_add_u32 m0, s51, 67584
  s_add_u32 s63, s63, s72
  buffer_load_dwordx4 v4, s[16:19], s63 offen lds
  v_mfma_f32_32x32x16_bf16 v[160:175], v[40:43], a[40:43], v[160:175]
  v_mfma_f32_32x32x16_bf16 v[224:239], v[40:43], a[168:171], v[224:239]
  v_mfma_f32_32x32x16_bf16 v[176:191], v[44:47], a[40:43], v[176:191]
  v_mfma_f32_32x32x16_bf16 v[240:255], v[44:47], a[168:171], v[240:255]
  s_waitcnt lgkmcnt(0)
  v_mfma_f32_32x32x16_bf16 v[128:143], v[48:51], a[44:47], v[128:143]
  v_mfma_f32_32x32x16_bf16 v[192:207], v[48:51], a[172:175], v[192:207]
  v_mfma_f32_32x32x16_bf16 v[144:159], v[52:55], a[44:47], v[144:159]
  v_mfma_f32_32x32x16_bf16 v[208:223], v[52:55], a[172:175], v[208:223]
  s_add_u32 m0, s51, 68608
  s_add_u32 s63, s63, s72
  buffer_load_dwordx4 v4, s[16:19], s63 offen lds
  s_lshl_b32 s31, s45, 6
  s_add_u32 s55, s55, s31
  s_add_u32 s51, s51, 16384
  s_cmp_ge_u32 s51, 98304
  s_cselect_b32 s31, 98304, 0
  s_sub_u32 s51, s51, s31
  v_mfma_f32_32x32x16_bf16 v[160:175], v[56:59], a[44:47], v[160:175]
  v_mfma_f32_32x32x16_bf16 v[224:239], v[56:59], a[172:175], v[224:239]
  v_mfma_f32_32x32x16_bf16 v[176:191], v[60:63], a[44:47], v[176:191]
  v_mfma_f32_32x32x16_bf16 v[240:255], v[60:63], a[172:175], v[240:255]
  s_waitcnt vmcnt(16)
  s_barrier
  v_add_u32 v11, s50, v24
  v_add_u32 v12, s50, v25
  v_add_u32 v13, s50, v26
  v_add_u32 v14, s50, v27
  ds_read_b64_tr_b16 v[32:33], v11 offset:0
  ds_read_b64_tr_b16 v[34:35], v11 offset:1024
  ds_read_b64_tr_b16 v[36:37], v12 offset:0
  ds_read_b64_tr_b16 v[38:39], v12 offset:1024
  ds_read_b64_tr_b16 v[40:41], v13 offset:0
  ds_read_b64_tr_b16 v[42:43], v13 offset:1024
  ds_read_b64_tr_b16 v[44:45], v14 offset:0
  ds_read_b64_tr_b16 v[46:47], v14 offset:1024
  s_and_b32 s31, s43, 15
  s_bfe_u32 s32, s43, 0x8000c
  s_mov_b32 s16, s12
  s_mov_b32 s17, s13
  s_cmp_eq_u32 s31, 6
  s_cselect_b32 s16, s14, s16
  s_cselect_b32 s17, s15, s17
  s_cmp_eq_u32 s31, 1
  s_cselect_b32 s16, s20, s16
  s_cselect_b32 s17, s21, s17
  s_mov_b32 s18, 0x400000
  s_mov_b32 s45, 8192
  s_cmp_eq_u32 s31, 2
  s_cselect_b32 s16, s22, s16
  s_cselect_b32 s17, s23, s17
  s_cselect_b32 s18, 1835008, s18
  s_cselect_b32 s45, 3584, s45
  s_cselect_b64 vcc, -1, 0
  s_mov_b32 s19, 0x20000
  v_cndmask_b32 v4, v2, v3, vcc
  s_lshl_b32 s72, s45, 2
  s_lshl_b32 s33, s45, 4
  s_mul_i32 s33, s33, s29
  s_lshl_b32 s55, s32, 8
  s_add_u32 s55, s55, s33
  s_add_u32 s50, s50, 16384
  s_cmp_ge_u32 s50, 98304
  s_cselect_b32 s31, 98304, 0
  s_sub_u32 s50, s50, s31
  ds_read_b64_tr_b16 v[48:49], v11 offset:4096
  ds_read_b64_tr_b16 v[50:51], v11 offset:5120
  ds_read_b64_tr_b16 v[52:53], v12 offset:4096
  ds_read_b64_tr_b16 v[54:55], v12 offset:5120
  ds_read_b64_tr_b16 v[56:57], v13 offset:4096
  ds_read_b64_tr_b16 v[58:59], v13 offset:5120
  ds_read_b64_tr_b16 v[60:61], v14 offset:4096
  ds_read_b64_tr_b16 v[62:63], v14 offset:5120
  s_waitcnt lgkmcnt(8)
  v_mfma_f32_32x32x16_bf16 v[128:143], v[32:35], a[48:51], v[128:143]
  v_mfma_f32_32x32x16_bf16 v[192:207], v[32:35], a[176:179], v[192:207]
  v_mfma_f32_32x32x16_bf16 v[144:159], v[36:39], a[48:51], v[144:159]
  v_mfma_f32_32x32x16_bf16 v[208:223], v[36:39], a[176:179], v[208:223]
  s_add_u32 m0, s51, 65536
  s_mov_b32 s63, s55
  buffer_load_dwordx4 v4, s[16:19], s63 offen lds
  v_mfma_f32_32x32x16_bf16 v[160:175], v[40:43], a[48:51], v[160:175]
  v_mfma_f32_32x32x16_bf16 v[224:239], v[40:43], a[176:179], v[224:239]
  v_mfma_f32_32x32x16_bf16 v[176:191], v[44:47], a[48:51], v[176:191]
  v_mfma_f32_32x32x16_bf16 v[240:255], v[44:47], a[176:179], v[240:255]
  ds_read_b64_tr_b16 v[32:33], v11 offset:8192
  ds_read_b64_tr_b16 v[34:35], v11 offset:9216
  ds_read_b64_tr_b16 v[36:37], v12 offset:8192
  ds_read_b64_tr_b16 v[38:39], v12 offset:9216
  ds_read_b64_tr_b16 v[40:41], v13 offset:8192
  ds_read_b64_tr_b16 v[42:43], v13 offset:9216
  ds_read_b64_tr_b16 v[44:45], v14 offset:8192
  ds_read_b64_tr_b16 v[46:47], v14 offset:9216
  s_waitcnt lgkmcnt(8)
  v_mfma_f32_32x32x16_bf16 v[128:143], v[48:51], a[52:55], v[128:143]
  v_mfma_f32_32x32x16_bf16 v[192:207], v[48:51], a[180:183], v[192:207]
  v_mfma_f32_32x32x16_bf16 v[144:159], v[52:55], a[52:55], v[144:159]
  v_mfma_f32_32x32x16_bf16 v[208:223], v[52:55], a[180:183], v[208:223]
  s_add_u32 m0, s51, 66560
  s_add_u32 s63, s63, s72
  buffer_load_dwordx4 v4, s[16:19], s63 offen lds
  v_mfma_f32_32x32x16_bf16 v[160:175], v[56:59], a[52:55], v[160:175]
  v_mfma_f32_32x32x16_bf16 v[224:239], v[56:59], a[180:183], v[224:239]
  v_mfma_f32_32x32x16_bf16 v[176:191], v[60:63], a[52:55], v[176:191]
  v_mfma_f32_32x32x16_bf16 v[240:255], v[60:63], a[180:183], v[240:255]
  ds_read_b64_tr_b16 v[48:49], v11 offset:12288
  ds_read_b64_tr_b16 v[50:51], v11 offset:13312
  ds_read_b64_tr_b16 v[52:53], v12 offset:12288
  ds_read_b64_tr_b16 v[54:55], v12 offset:13312
  ds_read_b64_tr_b16 v[56:57], v13 offset:12288
  ds_read_b64_tr_b16 v[58:59], v13 offset:13312
  ds_read_b64_tr_b16 v[60:61], v14 offset:12288
  ds_read_b64_tr_b16 v[62:63], v14 offset:13312
  s_waitcnt lgkmcnt(8)
  v_mfma_f32_32x32x16_bf16 v[128:143], v[32:35], a[56:59], v[128:143]
  v_mfma_f32_32x32x16_bf16 v[192:207], v[32:35], a[184:187], v[192:207]
  v_mfma_f32_32x32x16_bf16 v[144:159], v[36:39], a[56:59], v[144:159]
  v_mfma_f32_32x32x16_bf16 v[208:223], v[36:39], a[184:187], v[208:223]
  s_add_u32 m0, s51, 67584
  s_add_u32 s63, s63, s72
  buffer_load_dwordx4 v4, s[16:19], s63 offen lds
  v_mfma_f32_32x32x16_bf16 v[160:175], v[40:43], a[56:59], v[160:175]
  v_mfma_f32_32x32x16_bf16 v[224:239], v[40:43], a[184:187], v[224:239]
  v_mfma_f32_32x32x16_bf16 v[176:191], v[44:47], a[56:59], v[176:191]
  v_mfma_f32_32x32x16_bf16 v[240:255], v[44:47], a[184:187], v[240:255]
  s_waitcnt lgkmcnt(0)
  v_mfma_f32_32x32x16_bf16 v[128:143], v[48:51], a[60:63], v[128:143]
  v_mfma_f32_32x32x16_bf16 v[192:207], v[48:51], a[188:191], v[192:207]
  v_mfma_f32_32x32x16_bf16 v[144:159], v[52:55], a[60:63], v[144:159]
  v_mfma_f32_32x32x16_bf16 v[208:223], v[52:55], a[188:191], v[208:223]
  s_add_u32 m0, s51, 68608
  s_add_u32 s63, s63, s72
  buffer_load_dwordx4 v4, s[16:19], s63 offen lds
  s_lshl_b32 s31, s45, 6
  s_add_u32 s55, s55, s31
  s_add_u32 s51, s51, 16384
  s_cmp_ge_u32 s51, 98304
  s_cselect_b32 s31, 98304, 0
  s_sub_u32 s51, s51, s31
  v_mfma_f32_32x32x16_bf16 v[160:175], v[56:59], a[60:63], v[160:175]
  v_mfma_f32_32x32x16_bf16 v[224:239], v[56:59], a[188:191], v[224:239]
  v_mfma_f32_32x32x16_bf16 v[176:191], v[60:63], a[60:63], v[176:191]
  v_mfma_f32_32x32x16_bf16 v[240:255], v[60:63], a[188:191], v[240:255]
  s_waitcnt vmcnt(16)
  s_barrier
  v_add_u32 v11, s50, v24
  v_add_u32 v12, s50, v25
  v_add_u32 v13, s50, v26
  v_add_u32 v14, s50, v27
  ds_read_b64_tr_b16 v[32:33], v11 offset:0
  ds_read_b64_tr_b16 v[34:35], v11 offset:1024
  ds_read_b64_tr_b16 v[36:37], v12 offset:0
  ds_read_b64_tr_b16 v[38:39], v12 offset:1024
  ds_read_b64_tr_b16 v[40:41], v13 offset:0
  ds_read_b64_tr_b16 v[42:43], v13 offset:1024
  ds_read_b64_tr_b16 v[44:45], v14 offset:0
  ds_read_b64_tr_b16 v[46:47], v14 offset:1024
  s_add_u32 s50, s50, 16384
  s_cmp_ge_u32 s50, 98304
  s_cselect_b32 s31, 98304, 0
  s_sub_u32 s50, s50, s31
  ds_read_b64_tr_b16 v[48:49], v11 offset:4096
  ds_read_b64_tr_b16 v[50:51], v11 offset:5120
  ds_read_b64_tr_b16 v[52:53], v12 offset:4096
  ds_read_b64_tr_b16 v[54:55], v12 offset:5120
  ds_read_b64_tr_b16 v[56:57], v13 offset:4096
  ds_read_b64_tr_b16 v[58:59], v13 offset:5120
  ds_read_b64_tr_b16 v[60:61], v14 offset:4096
  ds_read_b64_tr_b16 v[62:63], v14 offset:5120
  s_waitcnt lgkmcnt(8)
  v_mfma_f32_32x32x16_bf16 v[128:143], v[32:35], a[64:67], v[128:143]
  v_mfma_f32_32x32x16_bf16 v[192:207], v[32:35], a[192:195], v[192:207]
  v_mfma_f32_32x32x16_bf16 v[144:159], v[36:39], a[64:67], v[144:159]
  v_mfma_f32_32x32x16_bf16 v[208:223], v[36:39], a[192:195], v[208:223]
  s_add_u32 m0, s51, 65536
  s_mov_b32 s63, s55
  buffer_load_dwordx4 v4, s[16:19], s63 offen lds
  v_mfma_f32_32x32x16_bf16 v[160:175], v[40:43], a[64:67], v[160:175]
  v_mfma_f32_32x32x16_bf16 v[224:239], v[40:43], a[192:195], v[224:239]
  v_mfma_f32_32x32x16_bf16 v[176:191], v[44:47], a[64:67], v[176:191]
  v_mfma_f32_32x32x16_bf16 v[240:255], v[44:47], a[192:195], v[240:255]
  ds_read_b64_tr_b16 v[32:33], v11 offset:8192
  ds_read_b64_tr_b16 v[34:35], v11 offset:9216
  ds_read_b64_tr_b16 v[36:37], v12 offset:8192
  ds_read_b64_tr_b16 v[38:39], v12 offset:9216
  ds_read_b64_tr_b16 v[40:41], v13 offset:8192
  ds_read_b64_tr_b16 v[42:43], v13 offset:9216
  ds_read_b64_tr_b16 v[44:45], v14 offset:8192
  ds_read_b64_tr_b16 v[46:47], v14 offset:9216
  s_waitcnt lgkmcnt(8)
  v_mfma_f32_32x32x16_bf16 v[128:143], v[48:51], a[68:71], v[128:143]
  v_mfma_f32_32x32x16_bf16 v[192:207], v[48:51], a[196:199], v[192:207]
  v_mfma_f32_32x32x16_bf16 v[144:159], v[52:55], a[68:71], v[144:159]
  v_mfma_f32_32x32x16_bf16 v[208:223], v[52:55], a[196:199], v[208:223]
  s_add_u32 m0, s51, 66560
  s_add_u32 s63, s63, s72
  buffer_load_dwordx4 v4, s[16:19], s63 offen lds
  v_mfma_f32_32x32x16_bf16 v[160:175], v[56:59], a[68:71], v[160:175]
  v_mfma_f32_32x32x16_bf16 v[224:239], v[56:59], a[196:199], v[224:239]
  v_mfma_f32_32x32x16_bf16 v[176:191], v[60:63], a[68:71], v[176:191]
  v_mfma_f32_32x32x16_bf16 v[240:255], v[60:63], a[196:199], v[240:255]
  ds_read_b64_tr_b16 v[48:49], v11 offset:12288
  ds_read_b64_tr_b16 v[50:51], v11 offset:13312
  ds_read_b64_tr_b16 v[52:53], v12 offset:12288
  ds_read_b64_tr_b16 v[54:55], v12 offset:13312
  ds_read_b64_tr_b16 v[56:57], v13 offset:12288
  ds_read_b64_tr_b16 v[58:59], v13 offset:13312
  ds_read_b64_tr_b16 v[60:61], v14 offset:12288
  ds_read_b64_tr_b16 v[62:63], v14 offset:13312
  s_waitcnt lgkmcnt(8)
  v_mfma_f32_32x32x16_bf16 v[128:143], v[32:35], a[72:75], v[128:143]
  v_mfma_f32_32x32x16_bf16 v[192:207], v[32:35], a[200:203], v[192:207]
  v_mfma_f32_32x32x16_bf16 v[144:159], v[36:39], a[72:75], v[144:159]
  v_mfma_f32_32x32x16_bf16 v[208:223], v[36:39], a[200:203], v[208:223]
  s_add_u32 m0, s51, 67584
  s_add_u32 s63, s63, s72
  buffer_load_dwordx4 v4, s[16:19], s63 offen lds
  v_mfma_f32_32x32x16_bf16 v[160:175], v[40:43], a[72:75], v[160:175]
  v_mfma_f32_32x32x16_bf16 v[224:239], v[40:43], a[200:203], v[224:239]
  v_mfma_f32_32x32x16_bf16 v[176:191], v[44:47], a[72:75], v[176:191]
  v_mfma_f32_32x32x16_bf16 v[240:255], v[44:47], a[200:203], v[240:255]
  s_waitcnt lgkmcnt(0)
  v_mfma_f32_32x32x16_bf16 v[128:143], v[48:51], a[76:79], v[128:143]
  v_mfma_f32_32x32x16_bf16 v[192:207], v[48:51], a[204:207], v[192:207]
  v_mfma_f32_32x32x16_bf16 v[144:159], v[52:55], a[76:79], v[144:159]
  v_mfma_f32_32x32x16_bf16 v[208:223], v[52:55], a[204:207], v[208:223]
  s_add_u32 m0, s51, 68608
  s_add_u32 s63, s63, s72
  buffer_load_dwordx4 v4, s[16:19], s63 offen lds
  s_lshl_b32 s31, s45, 6
  s_add_u32 s55, s55, s31
  s_add_u32 s51, s51, 16384
  s_cmp_ge_u32 s51, 98304
  s_cselect_b32 s31, 98304, 0
  s_sub_u32 s51, s51, s31
  v_mfma_f32_32x32x16_bf16 v[160:175], v[56:59], a[76:79], v[160:175]
  v_mfma_f32_32x32x16_bf16 v[224:239], v[56:59], a[204:207], v[224:239]
  v_mfma_f32_32x32x16_bf16 v[176:191], v[60:63], a[76:79], v[176:191]
  v_mfma_f32_32x32x16_bf16 v[240:255], v[60:63], a[204:207], v[240:255]
  s_waitcnt vmcnt(16)
  s_barrier
  v_add_u32 v11, s50, v24
  v_add_u32 v12, s50, v25
  v_add_u32 v13, s50, v26
  v_add_u32 v14, s50, v27
  ds_read_b64_tr_b16 v[32:33], v11 offset:0
  ds_read_b64_tr_b16 v[34:35], v11 offset:1024
  ds_read_b64_tr_b16 v[36:37], v12 offset:0
  ds_read_b64_tr_b16 v[38:39], v12 offset:1024
  ds_read_b64_tr_b16 v[40:41], v13 offset:0
  ds_read_b64_tr_b16 v[42:43], v13 offset:1024
  ds_read_b64_tr_b16 v[44:45], v14 offset:0
  ds_read_b64_tr_b16 v[46:47], v14 offset:1024
  s_add_u32 s50, s50, 16384
  s_cmp_ge_u32 s50, 98304
  s_cselect_b32 s31, 98304, 0
  s_sub_u32 s50, s50, s31
  ds_read_b64_tr_b16 v[48:49], v11 offset:4096
  ds_read_b64_tr_b16 v[50:51], v11 offset:5120
  ds_read_b64_tr_b16 v[52:53], v12 offset:4096
  ds_read_b64_tr_b16 v[54:55], v12 offset:5120
  ds_read_b64_tr_b16 v[56:57], v13 offset:4096
  ds_read_b64_tr_b16 v[58:59], v13 offset:5120
  ds_read_b64_tr_b16 v[60:61], v14 offset:4096
  ds_read_b64_tr_b16 v[62:63], v14 offset:5120
  s_waitcnt lgkmcnt(8)
  v_mfma_f32_32x32x16_bf16 v[128:143], v[32:35], a[80:83], v[128:143]
  v_mfma_f32_32x32x16_bf16 v[192:207], v[32:35], a[208:211], v[192:207]
  v_mfma_f32_32x32x16_bf16 v[144:159], v[36:39], a[80:83], v[144:159]
  v_mfma_f32_32x32x16_bf16 v[208:223], v[36:39], a[208:211], v[208:223]
  s_add_u32 m0, s51, 65536
  s_mov_b32 s63, s55
  buffer_load_dwordx4 v4, s[16:19], s63 offen lds
  v_mfma_f32_32x32x16_bf16 v[160:175], v[40:43], a[80:83], v[160:175]
  v_mfma_f32_32x32x16_bf16 v[224:239], v[40:43], a[208:211], v[224:239]
  v_mfma_f32_32x32x16_bf16 v[176:191], v[44:47], a[80:83], v[176:191]
  v_mfma_f32_32x32x16_bf16 v[240:255], v[44:47], a[208:211], v[240:255]
  ds_read_b64_tr_b16 v[32:33], v11 offset:8192
  ds_read_b64_tr_b16 v[34:35], v11 offset:9216
  ds_read_b64_tr_b16 v[36:37], v12 offset:8192
  ds_read_b64_tr_b16 v[38:39], v12 offset:9216
  ds_read_b64_tr_b16 v[40:41], v13 offset:8192
  ds_read_b64_tr_b16 v[42:43], v13 offset:9216
  ds_read_b64_tr_b16 v[44:45], v14 offset:8192
  ds_read_b64_tr_b16 v[46:47], v14 offset:9216
  s_waitcnt lgkmcnt(8)
  v_mfma_f32_32x32x16_bf16 v[128:143], v[48:51], a[84:87], v[128:143]
  v_mfma_f32_32x32x16_bf16 v[192:207], v[48:51], a[212:215], v[192:207]
  v_mfma_f32_32x32x16_bf16 v[144:159], v[52:55], a[84:87], v[144:159]
  v_mfma_f32_32x32x16_bf16 v[208:223], v[52:55], a[212:215], v[208:223]
  s_add_u32 m0, s51, 66560
  s_add_u32 s63, s63, s72
  buffer_load_dwordx4 v4, s[16:19], s63 offen lds
  v_mfma_f32_32x32x16_bf16 v[160:175], v[56:59], a[84:87], v[160:175]
  v_mfma_f32_32x32x16_bf16 v[224:239], v[56:59], a[212:215], v[224:239]
  v_mfma_f32_32x32x16_bf16 v[176:191], v[60:63], a[84:87], v[176:191]
  v_mfma_f32_32x32x16_bf16 v[240:255], v[60:63], a[212:215], v[240:255]
  ds_read_b64_tr_b16 v[48:49], v11 offset:12288
  ds_read_b64_tr_b16 v[50:51], v11 offset:13312
  ds_read_b64_tr_b16 v[52:53], v12 offset:12288
  ds_read_b64_tr_b16 v[54:55], v12 offset:13312
  ds_read_b64_tr_b16 v[56:57], v13 offset:12288
  ds_read_b64_tr_b16 v[58:59], v13 offset:13312
  ds_read_b64_tr_b16 v[60:61], v14 offset:12288
  ds_read_b64_tr_b16 v[62:63], v14 offset:13312
  s_waitcnt lgkmcnt(8)
  v_mfma_f32_32x32x16_bf16 v[128:143], v[32:35], a[88:91], v[128:143]
  v_mfma_f32_32x32x16_bf16 v[192:207], v[32:35], a[216:219], v[192:207]
  v_mfma_f32_32x32x16_bf16 v[144:159], v[36:39], a[88:91], v[144:159]
  v_mfma_f32_32x32x16_bf16 v[208:223], v[36:39], a[216:219], v[208:223]
  s_add_u32 m0, s51, 67584
  s_add_u32 s63, s63, s72
  buffer_load_dwordx4 v4, s[16:19], s63 offen lds
  v_mfma_f32_32x32x16_bf16 v[160:175], v[40:43], a[88:91], v[160:175]
  v_mfma_f32_32x32x16_bf16 v[224:239], v[40:43], a[216:219], v[224:239]
  v_mfma_f32_32x32x16_bf16 v[176:191], v[44:47], a[88:91], v[176:191]
  v_mfma_f32_32x32x16_bf16 v[240:255], v[44:47], a[216:219], v[240:255]
  s_waitcnt lgkmcnt(0)
  v_mfma_f32_32x32x16_bf16 v[128:143], v[48:51], a[92:95], v[128:143]
  v_mfma_f32_32x32x16_bf16 v[192:207], v[48:51], a[220:223], v[192:207]
  v_mfma_f32_32x32x16_bf16 v[144:159], v[52:55], a[92:95], v[144:159]
  v_mfma_f32_32x32x16_bf16 v[208:223], v[52:55], a[220:223], v[208:223]
  s_add_u32 m0, s51, 68608
  s_add_u32 s63, s63, s72
  buffer_load_dwordx4 v4, s[16:19], s63 offen lds
  s_lshl_b32 s31, s45, 6
  s_add_u32 s55, s55, s31
  s_add_u32 s51, s51, 16384
  s_cmp_ge_u32 s51, 98304
  s_cselect_b32 s31, 98304, 0
  s_sub_u32 s51, s51, s31
  v_mfma_f32_32x32x16_bf16 v[160:175], v[56:59], a[92:95], v[160:175]
  v_mfma_f32_32x32x16_bf16 v[224:239], v[56:59], a[220:223], v[224:239]
  v_mfma_f32_32x32x16_bf16 v[176:191], v[60:63], a[92:95], v[176:191]
  v_mfma_f32_32x32x16_bf16 v[240:255], v[60:63], a[220:223], v[240:255]
  s_waitcnt vmcnt(16)
  s_barrier
  v_add_u32 v11, s50, v24
  v_add_u32 v12, s50, v25
  v_add_u32 v13, s50, v26
  v_add_u32 v14, s50, v27
  ds_read_b64_tr_b16 v[32:33], v11 offset:0
  ds_read_b64_tr_b16 v[34:35], v11 offset:1024
  ds_read_b64_tr_b16 v[36:37], v12 offset:0
  ds_read_b64_tr_b16 v[38:39], v12 offset:1024
  ds_read_b64_tr_b16 v[40:41], v13 offset:0
  ds_read_b64_tr_b16 v[42:43], v13 offset:1024
  ds_read_b64_tr_b16 v[44:45], v14 offset:0
  ds_read_b64_tr_b16 v[46:47], v14 offset:1024
  s_add_u32 s50, s50, 16384
  s_cmp_ge_u32 s50, 98304
  s_cselect_b32 s31, 98304, 0
  s_sub_u32 s50, s50, s31
  ds_read_b64_tr_b16 v[48:49], v11 offset:4096
  ds_read_b64_tr_b16 v[50:51], v11 offset:5120
  ds_read_b64_tr_b16 v[52:53], v12 offset:4096
  ds_read_b64_tr_b16 v[54:55], v12 offset:5120
  ds_read_b64_tr_b16 v[56:57], v13 offset:4096
  ds_read_b64_tr_b16 v[58:59], v13 offset:5120
  ds_read_b64_tr_b16 v[60:61], v14 offset:4096
  ds_read_b64_tr_b16 v[62:63], v14 offset:5120
  s_waitcnt lgkmcnt(8)
  v_mfma_f32_32x32x16_bf16 v[128:143], v[32:35], a[96:99], v[128:143]
  v_mfma_f32_32x32x16_bf16 v[192:207], v[32:35], a[224:227], v[192:207]
  v_mfma_f32_32x32x16_bf16 v[144:159], v[36:39], a[96:99], v[144:159]
  v_mfma_f32_32x32x16_bf16 v[208:223], v[36:39], a[224:227], v[208:223]
  s_add_u32 m0, s51, 65536
  s_mov_b32 s63, s55
  buffer_load_dwordx4 v4, s[16:19], s63 offen lds
  v_mfma_f32_32x32x16_bf16 v[160:175], v[40:43], a[96:99], v[160:175]
  v_mfma_f32_32x32x16_bf16 v[224:239], v[40:43], a[224:227], v[224:239]
  v_mfma_f32_32x32x16_bf16 v[176:191], v[44:47], a[96:99], v[176:191]
  v_mfma_f32_32x32x16_bf16 v[240:255], v[44:47], a[224:227], v[240:255]
  ds_read_b64_tr_b16 v[32:33], v11 offset:8192
  ds_read_b64_tr_b16 v[34:35], v11 offset:9216
  ds_read_b64_tr_b16 v[36:37], v12 offset:8192
  ds_read_b64_tr_b16 v[38:39], v12 offset:9216
  ds_read_b64_tr_b16 v[40:41], v13 offset:8192
  ds_read_b64_tr_b16 v[42:43], v13 offset:9216
  ds_read_b64_tr_b16 v[44:45], v14 offset:8192
  ds_read_b64_tr_b16 v[46:47], v14 offset:9216
  s_waitcnt lgkmcnt(8)
  v_mfma_f32_32x32x16_bf16 v[128:143], v[48:51], a[100:103], v[128:143]
  v_mfma_f32_32x32x16_bf16 v[192:207], v[48:51], a[228:231], v[192:207]
  v_mfma_f32_32x32x16_bf16 v[144:159], v[52:55], a[100:103], v[144:159]
  v_mfma_f32_32x32x16_bf16 v[208:223], v[52:55], a[228:231], v[208:223]
  s_add_u32 m0, s51, 66560
  s_add_u32 s63, s63, s72
  buffer_load_dwordx4 v4, s[16:19], s63 offen lds
  v_mfma_f32_32x32x16_bf16 v[160:175], v[56:59], a[100:103], v[160:175]
  v_mfma_f32_32x32x16_bf16 v[224:239], v[56:59], a[228:231], v[224:239]
  v_mfma_f32_32x32x16_bf16 v[176:191], v[60:63], a[100:103], v[176:191]
  v_mfma_f32_32x32x16_bf16 v[240:255], v[60:63], a[228:231], v[240:255]
  ds_read_b64_tr_b16 v[48:49], v11 offset:12288
  ds_read_b64_tr_b16 v[50:51], v11 offset:13312
  ds_read_b64_tr_b16 v[52:53], v12 offset:12288
  ds_read_b64_tr_b16 v[54:55], v12 offset:13312
  ds_read_b64_tr_b16 v[56:57], v13 offset:12288
  ds_read_b64_tr_b16 v[58:59], v13 offset:13312
  ds_read_b64_tr_b16 v[60:61], v14 offset:12288
  ds_read_b64_tr_b16 v[62:63], v14 offset:13312
  s_waitcnt lgkmcnt(8)
  v_mfma_f32_32x32x16_bf16 v[128:143], v[32:35], a[104:107], v[128:143]
  v_mfma_f32_32x32x16_bf16 v[192:207], v[32:35], a[232:235], v[192:207]
  v_mfma_f32_32x32x16_bf16 v[144:159], v[36:39], a[104:107], v[144:159]
  v_mfma_f32_32x32x16_bf16 v[208:223], v[36:39], a[232:235], v[208:223]
  s_add_u32 m0, s51, 67584
  s_add_u32 s63, s63, s72
  buffer_load_dwordx4 v4, s[16:19], s63 offen lds
  v_mfma_f32_32x32x16_bf16 v[160:175], v[40:43], a[104:107], v[160:175]
  v_mfma_f32_32x32x16_bf16 v[224:239], v[40:43], a[232:235], v[224:239]
  v_mfma_f32_32x32x16_bf16 v[176:191], v[44:47], a[104:107], v[176:191]
  v_mfma_f32_32x32x16_bf16 v[240:255], v[44:47], a[232:235], v[240:255]
  s_waitcnt lgkmcnt(0)
  v_mfma_f32_32x32x16_bf16 v[128:143], v[48:51], a[108:111], v[128:143]
  v_mfma_f32_32x32x16_bf16 v[192:207], v[48:51], a[236:239], v[192:207]
  v_mfma_f32_32x32x16_bf16 v[144:159], v[52:55], a[108:111], v[144:159]
  v_mfma_f32_32x32x16_bf16 v[208:223], v[52:55], a[236:239], v[208:223]
  s_add_u32 m0, s51, 68608
  s_add_u32 s63, s63, s72
  buffer_load_dwordx4 v4, s[16:19], s63 offen lds
  s_lshl_b32 s31, s45, 6
  s_add_u32 s55, s55, s31
  s_add_u32 s51, s51, 16384
  s_cmp_ge_u32 s51, 98304
  s_cselect_b32 s31, 98304, 0
  s_sub_u32 s51, s51, s31
  v_mfma_f32_32x32x16_bf16 v[160:175], v[56:59], a[108:111], v[160:175]
  v_mfma_f32_32x32x16_bf16 v[224:239], v[56:59], a[236:239], v[224:239]
  v_mfma_f32_32x32x16_bf16 v[176:191], v[60:63], a[108:111], v[176:191]
  v_mfma_f32_32x32x16_bf16 v[240:255], v[60:63], a[236:239], v[240:255]
  s_waitcnt vmcnt(16)
  s_barrier
  v_add_u32 v11, s50, v24
  v_add_u32 v12, s50, v25
  v_add_u32 v13, s50, v26
  v_add_u32 v14, s50, v27
  ds_read_b64_tr_b16 v[32:33], v11 offset:0
  ds_read_b64_tr_b16 v[34:35], v11 offset:1024
  ds_read_b64_tr_b16 v[36:37], v12 offset:0
  ds_read_b64_tr_b16 v[38:39], v12 offset:1024
  ds_read_b64_tr_b16 v[40:41], v13 offset:0
  ds_read_b64_tr_b16 v[42:43], v13 offset:1024
  ds_read_b64_tr_b16 v[44:45], v14 offset:0
  ds_read_b64_tr_b16 v[46:47], v14 offset:1024
  s_cmp_eq_u32 s87, 0
  s_mov_b32 s31, s87
  s_mov_b32 s87, 0
  s_cbranch_scc1 L_pt_35
  s_cmp_lg_u32 s29, 0
  s_cbranch_scc1 L_pt_35
  v_lshlrev_b32 v22, 7, v1
  v_mov_b32 v21, 1
  s_and_b32 s32, s83, 255
  s_lshr_b32 exec_lo, s83, 8
  s_mov_b32 exec_hi, 0
  v_cmp_eq_u32 vcc, s32, v17
  s_and_b64 exec, exec, vcc
  s_cbranch_execz L_pt_35x
  buffer_store_dword v21, v22, s[4:7], s31 offen sc1
L_pt_35x:
  s_mov_b64 exec, -1
L_pt_35:
  s_add_u32 s50, s50, 16384
  s_cmp_ge_u32 s50, 98304
  s_cselect_b32 s31, 98304, 0
  s_sub_u32 s50, s50, s31
  ds_read_b64_tr_b16 v[48:49], v11 offset:4096
  ds_read_b64_tr_b16 v[50:51], v11 offset:5120
  ds_read_b64_tr_b16 v[52:53], v12 offset:4096
  ds_read_b64_tr_b16 v[54:55], v12 offset:5120
  ds_read_b64_tr_b16 v[56:57], v13 offset:4096
  ds_read_b64_tr_b16 v[58:59], v13 offset:5120
  ds_read_b64_tr_b16 v[60:61], v14 offset:4096
  ds_read_b64_tr_b16 v[62:63], v14 offset:5120
  s_waitcnt lgkmcnt(8)
  v_mfma_f32_32x32x16_bf16 v[128:143], v[32:35], a[112:115], v[128:143]
  v_mfma_f32_32x32x16_bf16 v[192:207], v[32:35], a[240:243], v[192:207]
  v_mfma_f32_32x32x16_bf16 v[144:159], v[36:39], a[112:115], v[144:159]
  v_mfma_f32_32x32x16_bf16 v[208:223], v[36:39], a[240:243], v[208:223]
  s_add_u32 m0, s51, 65536
  s_mov_b32 s63, s55
  buffer_load_dwordx4 v4, s[16:19], s63 offen lds
  v_mfma_f32_32x32x16_bf16 v[160:175], v[40:43], a[112:115], v[160:175]
  v_mfma_f32_32x32x16_bf16 v[224:239], v[40:43], a[240:243], v[224:239]
  v_mfma_f32_32x32x16_bf16 v[176:191], v[44:47], a[112:115], v[176:191]
  v_mfma_f32_32x32x16_bf16 v[240:255], v[44:47], a[240:243], v[240:255]
  ds_read_b64_tr_b16 v[32:33], v11 offset:8192
  ds_read_b64_tr_b16 v[34:35], v11 offset:9216
  ds_read_b64_tr_b16 v[36:37], v12 offset:8192
  ds_read_b64_tr_b16 v[38:39], v12 offset:9216
  ds_read_b64_tr_b16 v[40:41], v13 offset:8192
  ds_read_b64_tr_b16 v[42:43], v13 offset:9216
  ds_read_b64_tr_b16 v[44:45], v14 offset:8192
  ds_read_b64_tr_b16 v[46:47], v14 offset:9216
  s_waitcnt lgkmcnt(8)
  v_mfma_f32_32x32x16_bf16 v[128:143], v[48:51], a[116:119], v[128:143]
  v_mfma_f32_32x32x16_bf16 v[192:207], v[48:51], a[244:247], v[192:207]
  v_mfma_f32_32x32x16_bf16 v[144:159], v[52:55], a[116:119], v[144:159]
  v_mfma_f32_32x32x16_bf16 v[208:223], v[52:55], a[244:247], v[208:223]
  s_add_u32 m0, s51, 66560
  s_add_u32 s63, s63, s72
  buffer_load_dwordx4 v4, s[16:19], s63 offen lds
  v_mfma_f32_32x32x16_bf16 v[160:175], v[56:59], a[116:119], v[160:175]
  v_mfma_f32_32x32x16_bf16 v[224:239], v[56:59], a[244:247], v[224:239]
  v_mfma_f32_32x32x16_bf16 v[176:191], v[60:63], a[116:119], v[176:191]
  v_mfma_f32_32x32x16_bf16 v[240:255], v[60:63], a[244:247], v[240:255]
  ds_read_b64_tr_b16 v[48:49], v11 offset:12288
  ds_read_b64_tr_b16 v[50:51], v11 offset:13312
  ds_read_b64_tr_b16 v[52:53], v12 offset:12288
  ds_read_b64_tr_b16 v[54:55], v12 offset:13312
  ds_read_b64_tr_b16 v[56:57], v13 offset:12288
  ds_read_b64_tr_b16 v[58:59], v13 offset:13312
  ds_read_b64_tr_b16 v[60:61], v14 offset:12288
  ds_read_b64_tr_b16 v[62:63], v14 offset:13312
  s_waitcnt lgkmcnt(8)
  v_mfma_f32_32x32x16_bf16 v[128:143], v[32:35], a[120:123], v[128:143]
  v_mfma_f32_32x32x16_bf16 v[192:207], v[32:35], a[248:251], v[192:207]
  v_mfma_f32_32x32x16_bf16 v[144:159], v[36:39], a[120:123], v[144:159]
  v_mfma_f32_32x32x16_bf16 v[208:223], v[36:39], a[248:251], v[208:223]
  s_add_u32 m0, s51, 67584
  s_add_u32 s63, s63, s72
  buffer_load_dwordx4 v4, s[16:19], s63 offen lds
  v_mfma_f32_32x32x16_bf16 v[160:175], v[40:43], a[120:123], v[160:175]
  v_mfma_f32_32x32x16_bf16 v[224:239], v[40:43], a[248:251], v[224:239]
  v_mfma_f32_32x32x16_bf16 v[176:191], v[44:47], a[120:123], v[176:191]
  v_mfma_f32_32x32x16_bf16 v[240:255], v[44:47], a[248:251], v[240:255]
  s_waitcnt lgkmcnt(0)
  v_mfma_f32_32x32x16_bf16 v[128:143], v[48:51], a[124:127], v[128:143]
  v_mfma_f32_32x32x16_bf16 v[192:207], v[48:51], a[252:255], v[192:207]
  v_mfma_f32_32x32x16_bf16 v[144:159], v[52:55], a[124:127], v[144:159]
  v_mfma_f32_32x32x16_bf16 v[208:223], v[52:55], a[252:255], v[208:223]
  s_add_u32 m0, s51, 68608
  s_add_u32 s63, s63, s72
  buffer_load_dwordx4 v4, s[16:19], s63 offen lds
  s_lshl_b32 s31, s45, 6
  s_add_u32 s55, s55, s31
  s_add_u32 s51, s51, 16384
  s_cmp_ge_u32 s51, 98304
  s_cselect_b32 s31, 98304, 0
  s_sub_u32 s51, s51, s31
  v_mfma_f32_32x32x16_bf16 v[160:175], v[56:59], a[124:127], v[160:175]
  v_mfma_f32_32x32x16_bf16 v[224:239], v[56:59], a[252:255], v[224:239]
  v_mfma_f32_32x32x16_bf16 v[176:191], v[60:63], a[124:127], v[176:191]
  v_mfma_f32_32x32x16_bf16 v[240:255], v[60:63], a[252:255], v[240:255]
  s_nop 15
  s_bfe_u32 s61, s41, 0x8000c
  s_cmp_eq_u32 s49, 2
  s_cbranch_scc1 L_g1w
  s_lshl_b32 s56, s42, 8
  s_add_u32 s56, s56, s61
  s_lshl_b32 s56, s56, 13
  s_add_u32 s88, s56, 133961728
  s_mov_b32 s90, 262144
  s_lshl_b32 s85, s61, 6
  s_add_u32 s85, s85, 0
  s_lshl_b32 s68, s61, 7
  s_add_u32 s68, s68, 34944
  s_mov_b32 s86, 279
  s_mov_b32 s93, 511
  s_add_u32 s56, s56, 16777216
  s_cmp_eq_u32 s49, 1
  s_cbranch_scc0 L_g1k
  s_add_u32 s56, s56, 33554432
  s_mov_b32 s93, 1
L_g1k:
  v_bfe_u32 v21, v1, 4, 1
  v_lshrrev_b32 v22, 5, v1
  v_and_b32 v23, 15, v1
  v_lshlrev_b32 v18, 9, v21
  v_lshl_add_u32 v18, v22, 8, v18
  v_lshl_add_u32 v18, v23, 4, v18
  s_lshl_b32 s31, s29, 14
  s_add_u32 s31, s31, 0
  v_add_u32 v18, s31, v18
  v_lshlrev_b32 v21, 4, v1
  v_add_u32 v22, s31, v21
  v_cvt_pk_bf16_f32 v64, v128, v132
  v_cvt_pk_bf16_f32 v65, v129, v133
  v_cvt_pk_bf16_f32 v66, v130, v134
  v_cvt_pk_bf16_f32 v67, v131, v135
  ds_write_b128 v18, v[64:67] offset:0
  v_cvt_pk_bf16_f32 v68, v136, v140
  v_cvt_pk_bf16_f32 v69, v137, v141
  v_cvt_pk_bf16_f32 v70, v138, v142
  v_cvt_pk_bf16_f32 v71, v139, v143
  ds_write_b128 v18, v[68:71] offset:1024
  v_cvt_pk_bf16_f32 v72, v144, v148
  v_cvt_pk_bf16_f32 v73, v145, v149
  v_cvt_pk_bf16_f32 v74, v146, v150
  v_cvt_pk_bf16_f32 v75, v147, v151
  ds_write_b128 v18, v[72:75] offset:2048
  v_cvt_pk_bf16_f32 v76, v152, v156
  v_cvt_pk_bf16_f32 v77, v153, v157
  v_cvt_pk_bf16_f32 v78, v154, v158
  v_cvt_pk_bf16_f32 v79, v155, v159
  ds_write_b128 v18, v[76:79] offset:3072
  v_cvt_pk_bf16_f32 v64, v160, v164
  v_cvt_pk_bf16_f32 v65, v161, v165
  v_cvt_pk_bf16_f32 v66, v162, v166
  v_cvt_pk_bf16_f32 v67, v163, v167
  ds_write_b128 v18, v[64:67] offset:4096
  v_cvt_pk_bf16_f32 v68, v168, v172
  v_cvt_pk_bf16_f32 v69, v169, v173
  v_cvt_pk_bf16_f32 v70, v170, v174
  v_cvt_pk_bf16_f32 v71, v171, v175
  ds_write_b128 v18, v[68:71] offset:5120
  v_cvt_pk_bf16_f32 v72, v176, v180
  v_cvt_pk_bf16_f32 v73, v177, v181
  v_cvt_pk_bf16_f32 v74, v178, v182
  v_cvt_pk_bf16_f32 v75, v179, v183
  ds_write_b128 v18, v[72:75] offset:6144
  v_cvt_pk_bf16_f32 v76, v184, v188
  v_cvt_pk_bf16_f32 v77, v185, v189
  v_cvt_pk_bf16_f32 v78, v186, v190
  v_cvt_pk_bf16_f32 v79, v187, v191
  ds_write_b128 v18, v[76:79] offset:7168
  v_cvt_pk_bf16_f32 v64, v192, v196
  v_cvt_pk_bf16_f32 v65, v193, v197
  v_cvt_pk_bf16_f32 v66, v194, v198
  v_cvt_pk_bf16_f32 v67, v195, v199
  ds_write_b128 v18, v[64:67] offset:8192
  v_cvt_pk_bf16_f32 v68, v200, v204
  v_cvt_pk_bf16_f32 v69, v201, v205
  v_cvt_pk_bf16_f32 v70, v202, v206
  v_cvt_pk_bf16_f32 v71, v203, v207
  ds_write_b128 v18, v[68:71] offset:9216
  v_cvt_pk_bf16_f32 v72, v208, v212
  v_cvt_pk_bf16_f32 v73, v209, v213
  v_cvt_pk_bf16_f32 v74, v210, v214
  v_cvt_pk_bf16_f32 v75, v211, v215
  ds_write_b128 v18, v[72:75] offset:10240
  v_cvt_pk_bf16_f32 v76, v216, v220
  v_cvt_pk_bf16_f32 v77, v217, v221
  v_cvt_pk_bf16_f32 v78, v218, v222
  v_cvt_pk_bf16_f32 v79, v219, v223
  ds_write_b128 v18, v[76:79] offset:11264
  v_cvt_pk_bf16_f32 v64, v224, v228
  v_cvt_pk_bf16_f32 v65, v225, v229
  v_cvt_pk_bf16_f32 v66, v226, v230
  v_cvt_pk_bf16_f32 v67, v227, v231
  ds_write_b128 v18, v[64:67] offset:12288
  v_cvt_pk_bf16_f32 v68, v232, v236
  v_cvt_pk_bf16_f32 v69, v233, v237
  v_cvt_pk_bf16_f32 v70, v234, v238
  v_cvt_pk_bf16_f32 v71, v235, v239
  ds_write_b128 v18, v[68:71] offset:13312
  v_cvt_pk_bf16_f32 v72, v240, v244
  v_cvt_pk_bf16_f32 v73, v241, v245
  v_cvt_pk_bf16_f32 v74, v242, v246
  v_cvt_pk_bf16_f32 v75, v243, v247
  ds_write_b128 v18, v[72:75] offset:14336
  v_cvt_pk_bf16_f32 v76, v248, v252
  v_cvt_pk_bf16_f32 v77, v249, v253
  v_cvt_pk_bf16_f32 v78, v250, v254
  v_cvt_pk_bf16_f32 v79, v251, v255
  ds_write_b128 v18, v[76:79] offset:15360
  s_lshl_b32 s31, s29, 19
  s_add_u32 s62, s56, s31
  ds_read_b128 v[64:67], v22 offset:0
  ds_read_b128 v[68:71], v22 offset:1024
  ds_read_b128 v[72:75], v22 offset:2048
  ds_read_b128 v[76:79], v22 offset:3072
  ds_read_b128 v[80:83], v22 offset:4096
  ds_read_b128 v[84:87], v22 offset:5120
  ds_read_b128 v[88:91], v22 offset:6144
  ds_read_b128 v[92:95], v22 offset:7168
  ds_read_b128 v[96:99], v22 offset:8192
  ds_read_b128 v[100:103], v22 offset:9216
  ds_read_b128 v[104:107], v22 offset:10240
  ds_read_b128 v[108:111], v22 offset:11264
  ds_read_b128 v[112:115], v22 offset:12288
  ds_read_b128 v[116:119], v22 offset:13312
  ds_read_b128 v[120:123], v22 offset:14336
  ds_read_b128 v[124:127], v22 offset:15360
  s_waitcnt lgkmcnt(15)
  buffer_store_dwordx4 v[64:67], v21, s[4:7], s62 offen offset:0 sc1
  s_waitcnt lgkmcnt(14)
  buffer_store_dwordx4 v[68:71], v21, s[4:7], s62 offen offset:1024 sc1
  s_waitcnt lgkmcnt(13)
  buffer_store_dwordx4 v[72:75], v21, s[4:7], s62 offen offset:2048 sc1
  s_waitcnt lgkmcnt(12)
  buffer_store_dwordx4 v[76:79], v21, s[4:7], s62 offen offset:3072 sc1
  s_add_u32 s62, s62, 4096
  s_waitcnt lgkmcnt(11)
  buffer_store_dwordx4 v[80:83], v21, s[4:7], s62 offen offset:0 sc1
  s_waitcnt lgkmcnt(10)
  buffer_store_dwordx4 v[84:87], v21, s[4:7], s62 offen offset:1024 sc1
  s_waitcnt lgkmcnt(9)
  buffer_store_dwordx4 v[88:91], v21, s[4:7], s62 offen offset:2048 sc1
  s_waitcnt lgkmcnt(8)
  buffer_store_dwordx4 v[92:95], v21, s[4:7], s62 offen offset:3072 sc1
  s_add_u32 s62, s62, 258048
  s_waitcnt lgkmcnt(7)
  buffer_store_dwordx4 v[96:99], v21, s[4:7], s62 offen offset:0 sc1
  s_waitcnt lgkmcnt(6)
  buffer_store_dwordx4 v[100:103], v21, s[4:7], s62 offen offset:1024 sc1
  s_waitcnt lgkmcnt(5)
  buffer_store_dwordx4 v[104:107], v21, s[4:7], s62 offen offset:2048 sc1
  s_waitcnt lgkmcnt(4)
  buffer_store_dwordx4 v[108:111], v21, s[4:7], s62 offen offset:3072 sc1
  s_add_u32 s62, s62, 4096
  s_waitcnt lgkmcnt(3)
  buffer_store_dwordx4 v[112:115], v21, s[4:7], s62 offen offset:0 sc1
  s_waitcnt lgkmcnt(2)
  buffer_store_dwordx4 v[116:119], v21, s[4:7], s62 offen offset:1024 sc1
  s_waitcnt lgkmcnt(1)
  buffer_store_dwordx4 v[120:123], v21, s[4:7], s62 offen offset:2048 sc1
  s_waitcnt lgkmcnt(0)
  buffer_store_dwordx4 v[124:127], v21, s[4:7], s62 offen offset:3072 sc1
  s_add_u32 s62, s62, 4096
  s_branch L_g1n
L_g1w:
  s_lshl_b32 s32, s61, 8
  s_mul_i32 s56, s42, 458752
  s_add_u32 s56, s56, s32
  s_add_u32 s56, s56, 83886080
  s_lshl_b32 s88, s42, 7
  s_add_u32 s88, s88, 10240
  s_cmp_ge_u32 s61, 7
  s_cselect_b32 s31, 4192512, 0
  s_add_u32 s56, s56, s31
  s_cmp_ge_u32 s61, 7
  s_cselect_b32 s31, 1024, 0
  s_add_u32 s88, s88, s31
  s_mov_b32 s90, 64
  s_lshl_b32 s68, s42, 8
  s_add_u32 s68, s68, 28672
  s_cmp_ge_u32 s61, 7
  s_cselect_b32 s31, 2048, 0
  s_add_u32 s68, s68, s31
  s_mov_b32 s85, s88
  s_mov_b32 s86, 774
  s_mov_b32 s93, 3
  s_mov_b32 s73, 0x3d372713
  s_mov_b32 s74, 0xc0135761
  v_and_b32 v21, 31, v1
  v_lshrrev_b32 v22, 5, v1
  v_and_b32 v23, 15, v1
  v_xor_b32 v22, v22, v23
  v_lshlrev_b32 v18, 8, v21
  v_lshl_add_u32 v18, v22, 4, v18
  s_lshl_b32 s31, s29, 14
  s_add_u32 s31, s31, 0
  v_add_u32 v18, s31, v18
  v_lshrrev_b32 v21, 4, v1
  v_mul_u32_u24 v30, 1792, v21
  v_lshl_add_u32 v30, v23, 4, v30
  v_xor_b32 v22, v23, v21
  v_lshlrev_b32 v31, 8, v21
  v_lshl_add_u32 v31, v22, 4, v31
  v_add_u32 v31, s31, v31
  v_xor_b32 v19, 0, v18
  v_cvt_pk_bf16_f32 v64, v128, v129
  v_cvt_pk_bf16_f32 v66, v130, v131
  v_cvt_pk_bf16_f32 v68, v132, v133
  v_cvt_pk_bf16_f32 v70, v134, v135
  v_lshlrev_b32 v128, 16, v64
  v_and_b32 v129, 0xffff0000, v64
  v_lshlrev_b32 v130, 16, v66
  v_and_b32 v131, 0xffff0000, v66
  v_lshlrev_b32 v132, 16, v68
  v_and_b32 v133, 0xffff0000, v68
  v_lshlrev_b32 v134, 16, v70
  v_and_b32 v135, 0xffff0000, v70
  v_mul_f32 v64, v128, v128
  v_mul_f32 v65, v129, v129
  v_mul_f32 v66, v130, v130
  v_mul_f32 v67, v131, v131
  v_mul_f32 v68, v132, v132
  v_mul_f32 v69, v133, v133
  v_mul_f32 v70, v134, v134
  v_mul_f32 v71, v135, v135
  v_fma_f32 v64, v64, s73, 1.0
  v_fma_f32 v65, v65, s73, 1.0
  v_fma_f32 v66, v66, s73, 1.0
  v_fma_f32 v67, v67, s73, 1.0
  v_fma_f32 v68, v68, s73, 1.0
  v_fma_f32 v69, v69, s73, 1.0
  v_fma_f32 v70, v70, s73, 1.0
  v_fma_f32 v71, v71, s73, 1.0
  v_mul_f32 v64, v64, v128
  v_mul_f32 v65, v65, v129
  v_mul_f32 v66, v66, v130
  v_mul_f32 v67, v67, v131
  v_mul_f32 v68, v68, v132
  v_mul_f32 v69, v69, v133
  v_mul_f32 v70, v70, v134
  v_mul_f32 v71, v71, v135
  v_mul_f32 v64, s74, v64
  v_mul_f32 v65, s74, v65
  v_mul_f32 v66, s74, v66
  v_mul_f32 v67, s74, v67
  v_mul_f32 v68, s74, v68
  v_mul_f32 v69, s74, v69
  v_mul_f32 v70, s74, v70
  v_mul_f32 v71, s74, v71
  v_exp_f32 v64, v64
  v_exp_f32 v65, v65
  v_exp_f32 v66, v66
  v_exp_f32 v67, v67
  v_exp_f32 v68, v68
  v_exp_f32 v69, v69
  v_exp_f32 v70, v70
  v_exp_f32 v71, v71
  v_add_f32 v64, 1.0, v64
  v_add_f32 v65, 1.0, v65
  v_add_f32 v66, 1.0, v66
  v_add_f32 v67, 1.0, v67
  v_add_f32 v68, 1.0, v68
  v_add_f32 v69, 1.0, v69
  v_add_f32 v70, 1.0, v70
  v_add_f32 v71, 1.0, v71
  v_rcp_f32 v64, v64
  v_rcp_f32 v65, v65
  v_rcp_f32 v66, v66
  v_rcp_f32 v67, v67
  v_rcp_f32 v68, v68
  v_rcp_f32 v69, v69
  v_rcp_f32 v70, v70
  v_rcp_f32 v71, v71
  s_nop 0
  v_mul_f32 v128, v128, v64
  v_mul_f32 v129, v129, v65
  v_mul_f32 v130, v130, v66
  v_mul_f32 v131, v131, v67
  v_mul_f32 v132, v132, v68
  v_mul_f32 v133, v133, v69
  v_mul_f32 v134, v134, v70
  v_mul_f32 v135, v135, v71
  v_cvt_pk_bf16_f32 v64, v128, v129
  v_cvt_pk_bf16_f32 v65, v130, v131
  v_cvt_pk_bf16_f32 v66, v132, v133
  v_cvt_pk_bf16_f32 v67, v134, v135
  ds_write_b128 v19, v[64:67] offset:0
  v_cvt_pk_bf16_f32 v72, v192, v193
  v_cvt_pk_bf16_f32 v74, v194, v195
  v_cvt_pk_bf16_f32 v76, v196, v197
  v_cvt_pk_bf16_f32 v78, v198, v199
  v_lshlrev_b32 v192, 16, v72
  v_and_b32 v193, 0xffff0000, v72
  v_lshlrev_b32 v194, 16, v74
  v_and_b32 v195, 0xffff0000, v74
  v_lshlrev_b32 v196, 16, v76
  v_and_b32 v197, 0xffff0000, v76
  v_lshlrev_b32 v198, 16, v78
  v_and_b32 v199, 0xffff0000, v78
  v_mul_f32 v72, v192, v192
  v_mul_f32 v73, v193, v193
  v_mul_f32 v74, v194, v194
  v_mul_f32 v75, v195, v195
  v_mul_f32 v76, v196, v196
  v_mul_f32 v77, v197, v197
  v_mul_f32 v78, v198, v198
  v_mul_f32 v79, v199, v199
  v_fma_f32 v72, v72, s73, 1.0
  v_fma_f32 v73, v73, s73, 1.0
  v_fma_f32 v74, v74, s73, 1.0
  v_fma_f32 v75, v75, s73, 1.0
  v_fma_f32 v76, v76, s73, 1.0
  v_fma_f32 v77, v77, s73, 1.0
  v_fma_f32 v78, v78, s73, 1.0
  v_fma_f32 v79, v79, s73, 1.0
  v_mul_f32 v72, v72, v192
  v_mul_f32 v73, v73, v193
  v_mul_f32 v74, v74, v194
  v_mul_f32 v75, v75, v195
  v_mul_f32 v76, v76, v196
  v_mul_f32 v77, v77, v197
  v_mul_f32 v78, v78, v198
  v_mul_f32 v79, v79, v199
  v_mul_f32 v72, s74, v72
  v_mul_f32 v73, s74, v73
  v_mul_f32 v74, s74, v74
  v_mul_f32 v75, s74, v75
  v_mul_f32 v76, s74, v76
  v_mul_f32 v77, s74, v77
  v_mul_f32 v78, s74, v78
  v_mul_f32 v79, s74, v79
  v_exp_f32 v72, v72
  v_exp_f32 v73, v73
  v_exp_f32 v74, v74
  v_exp_f32 v75, v75
  v_exp_f32 v76, v76
  v_exp_f32 v77, v77
  v_exp_f32 v78, v78
  v_exp_f32 v79, v79
  v_add_f32 v72, 1.0, v72
  v_add_f32 v73, 1.0, v73
  v_add_f32 v74, 1.0, v74
  v_add_f32 v75, 1.0, v75
  v_add_f32 v76, 1.0, v76
  v_add_f32 v77, 1.0, v77
  v_add_f32 v78, 1.0, v78
  v_add_f32 v79, 1.0, v79
  v_rcp_f32 v72, v72
  v_rcp_f32 v73, v73
  v_rcp_f32 v74, v74
  v_rcp_f32 v75, v75
  v_rcp_f32 v76, v76
  v_rcp_f32 v77, v77
  v_rcp_f32 v78, v78
  v_rcp_f32 v79, v79
  s_nop 0
  v_mul_f32 v192, v192, v72
  v_mul_f32 v193, v193, v73
  v_mul_f32 v194, v194, v74
  v_mul_f32 v195, v195, v75
  v_mul_f32 v196, v196, v76
  v_mul_f32 v197, v197, v77
  v_mul_f32 v198, v198, v78
  v_mul_f32 v199, v199, v79
  v_cvt_pk_bf16_f32 v72, v192, v193
  v_cvt_pk_bf16_f32 v73, v194, v195
  v_cvt_pk_bf16_f32 v74, v196, v197
  v_cvt_pk_bf16_f32 v75, v198, v199
  ds_write_b128 v19, v[72:75] offset:8192
  v_xor_b32 v19, 32, v18
  v_cvt_pk_bf16_f32 v64, v136, v137
  v_cvt_pk_bf16_f32 v66, v138, v139
  v_cvt_pk_bf16_f32 v68, v140, v141
  v_cvt_pk_bf16_f32 v70, v142, v143
  v_lshlrev_b32 v136, 16, v64
  v_and_b32 v137, 0xffff0000, v64
  v_lshlrev_b32 v138, 16, v66
  v_and_b32 v139, 0xffff0000, v66
  v_lshlrev_b32 v140, 16, v68
  v_and_b32 v141, 0xffff0000, v68
  v_lshlrev_b32 v142, 16, v70
  v_and_b32 v143, 0xffff0000, v70
  v_mul_f32 v64, v136, v136
  v_mul_f32 v65, v137, v137
  v_mul_f32 v66, v138, v138
  v_mul_f32 v67, v139, v139
  v_mul_f32 v68, v140, v140
  v_mul_f32 v69, v141, v141
  v_mul_f32 v70, v142, v142
  v_mul_f32 v71, v143, v143
  v_fma_f32 v64, v64, s73, 1.0
  v_fma_f32 v65, v65, s73, 1.0
  v_fma_f32 v66, v66, s73, 1.0
  v_fma_f32 v67, v67, s73, 1.0
  v_fma_f32 v68, v68, s73, 1.0
  v_fma_f32 v69, v69, s73, 1.0
  v_fma_f32 v70, v70, s73, 1.0
  v_fma_f32 v71, v71, s73, 1.0
  v_mul_f32 v64, v64, v136
  v_mul_f32 v65, v65, v137
  v_mul_f32 v66, v66, v138
  v_mul_f32 v67, v67, v139
  v_mul_f32 v68, v68, v140
  v_mul_f32 v69, v69, v141
  v_mul_f32 v70, v70, v142
  v_mul_f32 v71, v71, v143
  v_mul_f32 v64, s74, v64
  v_mul_f32 v65, s74, v65
  v_mul_f32 v66, s74, v66
  v_mul_f32 v67, s74, v67
  v_mul_f32 v68, s74, v68
  v_mul_f32 v69, s74, v69
  v_mul_f32 v70, s74, v70
  v_mul_f32 v71, s74, v71
  v_exp_f32 v64, v64
  v_exp_f32 v65, v65
  v_exp_f32 v66, v66
  v_exp_f32 v67, v67
  v_exp_f32 v68, v68
  v_exp_f32 v69, v69
  v_exp_f32 v70, v70
  v_exp_f32 v71, v71
  v_add_f32 v64, 1.0, v64
  v_add_f32 v65, 1.0, v65
  v_add_f32 v66, 1.0, v66
  v_add_f32 v67, 1.0, v67
  v_add_f32 v68, 1.0, v68
  v_add_f32 v69, 1.0, v69
  v_add_f32 v70, 1.0, v70
  v_add_f32 v71, 1.0, v71
  v_rcp_f32 v64, v64
  v_rcp_f32 v65, v65
  v_rcp_f32 v66, v66
  v_rcp_f32 v67, v67
  v_rcp_f32 v68, v68
  v_rcp_f32 v69, v69
  v_rcp_f32 v70, v70
  v_rcp_f32 v71, v71
  s_nop 0
  v_mul_f32 v136, v136, v64
  v_mul_f32 v137, v137, v65
  v_mul_f32 v138, v138, v66
  v_mul_f32 v139, v139, v67
  v_mul_f32 v140, v140, v68
  v_mul_f32 v141, v141, v69
  v_mul_f32 v142, v142, v70
  v_mul_f32 v143, v143, v71
  v_cvt_pk_bf16_f32 v64, v136, v137
  v_cvt_pk_bf16_f32 v65, v138, v139
  v_cvt_pk_bf16_f32 v66, v140, v141
  v_cvt_pk_bf16_f32 v67, v142, v143
  ds_write_b128 v19, v[64:67] offset:0
  v_cvt_pk_bf16_f32 v72, v200, v201
  v_cvt_pk_bf16_f32 v74, v202, v203
  v_cvt_pk_bf16_f32 v76, v204, v205
  v_cvt_pk_bf16_f32 v78, v206, v207
  v_lshlrev_b32 v200, 16, v72
  v_and_b32 v201, 0xffff0000, v72
  v_lshlrev_b32 v202, 16, v74
  v_and_b32 v203, 0xffff0000, v74
  v_lshlrev_b32 v204, 16, v76
  v_and_b32 v205, 0xffff0000, v76
  v_lshlrev_b32 v206, 16, v78
  v_and_b32 v207, 0xffff0000, v78
  v_mul_f32 v72, v200, v200
  v_mul_f32 v73, v201, v201
  v_mul_f32 v74, v202, v202
  v_mul_f32 v75, v203, v203
  v_mul_f32 v76, v204, v204
  v_mul_f32 v77, v205, v205
  v_mul_f32 v78, v206, v206
  v_mul_f32 v79, v207, v207
  v_fma_f32 v72, v72, s73, 1.0
  v_fma_f32 v73, v73, s73, 1.0
  v_fma_f32 v74, v74, s73, 1.0
  v_fma_f32 v75, v75, s73, 1.0
  v_fma_f32 v76, v76, s73, 1.0
  v_fma_f32 v77, v77, s73, 1.0
  v_fma_f32 v78, v78, s73, 1.0
  v_fma_f32 v79, v79, s73, 1.0
  v_mul_f32 v72, v72, v200
  v_mul_f32 v73, v73, v201
  v_mul_f32 v74, v74, v202
  v_mul_f32 v75, v75, v203
  v_mul_f32 v76, v76, v204
  v_mul_f32 v77, v77, v205
  v_mul_f32 v78, v78, v206
  v_mul_f32 v79, v79, v207
  v_mul_f32 v72, s74, v72
  v_mul_f32 v73, s74, v73
  v_mul_f32 v74, s74, v74
  v_mul_f32 v75, s74, v75
  v_mul_f32 v76, s74, v76
  v_mul_f32 v77, s74, v77
  v_mul_f32 v78, s74, v78
  v_mul_f32 v79, s74, v79
  v_exp_f32 v72, v72
  v_exp_f32 v73, v73
  v_exp_f32 v74, v74
  v_exp_f32 v75, v75
  v_exp_f32 v76, v76
  v_exp_f32 v77, v77
  v_exp_f32 v78, v78
  v_exp_f32 v79, v79
  v_add_f32 v72, 1.0, v72
  v_add_f32 v73, 1.0, v73
  v_add_f32 v74, 1.0, v74
  v_add_f32 v75, 1.0, v75
  v_add_f32 v76, 1.0, v76
  v_add_f32 v77, 1.0, v77
  v_add_f32 v78, 1.0, v78
  v_add_f32 v79, 1.0, v79
  v_rcp_f32 v72, v72
  v_rcp_f32 v73, v73
  v_rcp_f32 v74, v74
  v_rcp_f32 v75, v75
  v_rcp_f32 v76, v76
  v_rcp_f32 v77, v77
  v_rcp_f32 v78, v78
  v_rcp_f32 v79, v79
  s_nop 0
  v_mul_f32 v200, v200, v72
  v_mul_f32 v201, v201, v73
  v_mul_f32 v202, v202, v74
  v_mul_f32 v203, v203, v75
  v_mul_f32 v204, v204, v76
  v_mul_f32 v205, v205, v77
  v_mul_f32 v206, v206, v78
  v_mul_f32 v207, v207, v79
  v_cvt_pk_bf16_f32 v72, v200, v201
  v_cvt_pk_bf16_f32 v73, v202, v203
  v_cvt_pk_bf16_f32 v74, v204, v205
  v_cvt_pk_bf16_f32 v75, v206, v207
  ds_write_b128 v19, v[72:75] offset:8192
  v_xor_b32 v19, 64, v18
  v_cvt_pk_bf16_f32 v64, v144, v145
  v_cvt_pk_bf16_f32 v66, v146, v147
  v_cvt_pk_bf16_f32 v68, v148, v149
  v_cvt_pk_bf16_f32 v70, v150, v151
  v_lshlrev_b32 v144, 16, v64
  v_and_b32 v145, 0xffff0000, v64
  v_lshlrev_b32 v146, 16, v66
  v_and_b32 v147, 0xffff0000, v66
  v_lshlrev_b32 v148, 16, v68
  v_and_b32 v149, 0xffff0000, v68
  v_lshlrev_b32 v150, 16, v70
  v_and_b32 v151, 0xffff0000, v70
  v_mul_f32 v64, v144, v144
  v_mul_f32 v65, v145, v145
  v_mul_f32 v66, v146, v146
  v_mul_f32 v67, v147, v147
  v_mul_f32 v68, v148, v148
  v_mul_f32 v69, v149, v149
  v_mul_f32 v70, v150, v150
  v_mul_f32 v71, v151, v151
  v_fma_f32 v64, v64, s73, 1.0
  v_fma_f32 v65, v65, s73, 1.0
  v_fma_f32 v66, v66, s73, 1.0
  v_fma_f32 v67, v67, s73, 1.0
  v_fma_f32 v68, v68, s73, 1.0
  v_fma_f32 v69, v69, s73, 1.0
  v_fma_f32 v70, v70, s73, 1.0
  v_fma_f32 v71, v71, s73, 1.0
  v_mul_f32 v64, v64, v144
  v_mul_f32 v65, v65, v145
  v_mul_f32 v66, v66, v146
  v_mul_f32 v67, v67, v147
  v_mul_f32 v68, v68, v148
  v_mul_f32 v69, v69, v149
  v_mul_f32 v70, v70, v150
  v_mul_f32 v71, v71, v151
  v_mul_f32 v64, s74, v64
  v_mul_f32 v65, s74, v65
  v_mul_f32 v66, s74, v66
  v_mul_f32 v67, s74, v67
  v_mul_f32 v68, s74, v68
  v_mul_f32 v69, s74, v69
  v_mul_f32 v70, s74, v70
  v_mul_f32 v71, s74, v71
  v_exp_f32 v64, v64
  v_exp_f32 v65, v65
  v_exp_f32 v66, v66
  v_exp_f32 v67, v67
  v_exp_f32 v68, v68
  v_exp_f32 v69, v69
  v_exp_f32 v70, v70
  v_exp_f32 v71, v71
  v_add_f32 v64, 1.0, v64
  v_add_f32 v65, 1.0, v65
  v_add_f32 v66, 1.0, v66
  v_add_f32 v67, 1.0, v67
  v_add_f32 v68, 1.0, v68
  v_add_f32 v69, 1.0, v69
  v_add_f32 v70, 1.0, v70
  v_add_f32 v71, 1.0, v71
  v_rcp_f32 v64, v64
  v_rcp_f32 v65, v65
  v_rcp_f32 v66, v66
  v_rcp_f32 v67, v67
  v_rcp_f32 v68, v68
  v_rcp_f32 v69, v69
  v_rcp_f32 v70, v70
  v_rcp_f32 v71, v71
  s_nop 0
  v_mul_f32 v144, v144, v64
  v_mul_f32 v145, v145, v65
  v_mul_f32 v146, v146, v66
  v_mul_f32 v147, v147, v67
  v_mul_f32 v148, v148, v68
  v_mul_f32 v149, v149, v69
  v_mul_f32 v150, v150, v70
  v_mul_f32 v151, v151, v71
  v_cvt_pk_bf16_f32 v64, v144, v145
  v_cvt_pk_bf16_f32 v65, v146, v147
  v_cvt_pk_bf16_f32 v66, v148, v149
  v_cvt_pk_bf16_f32 v67, v150, v151
  ds_write_b128 v19, v[64:67] offset:0
  v_cvt_pk_bf16_f32 v72, v208, v209
  v_cvt_pk_bf16_f32 v74, v210, v211
  v_cvt_pk_bf16_f32 v76, v212, v213
  v_cvt_pk_bf16_f32 v78, v214, v215
  v_lshlrev_b32 v208, 16, v72
  v_and_b32 v209, 0xffff0000, v72
  v_lshlrev_b32 v210, 16, v74
  v_and_b32 v211, 0xffff0000, v74
  v_lshlrev_b32 v212, 16, v76
  v_and_b32 v213, 0xffff0000, v76
  v_lshlrev_b32 v214, 16, v78
  v_and_b32 v215, 0xffff0000, v78
  v_mul_f32 v72, v208, v208
  v_mul_f32 v73, v209, v209
  v_mul_f32 v74, v210, v210
  v_mul_f32 v75, v211, v211
  v_mul_f32 v76, v212, v212
  v_mul_f32 v77, v213, v213
  v_mul_f32 v78, v214, v214
  v_mul_f32 v79, v215, v215
  v_fma_f32 v72, v72, s73, 1.0
  v_fma_f32 v73, v73, s73, 1.0
  v_fma_f32 v74, v74, s73, 1.0
  v_fma_f32 v75, v75, s73, 1.0
  v_fma_f32 v76, v76, s73, 1.0
  v_fma_f32 v77, v77, s73, 1.0
  v_fma_f32 v78, v78, s73, 1.0
  v_fma_f32 v79, v79, s73, 1.0
  v_mul_f32 v72, v72, v208
  v_mul_f32 v73, v73, v209
  v_mul_f32 v74, v74, v210
  v_mul_f32 v75, v75, v211
  v_mul_f32 v76, v76, v212
  v_mul_f32 v77, v77, v213
  v_mul_f32 v78, v78, v214
  v_mul_f32 v79, v79, v215
  v_mul_f32 v72, s74, v72
  v_mul_f32 v73, s74, v73
  v_mul_f32 v74, s74, v74
  v_mul_f32 v75, s74, v75
  v_mul_f32 v76, s74, v76
  v_mul_f32 v77, s74, v77
  v_mul_f32 v78, s74, v78
  v_mul_f32 v79, s74, v79
  v_exp_f32 v72, v72
  v_exp_f32 v73, v73
  v_exp_f32 v74, v74
  v_exp_f32 v75, v75
  v_exp_f32 v76, v76
  v_exp_f32 v77, v77
  v_exp_f32 v78, v78
  v_exp_f32 v79, v79
  v_add_f32 v72, 1.0, v72
  v_add_f32 v73, 1.0, v73
  v_add_f32 v74, 1.0, v74
  v_add_f32 v75, 1.0, v75
  v_add_f32 v76, 1.0, v76
  v_add_f32 v77, 1.0, v77
  v_add_f32 v78, 1.0, v78
  v_add_f32 v79, 1.0, v79
  v_rcp_f32 v72, v72
  v_rcp_f32 v73, v73
  v_rcp_f32 v74, v74
  v_rcp_f32 v75, v75
  v_rcp_f32 v76, v76
  v_rcp_f32 v77, v77
  v_rcp_f32 v78, v78
  v_rcp_f32 v79, v79
  s_nop 0
  v_mul_f32 v208, v208, v72
  v_mul_f32 v209, v209, v73
  v_mul_f32 v210, v210, v74
  v_mul_f32 v211, v211, v75
  v_mul_f32 v212, v212, v76
  v_mul_f32 v213, v213, v77
  v_mul_f32 v214, v214, v78
  v_mul_f32 v215, v215, v79
  v_cvt_pk_bf16_f32 v72, v208, v209
  v_cvt_pk_bf16_f32 v73, v210, v211
  v_cvt_pk_bf16_f32 v74, v212, v213
  v_cvt_pk_bf16_f32 v75, v214, v215
  ds_write_b128 v19, v[72:75] offset:8192
  v_xor_b32 v19, 96, v18
  v_cvt_pk_bf16_f32 v64, v152, v153
  v_cvt_pk_bf16_f32 v66, v154, v155
  v_cvt_pk_bf16_f32 v68, v156, v157
  v_cvt_pk_bf16_f32 v70, v158, v159
  v_lshlrev_b32 v152, 16, v64
  v_and_b32 v153, 0xffff0000, v64
  v_lshlrev_b32 v154, 16, v66
  v_and_b32 v155, 0xffff0000, v66
  v_lshlrev_b32 v156, 16, v68
  v_and_b32 v157, 0xffff0000, v68
  v_lshlrev_b32 v158, 16, v70
  v_and_b32 v159, 0xffff0000, v70
  v_mul_f32 v64, v152, v152
  v_mul_f32 v65, v153, v153
  v_mul_f32 v66, v154, v154
  v_mul_f32 v67, v155, v155
  v_mul_f32 v68, v156, v156
  v_mul_f32 v69, v157, v157
  v_mul_f32 v70, v158, v158
  v_mul_f32 v71, v159, v159
  v_fma_f32 v64, v64, s73, 1.0
  v_fma_f32 v65, v65, s73, 1.0
  v_fma_f32 v66, v66, s73, 1.0
  v_fma_f32 v67, v67, s73, 1.0
  v_fma_f32 v68, v68, s73, 1.0
  v_fma_f32 v69, v69, s73, 1.0
  v_fma_f32 v70, v70, s73, 1.0
  v_fma_f32 v71, v71, s73, 1.0
  v_mul_f32 v64, v64, v152
  v_mul_f32 v65, v65, v153
  v_mul_f32 v66, v66, v154
  v_mul_f32 v67, v67, v155
  v_mul_f32 v68, v68, v156
  v_mul_f32 v69, v69, v157
  v_mul_f32 v70, v70, v158
  v_mul_f32 v71, v71, v159
  v_mul_f32 v64, s74, v64
  v_mul_f32 v65, s74, v65
  v_mul_f32 v66, s74, v66
  v_mul_f32 v67, s74, v67
  v_mul_f32 v68, s74, v68
  v_mul_f32 v69, s74, v69
  v_mul_f32 v70, s74, v70
  v_mul_f32 v71, s74, v71
  v_exp_f32 v64, v64
  v_exp_f32 v65, v65
  v_exp_f32 v66, v66
  v_exp_f32 v67, v67
  v_exp_f32 v68, v68
  v_exp_f32 v69, v69
  v_exp_f32 v70, v70
  v_exp_f32 v71, v71
  v_add_f32 v64, 1.0, v64
  v_add_f32 v65, 1.0, v65
  v_add_f32 v66, 1.0, v66
  v_add_f32 v67, 1.0, v67
  v_add_f32 v68, 1.0, v68
  v_add_f32 v69, 1.0, v69
  v_add_f32 v70, 1.0, v70
  v_add_f32 v71, 1.0, v71
  v_rcp_f32 v64, v64
  v_rcp_f32 v65, v65
  v_rcp_f32 v66, v66
  v_rcp_f32 v67, v67
  v_rcp_f32 v68, v68
  v_rcp_f32 v69, v69
  v_rcp_f32 v70, v70
  v_rcp_f32 v71, v71
  s_nop 0
  v_mul_f32 v152, v152, v64
  v_mul_f32 v153, v153, v65
  v_mul_f32 v154, v154, v66
  v_mul_f32 v155, v155, v67
  v_mul_f32 v156, v156, v68
  v_mul_f32 v157, v157, v69
  v_mul_f32 v158, v158, v70
  v_mul_f32 v159, v159, v71
  v_cvt_pk_bf16_f32 v64, v152, v153
  v_cvt_pk_bf16_f32 v65, v154, v155
  v_cvt_pk_bf16_f32 v66, v156, v157
  v_cvt_pk_bf16_f32 v67, v158, v159
  ds_write_b128 v19, v[64:67] offset:0
  v_cvt_pk_bf16_f32 v72, v216, v217
  v_cvt_pk_bf16_f32 v74, v218, v219
  v_cvt_pk_bf16_f32 v76, v220, v221
  v_cvt_pk_bf16_f32 v78, v222, v223
  v_lshlrev_b32 v216, 16, v72
  v_and_b32 v217, 0xffff0000, v72
  v_lshlrev_b32 v218, 16, v74
  v_and_b32 v219, 0xffff0000, v74
  v_lshlrev_b32 v220, 16, v76
  v_and_b32 v221, 0xffff0000, v76
  v_lshlrev_b32 v222, 16, v78
  v_and_b32 v223, 0xffff0000, v78
  v_mul_f32 v72, v216, v216
  v_mul_f32 v73, v217, v217
  v_mul_f32 v74, v218, v218
  v_mul_f32 v75, v219, v219
  v_mul_f32 v76, v220, v220
  v_mul_f32 v77, v221, v221
  v_mul_f32 v78, v222, v222
  v_mul_f32 v79, v223, v223
  v_fma_f32 v72, v72, s73, 1.0
  v_fma_f32 v73, v73, s73, 1.0
  v_fma_f32 v74, v74, s73, 1.0
  v_fma_f32 v75, v75, s73, 1.0
  v_fma_f32 v76, v76, s73, 1.0
  v_fma_f32 v77, v77, s73, 1.0
  v_fma_f32 v78, v78, s73, 1.0
  v_fma_f32 v79, v79, s73, 1.0
  v_mul_f32 v72, v72, v216
  v_mul_f32 v73, v73, v217
  v_mul_f32 v74, v74, v218
  v_mul_f32 v75, v75, v219
  v_mul_f32 v76, v76, v220
  v_mul_f32 v77, v77, v221
  v_mul_f32 v78, v78, v222
  v_mul_f32 v79, v79, v223
  v_mul_f32 v72, s74, v72
  v_mul_f32 v73, s74, v73
  v_mul_f32 v74, s74, v74
  v_mul_f32 v75, s74, v75
  v_mul_f32 v76, s74, v76
  v_mul_f32 v77, s74, v77
  v_mul_f32 v78, s74, v78
  v_mul_f32 v79, s74, v79
  v_exp_f32 v72, v72
  v_exp_f32 v73, v73
  v_exp_f32 v74, v74
  v_exp_f32 v75, v75
  v_exp_f32 v76, v76
  v_exp_f32 v77, v77
  v_exp_f32 v78, v78
  v_exp_f32 v79, v79
  v_add_f32 v72, 1.0, v72
  v_add_f32 v73, 1.0, v73
  v_add_f32 v74, 1.0, v74
  v_add_f32 v75, 1.0, v75
  v_add_f32 v76, 1.0, v76
  v_add_f32 v77, 1.0, v77
  v_add_f32 v78, 1.0, v78
  v_add_f32 v79, 1.0, v79
  v_rcp_f32 v72, v72
  v_rcp_f32 v73, v73
  v_rcp_f32 v74, v74
  v_rcp_f32 v75, v75
  v_rcp_f32 v76, v76
  v_rcp_f32 v77, v77
  v_rcp_f32 v78, v78
  v_rcp_f32 v79, v79
  s_nop 0
  v_mul_f32 v216, v216, v72
  v_mul_f32 v217, v217, v73
  v_mul_f32 v218, v218, v74
  v_mul_f32 v219, v219, v75
  v_mul_f32 v220, v220, v76
  v_mul_f32 v221, v221, v77
  v_mul_f32 v222, v222, v78
  v_mul_f32 v223, v223, v79
  v_cvt_pk_bf16_f32 v72, v216, v217
  v_cvt_pk_bf16_f32 v73, v218, v219
  v_cvt_pk_bf16_f32 v74, v220, v221
  v_cvt_pk_bf16_f32 v75, v222, v223
  ds_write_b128 v19, v[72:75] offset:8192
  v_xor_b32 v19, 128, v18
  v_cvt_pk_bf16_f32 v64, v160, v161
  v_cvt_pk_bf16_f32 v66, v162, v163
  v_cvt_pk_bf16_f32 v68, v164, v165
  v_cvt_pk_bf16_f32 v70, v166, v167
  v_lshlrev_b32 v160, 16, v64
  v_and_b32 v161, 0xffff0000, v64
  v_lshlrev_b32 v162, 16, v66
  v_and_b32 v163, 0xffff0000, v66
  v_lshlrev_b32 v164, 16, v68
  v_and_b32 v165, 0xffff0000, v68
  v_lshlrev_b32 v166, 16, v70
  v_and_b32 v167, 0xffff0000, v70
  v_mul_f32 v64, v160, v160
  v_mul_f32 v65, v161, v161
  v_mul_f32 v66, v162, v162
  v_mul_f32 v67, v163, v163
  v_mul_f32 v68, v164, v164
  v_mul_f32 v69, v165, v165
  v_mul_f32 v70, v166, v166
  v_mul_f32 v71, v167, v167
  v_fma_f32 v64, v64, s73, 1.0
  v_fma_f32 v65, v65, s73, 1.0
  v_fma_f32 v66, v66, s73, 1.0
  v_fma_f32 v67, v67, s73, 1.0
  v_fma_f32 v68, v68, s73, 1.0
  v_fma_f32 v69, v69, s73, 1.0
  v_fma_f32 v70, v70, s73, 1.0
  v_fma_f32 v71, v71, s73, 1.0
  v_mul_f32 v64, v64, v160
  v_mul_f32 v65, v65, v161
  v_mul_f32 v66, v66, v162
  v_mul_f32 v67, v67, v163
  v_mul_f32 v68, v68, v164
  v_mul_f32 v69, v69, v165
  v_mul_f32 v70, v70, v166
  v_mul_f32 v71, v71, v167
  v_mul_f32 v64, s74, v64
  v_mul_f32 v65, s74, v65
  v_mul_f32 v66, s74, v66
  v_mul_f32 v67, s74, v67
  v_mul_f32 v68, s74, v68
  v_mul_f32 v69, s74, v69
  v_mul_f32 v70, s74, v70
  v_mul_f32 v71, s74, v71
  v_exp_f32 v64, v64
  v_exp_f32 v65, v65
  v_exp_f32 v66, v66
  v_exp_f32 v67, v67
  v_exp_f32 v68, v68
  v_exp_f32 v69, v69
  v_exp_f32 v70, v70
  v_exp_f32 v71, v71
  v_add_f32 v64, 1.0, v64
  v_add_f32 v65, 1.0, v65
  v_add_f32 v66, 1.0, v66
  v_add_f32 v67, 1.0, v67
  v_add_f32 v68, 1.0, v68
  v_add_f32 v69, 1.0, v69
  v_add_f32 v70, 1.0, v70
  v_add_f32 v71, 1.0, v71
  v_rcp_f32 v64, v64
  v_rcp_f32 v65, v65
  v_rcp_f32 v66, v66
  v_rcp_f32 v67, v67
  v_rcp_f32 v68, v68
  v_rcp_f32 v69, v69
  v_rcp_f32 v70, v70
  v_rcp_f32 v71, v71
  s_nop 0
  v_mul_f32 v160, v160, v64
  v_mul_f32 v161, v161, v65
  v_mul_f32 v162, v162, v66
  v_mul_f32 v163, v163, v67
  v_mul_f32 v164, v164, v68
  v_mul_f32 v165, v165, v69
  v_mul_f32 v166, v166, v70
  v_mul_f32 v167, v167, v71
  v_cvt_pk_bf16_f32 v64, v160, v161
  v_cvt_pk_bf16_f32 v65, v162, v163
  v_cvt_pk_bf16_f32 v66, v164, v165
  v_cvt_pk_bf16_f32 v67, v166, v167
  ds_write_b128 v19, v[64:67] offset:0
  v_cvt_pk_bf16_f32 v72, v224, v225
  v_cvt_pk_bf16_f32 v74, v226, v227
  v_cvt_pk_bf16_f32 v76, v228, v229
  v_cvt_pk_bf16_f32 v78, v230, v231
  v_lshlrev_b32 v224, 16, v72
  v_and_b32 v225, 0xffff0000, v72
  v_lshlrev_b32 v226, 16, v74
  v_and_b32 v227, 0xffff0000, v74
  v_lshlrev_b32 v228, 16, v76
  v_and_b32 v229, 0xffff0000, v76
  v_lshlrev_b32 v230, 16, v78
  v_and_b32 v231, 0xffff0000, v78
  v_mul_f32 v72, v224, v224
  v_mul_f32 v73, v225, v225
  v_mul_f32 v74, v226, v226
  v_mul_f32 v75, v227, v227
  v_mul_f32 v76, v228, v228
  v_mul_f32 v77, v229, v229
  v_mul_f32 v78, v230, v230
  v_mul_f32 v79, v231, v231
  v_fma_f32 v72, v72, s73, 1.0
  v_fma_f32 v73, v73, s73, 1.0
  v_fma_f32 v74, v74, s73, 1.0
  v_fma_f32 v75, v75, s73, 1.0
  v_fma_f32 v76, v76, s73, 1.0
  v_fma_f32 v77, v77, s73, 1.0
  v_fma_f32 v78, v78, s73, 1.0
  v_fma_f32 v79, v79, s73, 1.0
  v_mul_f32 v72, v72, v224
  v_mul_f32 v73, v73, v225
  v_mul_f32 v74, v74, v226
  v_mul_f32 v75, v75, v227
  v_mul_f32 v76, v76, v228
  v_mul_f32 v77, v77, v229
  v_mul_f32 v78, v78, v230
  v_mul_f32 v79, v79, v231
  v_mul_f32 v72, s74, v72
  v_mul_f32 v73, s74, v73
  v_mul_f32 v74, s74, v74
  v_mul_f32 v75, s74, v75
  v_mul_f32 v76, s74, v76
  v_mul_f32 v77, s74, v77
  v_mul_f32 v78, s74, v78
  v_mul_f32 v79, s74, v79
  v_exp_f32 v72, v72
  v_exp_f32 v73, v73
  v_exp_f32 v74, v74
  v_exp_f32 v75, v75
  v_exp_f32 v76, v76
  v_exp_f32 v77, v77
  v_exp_f32 v78, v78
  v_exp_f32 v79, v79
  v_add_f32 v72, 1.0, v72
  v_add_f32 v73, 1.0, v73
  v_add_f32 v74, 1.0, v74
  v_add_f32 v75, 1.0, v75
  v_add_f32 v76, 1.0, v76
  v_add_f32 v77, 1.0, v77
  v_add_f32 v78, 1.0, v78
  v_add_f32 v79, 1.0, v79
  v_rcp_f32 v72, v72
  v_rcp_f32 v73, v73
  v_rcp_f32 v74, v74
  v_rcp_f32 v75, v75
  v_rcp_f32 v76, v76
  v_rcp_f32 v77, v77
  v_rcp_f32 v78, v78
  v_rcp_f32 v79, v79
  s_nop 0
  v_mul_f32 v224, v224, v72
  v_mul_f32 v225, v225, v73
  v_mul_f32 v226, v226, v74
  v_mul_f32 v227, v227, v75
  v_mul_f32 v228, v228, v76
  v_mul_f32 v229, v229, v77
  v_mul_f32 v230, v230, v78
  v_mul_f32 v231, v231, v79
  v_cvt_pk_bf16_f32 v72, v224, v225
  v_cvt_pk_bf16_f32 v73, v226, v227
  v_cvt_pk_bf16_f32 v74, v228, v229
  v_cvt_pk_bf16_f32 v75, v230, v231
  ds_write_b128 v19, v[72:75] offset:8192
  v_xor_b32 v19, 160, v18
  v_cvt_pk_bf16_f32 v64, v168, v169
  v_cvt_pk_bf16_f32 v66, v170, v171
  v_cvt_pk_bf16_f32 v68, v172, v173
  v_cvt_pk_bf16_f32 v70, v174, v175
  v_lshlrev_b32 v168, 16, v64
  v_and_b32 v169, 0xffff0000, v64
  v_lshlrev_b32 v170, 16, v66
  v_and_b32 v171, 0xffff0000, v66
  v_lshlrev_b32 v172, 16, v68
  v_and_b32 v173, 0xffff0000, v68
  v_lshlrev_b32 v174, 16, v70
  v_and_b32 v175, 0xffff0000, v70
  v_mul_f32 v64, v168, v168
  v_mul_f32 v65, v169, v169
  v_mul_f32 v66, v170, v170
  v_mul_f32 v67, v171, v171
  v_mul_f32 v68, v172, v172
  v_mul_f32 v69, v173, v173
  v_mul_f32 v70, v174, v174
  v_mul_f32 v71, v175, v175
  v_fma_f32 v64, v64, s73, 1.0
  v_fma_f32 v65, v65, s73, 1.0
  v_fma_f32 v66, v66, s73, 1.0
  v_fma_f32 v67, v67, s73, 1.0
  v_fma_f32 v68, v68, s73, 1.0
  v_fma_f32 v69, v69, s73, 1.0
  v_fma_f32 v70, v70, s73, 1.0
  v_fma_f32 v71, v71, s73, 1.0
  v_mul_f32 v64, v64, v168
  v_mul_f32 v65, v65, v169
  v_mul_f32 v66, v66, v170
  v_mul_f32 v67, v67, v171
  v_mul_f32 v68, v68, v172
  v_mul_f32 v69, v69, v173
  v_mul_f32 v70, v70, v174
  v_mul_f32 v71, v71, v175
  v_mul_f32 v64, s74, v64
  v_mul_f32 v65, s74, v65
  v_mul_f32 v66, s74, v66
  v_mul_f32 v67, s74, v67
  v_mul_f32 v68, s74, v68
  v_mul_f32 v69, s74, v69
  v_mul_f32 v70, s74, v70
  v_mul_f32 v71, s74, v71
  v_exp_f32 v64, v64
  v_exp_f32 v65, v65
  v_exp_f32 v66, v66
  v_exp_f32 v67, v67
  v_exp_f32 v68, v68
  v_exp_f32 v69, v69
  v_exp_f32 v70, v70
  v_exp_f32 v71, v71
  v_add_f32 v64, 1.0, v64
  v_add_f32 v65, 1.0, v65
  v_add_f32 v66, 1.0, v66
  v_add_f32 v67, 1.0, v67
  v_add_f32 v68, 1.0, v68
  v_add_f32 v69, 1.0, v69
  v_add_f32 v70, 1.0, v70
  v_add_f32 v71, 1.0, v71
  v_rcp_f32 v64, v64
  v_rcp_f32 v65, v65
  v_rcp_f32 v66, v66
  v_rcp_f32 v67, v67
  v_rcp_f32 v68, v68
  v_rcp_f32 v69, v69
  v_rcp_f32 v70, v70
  v_rcp_f32 v71, v71
  s_nop 0
  v_mul_f32 v168, v168, v64
  v_mul_f32 v169, v169, v65
  v_mul_f32 v170, v170, v66
  v_mul_f32 v171, v171, v67
  v_mul_f32 v172, v172, v68
  v_mul_f32 v173, v173, v69
  v_mul_f32 v174, v174, v70
  v_mul_f32 v175, v175, v71
  v_cvt_pk_bf16_f32 v64, v168, v169
  v_cvt_pk_bf16_f32 v65, v170, v171
  v_cvt_pk_bf16_f32 v66, v172, v173
  v_cvt_pk_bf16_f32 v67, v174, v175
  ds_write_b128 v19, v[64:67] offset:0
  v_cvt_pk_bf16_f32 v72, v232, v233
  v_cvt_pk_bf16_f32 v74, v234, v235
  v_cvt_pk_bf16_f32 v76, v236, v237
  v_cvt_pk_bf16_f32 v78, v238, v239
  v_lshlrev_b32 v232, 16, v72
  v_and_b32 v233, 0xffff0000, v72
  v_lshlrev_b32 v234, 16, v74
  v_and_b32 v235, 0xffff0000, v74
  v_lshlrev_b32 v236, 16, v76
  v_and_b32 v237, 0xffff0000, v76
  v_lshlrev_b32 v238, 16, v78
  v_and_b32 v239, 0xffff0000, v78
  v_mul_f32 v72, v232, v232
  v_mul_f32 v73, v233, v233
  v_mul_f32 v74, v234, v234
  v_mul_f32 v75, v235, v235
  v_mul_f32 v76, v236, v236
  v_mul_f32 v77, v237, v237
  v_mul_f32 v78, v238, v238
  v_mul_f32 v79, v239, v239
  v_fma_f32 v72, v72, s73, 1.0
  v_fma_f32 v73, v73, s73, 1.0
  v_fma_f32 v74, v74, s73, 1.0
  v_fma_f32 v75, v75, s73, 1.0
  v_fma_f32 v76, v76, s73, 1.0
  v_fma_f32 v77, v77, s73, 1.0
  v_fma_f32 v78, v78, s73, 1.0
  v_fma_f32 v79, v79, s73, 1.0
  v_mul_f32 v72, v72, v232
  v_mul_f32 v73, v73, v233
  v_mul_f32 v74, v74, v234
  v_mul_f32 v75, v75, v235
  v_mul_f32 v76, v76, v236
  v_mul_f32 v77, v77, v237
  v_mul_f32 v78, v78, v238
  v_mul_f32 v79, v79, v239
  v_mul_f32 v72, s74, v72
  v_mul_f32 v73, s74, v73
  v_mul_f32 v74, s74, v74
  v_mul_f32 v75, s74, v75
  v_mul_f32 v76, s74, v76
  v_mul_f32 v77, s74, v77
  v_mul_f32 v78, s74, v78
  v_mul_f32 v79, s74, v79
  v_exp_f32 v72, v72
  v_exp_f32 v73, v73
  v_exp_f32 v74, v74
  v_exp_f32 v75, v75
  v_exp_f32 v76, v76
  v_exp_f32 v77, v77
  v_exp_f32 v78, v78
  v_exp_f32 v79, v79
  v_add_f32 v72, 1.0, v72
  v_add_f32 v73, 1.0, v73
  v_add_f32 v74, 1.0, v74
  v_add_f32 v75, 1.0, v75
  v_add_f32 v76, 1.0, v76
  v_add_f32 v77, 1.0, v77
  v_add_f32 v78, 1.0, v78
  v_add_f32 v79, 1.0, v79
  v_rcp_f32 v72, v72
  v_rcp_f32 v73, v73
  v_rcp_f32 v74, v74
  v_rcp_f32 v75, v75
  v_rcp_f32 v76, v76
  v_rcp_f32 v77, v77
  v_rcp_f32 v78, v78
  v_rcp_f32 v79, v79
  s_nop 0
  v_mul_f32 v232, v232, v72
  v_mul_f32 v233, v233, v73
  v_mul_f32 v234, v234, v74
  v_mul_f32 v235, v235, v75
  v_mul_f32 v236, v236, v76
  v_mul_f32 v237, v237, v77
  v_mul_f32 v238, v238, v78
  v_mul_f32 v239, v239, v79
  v_cvt_pk_bf16_f32 v72, v232, v233
  v_cvt_pk_bf16_f32 v73, v234, v235
  v_cvt_pk_bf16_f32 v74, v236, v237
  v_cvt_pk_bf16_f32 v75, v238, v239
  ds_write_b128 v19, v[72:75] offset:8192
  v_xor_b32 v19, 192, v18
  v_cvt_pk_bf16_f32 v64, v176, v177
  v_cvt_pk_bf16_f32 v66, v178, v179
  v_cvt_pk_bf16_f32 v68, v180, v181
  v_cvt_pk_bf16_f32 v70, v182, v183
  v_lshlrev_b32 v176, 16, v64
  v_and_b32 v177, 0xffff0000, v64
  v_lshlrev_b32 v178, 16, v66
  v_and_b32 v179, 0xffff0000, v66
  v_lshlrev_b32 v180, 16, v68
  v_and_b32 v181, 0xffff0000, v68
  v_lshlrev_b32 v182, 16, v70
  v_and_b32 v183, 0xffff0000, v70
  v_mul_f32 v64, v176, v176
  v_mul_f32 v65, v177, v177
  v_mul_f32 v66, v178, v178
  v_mul_f32 v67, v179, v179
  v_mul_f32 v68, v180, v180
  v_mul_f32 v69, v181, v181
  v_mul_f32 v70, v182, v182
  v_mul_f32 v71, v183, v183
  v_fma_f32 v64, v64, s73, 1.0
  v_fma_f32 v65, v65, s73, 1.0
  v_fma_f32 v66, v66, s73, 1.0
  v_fma_f32 v67, v67, s73, 1.0
  v_fma_f32 v68, v68, s73, 1.0
  v_fma_f32 v69, v69, s73, 1.0
  v_fma_f32 v70, v70, s73, 1.0
  v_fma_f32 v71, v71, s73, 1.0
  v_mul_f32 v64, v64, v176
  v_mul_f32 v65, v65, v177
  v_mul_f32 v66, v66, v178
  v_mul_f32 v67, v67, v179
  v_mul_f32 v68, v68, v180
  v_mul_f32 v69, v69, v181
  v_mul_f32 v70, v70, v182
  v_mul_f32 v71, v71, v183
  v_mul_f32 v64, s74, v64
  v_mul_f32 v65, s74, v65
  v_mul_f32 v66, s74, v66
  v_mul_f32 v67, s74, v67
  v_mul_f32 v68, s74, v68
  v_mul_f32 v69, s74, v69
  v_mul_f32 v70, s74, v70
  v_mul_f32 v71, s74, v71
  v_exp_f32 v64, v64
  v_exp_f32 v65, v65
  v_exp_f32 v66, v66
  v_exp_f32 v67, v67
  v_exp_f32 v68, v68
  v_exp_f32 v69, v69
  v_exp_f32 v70, v70
  v_exp_f32 v71, v71
  v_add_f32 v64, 1.0, v64
  v_add_f32 v65, 1.0, v65
  v_add_f32 v66, 1.0, v66
  v_add_f32 v67, 1.0, v67
  v_add_f32 v68, 1.0, v68
  v_add_f32 v69, 1.0, v69
  v_add_f32 v70, 1.0, v70
  v_add_f32 v71, 1.0, v71
  v_rcp_f32 v64, v64
  v_rcp_f32 v65, v65
  v_rcp_f32 v66, v66
  v_rcp_f32 v67, v67
  v_rcp_f32 v68, v68
  v_rcp_f32 v69, v69
  v_rcp_f32 v70, v70
  v_rcp_f32 v71, v71
  s_nop 0
  v_mul_f32 v176, v176, v64
  v_mul_f32 v177, v177, v65
  v_mul_f32 v178, v178, v66
  v_mul_f32 v179, v179, v67
  v_mul_f32 v180, v180, v68
  v_mul_f32 v181, v181, v69
  v_mul_f32 v182, v182, v70
  v_mul_f32 v183, v183, v71
  v_cvt_pk_bf16_f32 v64, v176, v177
  v_cvt_pk_bf16_f32 v65, v178, v179
  v_cvt_pk_bf16_f32 v66, v180, v181
  v_cvt_pk_bf16_f32 v67, v182, v183
  ds_write_b128 v19, v[64:67] offset:0
  v_cvt_pk_bf16_f32 v72, v240, v241
  v_cvt_pk_bf16_f32 v74, v242, v243
  v_cvt_pk_bf16_f32 v76, v244, v245
  v_cvt_pk_bf16_f32 v78, v246, v247
  v_lshlrev_b32 v240, 16, v72
  v_and_b32 v241, 0xffff0000, v72
  v_lshlrev_b32 v242, 16, v74
  v_and_b32 v243, 0xffff0000, v74
  v_lshlrev_b32 v244, 16, v76
  v_and_b32 v245, 0xffff0000, v76
  v_lshlrev_b32 v246, 16, v78
  v_and_b32 v247, 0xffff0000, v78
  v_mul_f32 v72, v240, v240
  v_mul_f32 v73, v241, v241
  v_mul_f32 v74, v242, v242
  v_mul_f32 v75, v243, v243
  v_mul_f32 v76, v244, v244
  v_mul_f32 v77, v245, v245
  v_mul_f32 v78, v246, v246
  v_mul_f32 v79, v247, v247
  v_fma_f32 v72, v72, s73, 1.0
  v_fma_f32 v73, v73, s73, 1.0
  v_fma_f32 v74, v74, s73, 1.0
  v_fma_f32 v75, v75, s73, 1.0
  v_fma_f32 v76, v76, s73, 1.0
  v_fma_f32 v77, v77, s73, 1.0
  v_fma_f32 v78, v78, s73, 1.0
  v_fma_f32 v79, v79, s73, 1.0
  v_mul_f32 v72, v72, v240
  v_mul_f32 v73, v73, v241
  v_mul_f32 v74, v74, v242
  v_mul_f32 v75, v75, v243
  v_mul_f32 v76, v76, v244
  v_mul_f32 v77, v77, v245
  v_mul_f32 v78, v78, v246
  v_mul_f32 v79, v79, v247
  v_mul_f32 v72, s74, v72
  v_mul_f32 v73, s74, v73
  v_mul_f32 v74, s74, v74
  v_mul_f32 v75, s74, v75
  v_mul_f32 v76, s74, v76
  v_mul_f32 v77, s74, v77
  v_mul_f32 v78, s74, v78
  v_mul_f32 v79, s74, v79
  v_exp_f32 v72, v72
  v_exp_f32 v73, v73
  v_exp_f32 v74, v74
  v_exp_f32 v75, v75
  v_exp_f32 v76, v76
  v_exp_f32 v77, v77
  v_exp_f32 v78, v78
  v_exp_f32 v79, v79
  v_add_f32 v72, 1.0, v72
  v_add_f32 v73, 1.0, v73
  v_add_f32 v74, 1.0, v74
  v_add_f32 v75, 1.0, v75
  v_add_f32 v76, 1.0, v76
  v_add_f32 v77, 1.0, v77
  v_add_f32 v78, 1.0, v78
  v_add_f32 v79, 1.0, v79
  v_rcp_f32 v72, v72
  v_rcp_f32 v73, v73
  v_rcp_f32 v74, v74
  v_rcp_f32 v75, v75
  v_rcp_f32 v76, v76
  v_rcp_f32 v77, v77
  v_rcp_f32 v78, v78
  v_rcp_f32 v79, v79
  s_nop 0
  v_mul_f32 v240, v240, v72
  v_mul_f32 v241, v241, v73
  v_mul_f32 v242, v242, v74
  v_mul_f32 v243, v243, v75
  v_mul_f32 v244, v244, v76
  v_mul_f32 v245, v245, v77
  v_mul_f32 v246, v246, v78
  v_mul_f32 v247, v247, v79
  v_cvt_pk_bf16_f32 v72, v240, v241
  v_cvt_pk_bf16_f32 v73, v242, v243
  v_cvt_pk_bf16_f32 v74, v244, v245
  v_cvt_pk_bf16_f32 v75, v246, v247
  ds_write_b128 v19, v[72:75] offset:8192
  v_xor_b32 v19, 224, v18
  v_cvt_pk_bf16_f32 v64, v184, v185
  v_cvt_pk_bf16_f32 v66, v186, v187
  v_cvt_pk_bf16_f32 v68, v188, v189
  v_cvt_pk_bf16_f32 v70, v190, v191
  v_lshlrev_b32 v184, 16, v64
  v_and_b32 v185, 0xffff0000, v64
  v_lshlrev_b32 v186, 16, v66
  v_and_b32 v187, 0xffff0000, v66
  v_lshlrev_b32 v188, 16, v68
  v_and_b32 v189, 0xffff0000, v68
  v_lshlrev_b32 v190, 16, v70
  v_and_b32 v191, 0xffff0000, v70
  v_mul_f32 v64, v184, v184
  v_mul_f32 v65, v185, v185
  v_mul_f32 v66, v186, v186
  v_mul_f32 v67, v187, v187
  v_mul_f32 v68, v188, v188
  v_mul_f32 v69, v189, v189
  v_mul_f32 v70, v190, v190
  v_mul_f32 v71, v191, v191
  v_fma_f32 v64, v64, s73, 1.0
  v_fma_f32 v65, v65, s73, 1.0
  v_fma_f32 v66, v66, s73, 1.0
  v_fma_f32 v67, v67, s73, 1.0
  v_fma_f32 v68, v68, s73, 1.0
  v_fma_f32 v69, v69, s73, 1.0
  v_fma_f32 v70, v70, s73, 1.0
  v_fma_f32 v71, v71, s73, 1.0
  v_mul_f32 v64, v64, v184
  v_mul_f32 v65, v65, v185
  v_mul_f32 v66, v66, v186
  v_mul_f32 v67, v67, v187
  v_mul_f32 v68, v68, v188
  v_mul_f32 v69, v69, v189
  v_mul_f32 v70, v70, v190
  v_mul_f32 v71, v71, v191
  v_mul_f32 v64, s74, v64
  v_mul_f32 v65, s74, v65
  v_mul_f32 v66, s74, v66
  v_mul_f32 v67, s74, v67
  v_mul_f32 v68, s74, v68
  v_mul_f32 v69, s74, v69
  v_mul_f32 v70, s74, v70
  v_mul_f32 v71, s74, v71
  v_exp_f32 v64, v64
  v_exp_f32 v65, v65
  v_exp_f32 v66, v66
  v_exp_f32 v67, v67
  v_exp_f32 v68, v68
  v_exp_f32 v69, v69
  v_exp_f32 v70, v70
  v_exp_f32 v71, v71
  v_add_f32 v64, 1.0, v64
  v_add_f32 v65, 1.0, v65
  v_add_f32 v66, 1.0, v66
  v_add_f32 v67, 1.0, v67
  v_add_f32 v68, 1.0, v68
  v_add_f32 v69, 1.0, v69
  v_add_f32 v70, 1.0, v70
  v_add_f32 v71, 1.0, v71
  v_rcp_f32 v64, v64
  v_rcp_f32 v65, v65
  v_rcp_f32 v66, v66
  v_rcp_f32 v67, v67
  v_rcp_f32 v68, v68
  v_rcp_f32 v69, v69
  v_rcp_f32 v70, v70
  v_rcp_f32 v71, v71
  s_nop 0
  v_mul_f32 v184, v184, v64
  v_mul_f32 v185, v185, v65
  v_mul_f32 v186, v186, v66
  v_mul_f32 v187, v187, v67
  v_mul_f32 v188, v188, v68
  v_mul_f32 v189, v189, v69
  v_mul_f32 v190, v190, v70
  v_mul_f32 v191, v191, v71
  v_cvt_pk_bf16_f32 v64, v184, v185
  v_cvt_pk_bf16_f32 v65, v186, v187
  v_cvt_pk_bf16_f32 v66, v188, v189
  v_cvt_pk_bf16_f32 v67, v190, v191
  ds_write_b128 v19, v[64:67] offset:0
  v_cvt_pk_bf16_f32 v72, v248, v249
  v_cvt_pk_bf16_f32 v74, v250, v251
  v_cvt_pk_bf16_f32 v76, v252, v253
  v_cvt_pk_bf16_f32 v78, v254, v255
  v_lshlrev_b32 v248, 16, v72
  v_and_b32 v249, 0xffff0000, v72
  v_lshlrev_b32 v250, 16, v74
  v_and_b32 v251, 0xffff0000, v74
  v_lshlrev_b32 v252, 16, v76
  v_and_b32 v253, 0xffff0000, v76
  v_lshlrev_b32 v254, 16, v78
  v_and_b32 v255, 0xffff0000, v78
  v_mul_f32 v72, v248, v248
  v_mul_f32 v73, v249, v249
  v_mul_f32 v74, v250, v250
  v_mul_f32 v75, v251, v251
  v_mul_f32 v76, v252, v252
  v_mul_f32 v77, v253, v253
  v_mul_f32 v78, v254, v254
  v_mul_f32 v79, v255, v255
  v_fma_f32 v72, v72, s73, 1.0
  v_fma_f32 v73, v73, s73, 1.0
  v_fma_f32 v74, v74, s73, 1.0
  v_fma_f32 v75, v75, s73, 1.0
  v_fma_f32 v76, v76, s73, 1.0
  v_fma_f32 v77, v77, s73, 1.0
  v_fma_f32 v78, v78, s73, 1.0
  v_fma_f32 v79, v79, s73, 1.0
  v_mul_f32 v72, v72, v248
  v_mul_f32 v73, v73, v249
  v_mul_f32 v74, v74, v250
  v_mul_f32 v75, v75, v251
  v_mul_f32 v76, v76, v252
  v_mul_f32 v77, v77, v253
  v_mul_f32 v78, v78, v254
  v_mul_f32 v79, v79, v255
  v_mul_f32 v72, s74, v72
  v_mul_f32 v73, s74, v73
  v_mul_f32 v74, s74, v74
  v_mul_f32 v75, s74, v75
  v_mul_f32 v76, s74, v76
  v_mul_f32 v77, s74, v77
  v_mul_f32 v78, s74, v78
  v_mul_f32 v79, s74, v79
  v_exp_f32 v72, v72
  v_exp_f32 v73, v73
  v_exp_f32 v74, v74
  v_exp_f32 v75, v75
  v_exp_f32 v76, v76
  v_exp_f32 v77, v77
  v_exp_f32 v78, v78
  v_exp_f32 v79, v79
  v_add_f32 v72, 1.0, v72
  v_add_f32 v73, 1.0, v73
  v_add_f32 v74, 1.0, v74
  v_add_f32 v75, 1.0, v75
  v_add_f32 v76, 1.0, v76
  v_add_f32 v77, 1.0, v77
  v_add_f32 v78, 1.0, v78
  v_add_f32 v79, 1.0, v79
  v_rcp_f32 v72, v72
  v_rcp_f32 v73, v73
  v_rcp_f32 v74, v74
  v_rcp_f32 v75, v75
  v_rcp_f32 v76, v76
  v_rcp_f32 v77, v77
  v_rcp_f32 v78, v78
  v_rcp_f32 v79, v79
  s_nop 0
  v_mul_f32 v248, v248, v72
  v_mul_f32 v249, v249, v73
  v_mul_f32 v250, v250, v74
  v_mul_f32 v251, v251, v75
  v_mul_f32 v252, v252, v76
  v_mul_f32 v253, v253, v77
  v_mul_f32 v254, v254, v78
  v_mul_f32 v255, v255, v79
  v_cvt_pk_bf16_f32 v72, v248, v249
  v_cvt_pk_bf16_f32 v73, v250, v251
  v_cvt_pk_bf16_f32 v74, v252, v253
  v_cvt_pk_bf16_f32 v75, v254, v255
  ds_write_b128 v19, v[72:75] offset:8192
  s_mul_i32 s31, s29, 114688
  s_add_u32 s62, s56, s31
  v_xor_b32 v23, 0, v31
  ds_read_b128 v[64:67], v23 offset:0
  v_xor_b32 v23, 64, v31
  ds_read_b128 v[68:71], v23 offset:1024
  v_xor_b32 v23, 128, v31
  ds_read_b128 v[72:75], v23 offset:2048
  v_xor_b32 v23, 192, v31
  ds_read_b128 v[76:79], v23 offset:3072
  v_xor_b32 v23, 0, v31
  ds_read_b128 v[80:83], v23 offset:4096
  v_xor_b32 v23, 64, v31
  ds_read_b128 v[84:87], v23 offset:5120
  v_xor_b32 v23, 128, v31
  ds_read_b128 v[88:91], v23 offset:6144
  v_xor_b32 v23, 192, v31
  ds_read_b128 v[92:95], v23 offset:7168
  v_xor_b32 v23, 0, v31
  ds_read_b128 v[96:99], v23 offset:8192
  v_xor_b32 v23, 64, v31
  ds_read_b128 v[100:103], v23 offset:9216
  v_xor_b32 v23, 128, v31
  ds_read_b128 v[104:107], v23 offset:10240
  v_xor_b32 v23, 192, v31
  ds_read_b128 v[108:111], v23 offset:11264
  v_xor_b32 v23, 0, v31
  ds_read_b128 v[112:115], v23 offset:12288
  v_xor_b32 v23, 64, v31
  ds_read_b128 v[116:119], v23 offset:13312
  v_xor_b32 v23, 128, v31
  ds_read_b128 v[120:123], v23 offset:14336
  v_xor_b32 v23, 192, v31
  ds_read_b128 v[124:127], v23 offset:15360
  s_waitcnt lgkmcnt(15)
  buffer_store_dwordx4 v[64:67], v30, s[4:7], s62 offen sc1
  s_add_u32 s62, s62, 7168
  s_waitcnt lgkmcnt(14)
  buffer_store_dwordx4 v[68:71], v30, s[4:7], s62 offen sc1
  s_add_u32 s62, s62, 7168
  s_waitcnt lgkmcnt(13)
  buffer_store_dwordx4 v[72:75], v30, s[4:7], s62 offen sc1
  s_add_u32 s62, s62, 7168
  s_waitcnt lgkmcnt(12)
  buffer_store_dwordx4 v[76:79], v30, s[4:7], s62 offen sc1
  s_add_u32 s62, s62, 7168
  s_waitcnt lgkmcnt(11)
  buffer_store_dwordx4 v[80:83], v30, s[4:7], s62 offen sc1
  s_add_u32 s62, s62, 7168
  s_waitcnt lgkmcnt(10)
  buffer_store_dwordx4 v[84:87], v30, s[4:7], s62 offen sc1
  s_add_u32 s62, s62, 7168
  s_waitcnt lgkmcnt(9)
  buffer_store_dwordx4 v[88:91], v30, s[4:7], s62 offen sc1
  s_add_u32 s62, s62, 7168
  s_waitcnt lgkmcnt(8)
  buffer_store_dwordx4 v[92:95], v30, s[4:7], s62 offen sc1
  s_add_u32 s62, s62, 7168
  s_waitcnt lgkmcnt(7)
  buffer_store_dwordx4 v[96:99], v30, s[4:7], s62 offen sc1
  s_add_u32 s62, s62, 7168
  s_waitcnt lgkmcnt(6)
  buffer_store_dwordx4 v[100:103], v30, s[4:7], s62 offen sc1
  s_add_u32 s62, s62, 7168
  s_waitcnt lgkmcnt(5)
  buffer_store_dwordx4 v[104:107], v30, s[4:7], s62 offen sc1
  s_add_u32 s62, s62, 7168
  s_waitcnt lgkmcnt(4)
  buffer_store_dwordx4 v[108:111], v30, s[4:7], s62 offen sc1
  s_add_u32 s62, s62, 7168
  s_waitcnt lgkmcnt(3)
  buffer_store_dwordx4 v[112:115], v30, s[4:7], s62 offen sc1
  s_add_u32 s62, s62, 7168
  s_waitcnt lgkmcnt(2)
  buffer_store_dwordx4 v[116:119], v30, s[4:7], s62 offen sc1
  s_add_u32 s62, s62, 7168
  s_waitcnt lgkmcnt(1)
  buffer_store_dwordx4 v[120:123], v30, s[4:7], s62 offen sc1
  s_add_u32 s62, s62, 7168
  s_waitcnt lgkmcnt(0)
  buffer_store_dwordx4 v[124:127], v30, s[4:7], s62 offen sc1
  s_add_u32 s62, s62, 7168
  s_branch L_g1n
L_g1v:
  s_cmp_lg_u32 s93, 0
  s_cbranch_scc1 L_g1w_36
  s_waitcnt vmcnt(16)
L_g1w_36:
  s_waitcnt vmcnt(32)
  s_barrier
  v_add_u32 v11, s50, v24
  v_add_u32 v12, s50, v25
  v_add_u32 v13, s50, v26
  v_add_u32 v14, s50, v27
  ds_read_b64_tr_b16 v[32:33], v11 offset:0
  ds_read_b64_tr_b16 v[34:35], v11 offset:1024
  ds_read_b64_tr_b16 v[36:37], v12 offset:0
  ds_read_b64_tr_b16 v[38:39], v12 offset:1024
  ds_read_b64_tr_b16 v[40:41], v13 offset:0
  ds_read_b64_tr_b16 v[42:43], v13 offset:1024
  ds_read_b64_tr_b16 v[44:45], v14 offset:0
  ds_read_b64_tr_b16 v[46:47], v14 offset:1024
  s_add_u32 s50, s50, 16384
  s_cmp_ge_u32 s50, 98304
  s_cselect_b32 s31, 98304, 0
  s_sub_u32 s50, s50, s31
  ds_read_b64_tr_b16 v[48:49], v11 offset:4096
  ds_read_b64_tr_b16 v[50:51], v11 offset:5120
  ds_read_b64_tr_b16 v[52:53], v12 offset:4096
  ds_read_b64_tr_b16 v[54:55], v12 offset:5120
  ds_read_b64_tr_b16 v[56:57], v13 offset:4096
  ds_read_b64_tr_b16 v[58:59], v13 offset:5120
  ds_read_b64_tr_b16 v[60:61], v14 offset:4096
  ds_read_b64_tr_b16 v[62:63], v14 offset:5120
  s_waitcnt lgkmcnt(8)
  v_mfma_f32_32x32x16_bf16 v[128:143], a[0:3], v[32:35], 0
  v_mfma_f32_32x32x16_bf16 v[192:207], a[128:131], v[32:35], 0
  v_mfma_f32_32x32x16_bf16 v[144:159], a[0:3], v[36:39], 0
  v_mfma_f32_32x32x16_bf16 v[208:223], a[128:131], v[36:39], 0
  s_add_u32 m0, s51, 65536
  s_mov_b32 s63, s55
  buffer_load_dwordx4 v4, s[16:19], s63 offen lds
  v_mfma_f32_32x32x16_bf16 v[160:175], a[0:3], v[40:43], 0
  v_mfma_f32_32x32x16_bf16 v[224:239], a[128:131], v[40:43], 0
  v_mfma_f32_32x32x16_bf16 v[176:191], a[0:3], v[44:47], 0
  v_mfma_f32_32x32x16_bf16 v[240:255], a[128:131], v[44:47], 0
  ds_read_b64_tr_b16 v[32:33], v11 offset:8192
  ds_read_b64_tr_b16 v[34:35], v11 offset:9216
  ds_read_b64_tr_b16 v[36:37], v12 offset:8192
  ds_read_b64_tr_b16 v[38:39], v12 offset:9216
  ds_read_b64_tr_b16 v[40:41], v13 offset:8192
  ds_read_b64_tr_b16 v[42:43], v13 offset:9216
  ds_read_b64_tr_b16 v[44:45], v14 offset:8192
  ds_read_b64_tr_b16 v[46:47], v14 offset:9216
  s_waitcnt lgkmcnt(8)
  v_mfma_f32_32x32x16_bf16 v[128:143], a[4:7], v[48:51], v[128:143]
  v_mfma_f32_32x32x16_bf16 v[192:207], a[132:135], v[48:51], v[192:207]
  v_mfma_f32_32x32x16_bf16 v[144:159], a[4:7], v[52:55], v[144:159]
  v_mfma_f32_32x32x16_bf16 v[208:223], a[132:135], v[52:55], v[208:223]
  s_add_u32 m0, s51, 66560
  s_add_u32 s63, s63, s72
  buffer_load_dwordx4 v4, s[16:19], s63 offen lds
  v_mfma_f32_32x32x16_bf16 v[160:175], a[4:7], v[56:59], v[160:175]
  v_mfma_f32_32x32x16_bf16 v[224:239], a[132:135], v[56:59], v[224:239]
  v_mfma_f32_32x32x16_bf16 v[176:191], a[4:7], v[60:63], v[176:191]
  v_mfma_f32_32x32x16_bf16 v[240:255], a[132:135], v[60:63], v[240:255]
  ds_read_b64_tr_b16 v[48:49], v11 offset:12288
  ds_read_b64_tr_b16 v[50:51], v11 offset:13312
  ds_read_b64_tr_b16 v[52:53], v12 offset:12288
  ds_read_b64_tr_b16 v[54:55], v12 offset:13312
  ds_read_b64_tr_b16 v[56:57], v13 offset:12288
  ds_read_b64_tr_b16 v[58:59], v13 offset:13312
  ds_read_b64_tr_b16 v[60:61], v14 offset:12288
  ds_read_b64_tr_b16 v[62:63], v14 offset:13312
  s_waitcnt lgkmcnt(8)
  v_mfma_f32_32x32x16_bf16 v[128:143], a[8:11], v[32:35], v[128:143]
  v_mfma_f32_32x32x16_bf16 v[192:207], a[136:139], v[32:35], v[192:207]
  v_mfma_f32_32x32x16_bf16 v[144:159], a[8:11], v[36:39], v[144:159]
  v_mfma_f32_32x32x16_bf16 v[208:223], a[136:139], v[36:39], v[208:223]
  s_add_u32 m0, s51, 67584
  s_add_u32 s63, s63, s72
  buffer_load_dwordx4 v4, s[16:19], s63 offen lds
  v_mfma_f32_32x32x16_bf16 v[160:175], a[8:11], v[40:43], v[160:175]
  v_mfma_f32_32x32x16_bf16 v[224:239], a[136:139], v[40:43], v[224:239]
  v_mfma_f32_32x32x16_bf16 v[176:191], a[8:11], v[44:47], v[176:191]
  v_mfma_f32_32x32x16_bf16 v[240:255], a[136:139], v[44:47], v[240:255]
  s_waitcnt lgkmcnt(0)
  v_mfma_f32_32x32x16_bf16 v[128:143], a[12:15], v[48:51], v[128:143]
  v_mfma_f32_32x32x16_bf16 v[192:207], a[140:143], v[48:51], v[192:207]
  v_mfma_f32_32x32x16_bf16 v[144:159], a[12:15], v[52:55], v[144:159]
  v_mfma_f32_32x32x16_bf16 v[208:223], a[140:143], v[52:55], v[208:223]
  s_add_u32 m0, s51, 68608
  s_add_u32 s63, s63, s72
  buffer_load_dwordx4 v4, s[16:19], s63 offen lds
  s_lshl_b32 s31, s45, 6
  s_add_u32 s55, s55, s31
  s_add_u32 s51, s51, 16384
  s_cmp_ge_u32 s51, 98304
  s_cselect_b32 s31, 98304, 0
  s_sub_u32 s51, s51, s31
  v_mfma_f32_32x32x16_bf16 v[160:175], a[12:15], v[56:59], v[160:175]
  v_mfma_f32_32x32x16_bf16 v[224:239], a[140:143], v[56:59], v[224:239]
  v_mfma_f32_32x32x16_bf16 v[176:191], a[12:15], v[60:63], v[176:191]
  v_mfma_f32_32x32x16_bf16 v[240:255], a[140:143], v[60:63], v[240:255]
  s_cmp_lg_u32 s93, 0
  s_cbranch_scc1 L_g1w_37
  s_waitcnt vmcnt(16)
L_g1w_37:
  s_waitcnt vmcnt(32)
  s_barrier
  v_add_u32 v11, s50, v24
  v_add_u32 v12, s50, v25
  v_add_u32 v13, s50, v26
  v_add_u32 v14, s50, v27
  ds_read_b64_tr_b16 v[32:33], v11 offset:0
  ds_read_b64_tr_b16 v[34:35], v11 offset:1024
  ds_read_b64_tr_b16 v[36:37], v12 offset:0
  ds_read_b64_tr_b16 v[38:39], v12 offset:1024
  ds_read_b64_tr_b16 v[40:41], v13 offset:0
  ds_read_b64_tr_b16 v[42:43], v13 offset:1024
  ds_read_b64_tr_b16 v[44:45], v14 offset:0
  ds_read_b64_tr_b16 v[46:47], v14 offset:1024
  s_add_u32 s50, s50, 16384
  s_cmp_ge_u32 s50, 98304
  s_cselect_b32 s31, 98304, 0
  s_sub_u32 s50, s50, s31
  ds_read_b64_tr_b16 v[48:49], v11 offset:4096
  ds_read_b64_tr_b16 v[50:51], v11 offset:5120
  ds_read_b64_tr_b16 v[52:53], v12 offset:4096
  ds_read_b64_tr_b16 v[54:55], v12 offset:5120
  ds_read_b64_tr_b16 v[56:57], v13 offset:4096
  ds_read_b64_tr_b16 v[58:59], v13 offset:5120
  ds_read_b64_tr_b16 v[60:61], v14 offset:4096
  ds_read_b64_tr_b16 v[62:63], v14 offset:5120
  s_waitcnt lgkmcnt(8)
  v_mfma_f32_32x32x16_bf16 v[128:143], a[16:19], v[32:35], v[128:143]
  v_mfma_f32_32x32x16_bf16 v[192:207], a[144:147], v[32:35], v[192:207]
  v_mfma_f32_32x32x16_bf16 v[144:159], a[16:19], v[36:39], v[144:159]
  v_mfma_f32_32x32x16_bf16 v[208:223], a[144:147], v[36:39], v[208:223]
  s_add_u32 m0, s51, 65536
  s_mov_b32 s63, s55
  buffer_load_dwordx4 v4, s[16:19], s63 offen lds
  v_mfma_f32_32x32x16_bf16 v[160:175], a[16:19], v[40:43], v[160:175]
  v_mfma_f32_32x32x16_bf16 v[224:239], a[144:147], v[40:43], v[224:239]
  v_mfma_f32_32x32x16_bf16 v[176:191], a[16:19], v[44:47], v[176:191]
  v_mfma_f32_32x32x16_bf16 v[240:255], a[144:147], v[44:47], v[240:255]
  ds_read_b64_tr_b16 v[32:33], v11 offset:8192
  ds_read_b64_tr_b16 v[34:35], v11 offset:9216
  ds_read_b64_tr_b16 v[36:37], v12 offset:8192
  ds_read_b64_tr_b16 v[38:39], v12 offset:9216
  ds_read_b64_tr_b16 v[40:41], v13 offset:8192
  ds_read_b64_tr_b16 v[42:43], v13 offset:9216
  ds_read_b64_tr_b16 v[44:45], v14 offset:8192
  ds_read_b64_tr_b16 v[46:47], v14 offset:9216
  s_waitcnt lgkmcnt(8)
  v_mfma_f32_32x32x16_bf16 v[128:143], a[20:23], v[48:51], v[128:143]
  v_mfma_f32_32x32x16_bf16 v[192:207], a[148:151], v[48:51], v[192:207]
  v_mfma_f32_32x32x16_bf16 v[144:159], a[20:23], v[52:55], v[144:159]
  v_mfma_f32_32x32x16_bf16 v[208:223], a[148:151], v[52:55], v[208:223]
  s_add_u32 m0, s51, 66560
  s_add_u32 s63, s63, s72
  buffer_load_dwordx4 v4, s[16:19], s63 offen lds
  v_mfma_f32_32x32x16_bf16 v[160:175], a[20:23], v[56:59], v[160:175]
  v_mfma_f32_32x32x16_bf16 v[224:239], a[148:151], v[56:59], v[224:239]
  v_mfma_f32_32x32x16_bf16 v[176:191], a[20:23], v[60:63], v[176:191]
  v_mfma_f32_32x32x16_bf16 v[240:255], a[148:151], v[60:63], v[240:255]
  ds_read_b64_tr_b16 v[48:49], v11 offset:12288
  ds_read_b64_tr_b16 v[50:51], v11 offset:13312
  ds_read_b64_tr_b16 v[52:53], v12 offset:12288
  ds_read_b64_tr_b16 v[54:55], v12 offset:13312
  ds_read_b64_tr_b16 v[56:57], v13 offset:12288
  ds_read_b64_tr_b16 v[58:59], v13 offset:13312
  ds_read_b64_tr_b16 v[60:61], v14 offset:12288
  ds_read_b64_tr_b16 v[62:63], v14 offset:13312
  s_waitcnt lgkmcnt(8)
  v_mfma_f32_32x32x16_bf16 v[128:143], a[24:27], v[32:35], v[128:143]
  v_mfma_f32_32x32x16_bf16 v[192:207], a[152:155], v[32:35], v[192:207]
  v_mfma_f32_32x32x16_bf16 v[144:159], a[24:27], v[36:39], v[144:159]
  v_mfma_f32_32x32x16_bf16 v[208:223], a[152:155], v[36:39], v[208:223]
  s_add_u32 m0, s51, 67584
  s_add_u32 s63, s63, s72
  buffer_load_dwordx4 v4, s[16:19], s63 offen lds
  v_mfma_f32_32x32x16_bf16 v[160:175], a[24:27], v[40:43], v[160:175]
  v_mfma_f32_32x32x16_bf16 v[224:239], a[152:155], v[40:43], v[224:239]
  v_mfma_f32_32x32x16_bf16 v[176:191], a[24:27], v[44:47], v[176:191]
  v_mfma_f32_32x32x16_bf16 v[240:255], a[152:155], v[44:47], v[240:255]
  s_waitcnt lgkmcnt(0)
  v_mfma_f32_32x32x16_bf16 v[128:143], a[28:31], v[48:51], v[128:143]
  v_mfma_f32_32x32x16_bf16 v[192:207], a[156:159], v[48:51], v[192:207]
  v_mfma_f32_32x32x16_bf16 v[144:159], a[28:31], v[52:55], v[144:159]
  v_mfma_f32_32x32x16_bf16 v[208:223], a[156:159], v[52:55], v[208:223]
  s_add_u32 m0, s51, 68608
  s_add_u32 s63, s63, s72
  buffer_load_dwordx4 v4, s[16:19], s63 offen lds
  s_lshl_b32 s31, s45, 6
  s_add_u32 s55, s55, s31
  s_add_u32 s51, s51, 16384
  s_cmp_ge_u32 s51, 98304
  s_cselect_b32 s31, 98304, 0
  s_sub_u32 s51, s51, s31
  v_mfma_f32_32x32x16_bf16 v[160:175], a[28:31], v[56:59], v[160:175]
  v_mfma_f32_32x32x16_bf16 v[224:239], a[156:159], v[56:59], v[224:239]
  v_mfma_f32_32x32x16_bf16 v[176:191], a[28:31], v[60:63], v[176:191]
  v_mfma_f32_32x32x16_bf16 v[240:255], a[156:159], v[60:63], v[240:255]
  s_cmp_eq_u32 s93, 0
  s_cbranch_scc1 L_g1w_38
  s_waitcnt vmcnt(8)
L_g1w_38:
  s_waitcnt vmcnt(16)
  s_barrier
  v_add_u32 v11, s50, v24
  v_add_u32 v12, s50, v25
  v_add_u32 v13, s50, v26
  v_add_u32 v14, s50, v27
  ds_read_b64_tr_b16 v[32:33], v11 offset:0
  ds_read_b64_tr_b16 v[34:35], v11 offset:1024
  ds_read_b64_tr_b16 v[36:37], v12 offset:0
  ds_read_b64_tr_b16 v[38:39], v12 offset:1024
  ds_read_b64_tr_b16 v[40:41], v13 offset:0
  ds_read_b64_tr_b16 v[42:43], v13 offset:1024
  ds_read_b64_tr_b16 v[44:45], v14 offset:0
  ds_read_b64_tr_b16 v[46:47], v14 offset:1024
  s_cmp_eq_u32 s93, 0
  s_cbranch_scc1 L_ps_39
  s_mov_b32 s31, s93
  s_mov_b32 s87, s68
  s_mov_b32 s83, s86
  s_mov_b32 s93, 0
  s_cmp_lg_u32 s29, 0
  s_cbranch_scc1 L_ps_39
  v_mov_b32 v17, 1
  v_mul_lo_u32 v22, v1, s90
  v_add_u32 v22, s88, v22
  v_writelane_b32 v22, s85, 0
  s_mov_b32 exec_lo, s31
  s_mov_b32 exec_hi, 0
  buffer_atomic_add v17, v22, s[4:7], 0 offen sc0
  s_mov_b64 exec, -1
L_ps_39:
  s_add_u32 s50, s50, 16384
  s_cmp_ge_u32 s50, 98304
  s_cselect_b32 s31, 98304, 0
  s_sub_u32 s50, s50, s31
  ds_read_b64_tr_b16 v[48:49], v11 offset:4096
  ds_read_b64_tr_b16 v[50:51], v11 offset:5120
  ds_read_b64_tr_b16 v[52:53], v12 offset:4096
  ds_read_b64_tr_b16 v[54:55], v12 offset:5120
  ds_read_b64_tr_b16 v[56:57], v13 offset:4096
  ds_read_b64_tr_b16 v[58:59], v13 offset:5120
  ds_read_b64_tr_b16 v[60:61], v14 offset:4096
  ds_read_b64_tr_b16 v[62:63], v14 offset:5120
  s_waitcnt lgkmcnt(8)
  v_mfma_f32_32x32x16_bf16 v[128:143], a[32:35], v[32:35], v[128:143]
  v_mfma_f32_32x32x16_bf16 v[192:207], a[160:163], v[32:35], v[192:207]
  v_mfma_f32_32x32x16_bf16 v[144:159], a[32:35], v[36:39], v[144:159]
  v_mfma_f32_32x32x16_bf16 v[208:223], a[160:163], v[36:39], v[208:223]
  s_add_u32 m0, s51, 65536
  s_mov_b32 s63, s55
  buffer_load_dwordx4 v4, s[16:19], s63 offen lds
  v_mfma_f32_32x32x16_bf16 v[160:175], a[32:35], v[40:43], v[160:175]
  v_mfma_f32_32x32x16_bf16 v[224:239], a[160:163], v[40:43], v[224:239]
  v_mfma_f32_32x32x16_bf16 v[176:191], a[32:35], v[44:47], v[176:191]
  v_mfma_f32_32x32x16_bf16 v[240:255], a[160:163], v[44:47], v[240:255]
  ds_read_b64_tr_b16 v[32:33], v11 offset:8192
  ds_read_b64_tr_b16 v[34:35], v11 offset:9216
  ds_read_b64_tr_b16 v[36:37], v12 offset:8192
  ds_read_b64_tr_b16 v[38:39], v12 offset:9216
  ds_read_b64_tr_b16 v[40:41], v13 offset:8192
  ds_read_b64_tr_b16 v[42:43], v13 offset:9216
  ds_read_b64_tr_b16 v[44:45], v14 offset:8192
  ds_read_b64_tr_b16 v[46:47], v14 offset:9216
  s_waitcnt lgkmcnt(8)
  v_mfma_f32_32x32x16_bf16 v[128:143], a[36:39], v[48:51], v[128:143]
  v_mfma_f32_32x32x16_bf16 v[192:207], a[164:167], v[48:51], v[192:207]
  v_mfma_f32_32x32x16_bf16 v[144:159], a[36:39], v[52:55], v[144:159]
  v_mfma_f32_32x32x16_bf16 v[208:223], a[164:167], v[52:55], v[208:223]
  s_add_u32 m0, s51, 66560
  s_add_u32 s63, s63, s72
  buffer_load_dwordx4 v4, s[16:19], s63 offen lds
  v_mfma_f32_32x32x16_bf16 v[160:175], a[36:39], v[56:59], v[160:175]
  v_mfma_f32_32x32x16_bf16 v[224:239], a[164:167], v[56:59], v[224:239]
  v_mfma_f32_32x32x16_bf16 v[176:191], a[36:39], v[60:63], v[176:191]
  v_mfma_f32_32x32x16_bf16 v[240:255], a[164:167], v[60:63], v[240:255]
  ds_read_b64_tr_b16 v[48:49], v11 offset:12288
  ds_read_b64_tr_b16 v[50:51], v11 offset:13312
  ds_read_b64_tr_b16 v[52:53], v12 offset:12288
  ds_read_b64_tr_b16 v[54:55], v12 offset:13312
  ds_read_b64_tr_b16 v[56:57], v13 offset:12288
  ds_read_b64_tr_b16 v[58:59], v13 offset:13312
  ds_read_b64_tr_b16 v[60:61], v14 offset:12288
  ds_read_b64_tr_b16 v[62:63], v14 offset:13312
  s_waitcnt lgkmcnt(8)
  v_mfma_f32_32x32x16_bf16 v[128:143], a[40:43], v[32:35], v[128:143]
  v_mfma_f32_32x32x16_bf16 v[192:207], a[168:171], v[32:35], v[192:207]
  v_mfma_f32_32x32x16_bf16 v[144:159], a[40:43], v[36:39], v[144:159]
  v_mfma_f32_32x32x16_bf16 v[208:223], a[168:171], v[36:39], v[208:223]
  s_add_u32 m0, s51, 67584
  s_add_u32 s63, s63, s72
  buffer_load_dwordx4 v4, s[16:19], s63 offen lds
  v_mfma_f32_32x32x16_bf16 v[160:175], a[40:43], v[40:43], v[160:175]
  v_mfma_f32_32x32x16_bf16 v[224:239], a[168:171], v[40:43], v[224:239]
  v_mfma_f32_32x32x16_bf16 v[176:191], a[40:43], v[44:47], v[176:191]
  v_mfma_f32_32x32x16_bf16 v[240:255], a[168:171], v[44:47], v[240:255]
  s_waitcnt lgkmcnt(0)
  v_mfma_f32_32x32x16_bf16 v[128:143], a[44:47], v[48:51], v[128:143]
  v_mfma_f32_32x32x16_bf16 v[192:207], a[172:175], v[48:51], v[192:207]
  v_mfma_f32_32x32x16_bf16 v[144:159], a[44:47], v[52:55], v[144:159]
  v_mfma_f32_32x32x16_bf16 v[208:223], a[172:175], v[52:55], v[208:223]
  s_add_u32 m0, s51, 68608
  s_add_u32 s63, s63, s72
  buffer_load_dwordx4 v4, s[16:19], s63 offen lds
  s_lshl_b32 s31, s45, 6
  s_add_u32 s55, s55, s31
  s_add_u32 s51, s51, 16384
  s_cmp_ge_u32 s51, 98304
  s_cselect_b32 s31, 98304, 0
  s_sub_u32 s51, s51, s31
  v_mfma_f32_32x32x16_bf16 v[160:175], a[44:47], v[56:59], v[160:175]
  v_mfma_f32_32x32x16_bf16 v[224:239], a[172:175], v[56:59], v[224:239]
  v_mfma_f32_32x32x16_bf16 v[176:191], a[44:47], v[60:63], v[176:191]
  v_mfma_f32_32x32x16_bf16 v[240:255], a[172:175], v[60:63], v[240:255]
  s_waitcnt vmcnt(16)
  s_barrier
  v_add_u32 v11, s50, v24
  v_add_u32 v12, s50, v25
  v_add_u32 v13, s50, v26
  v_add_u32 v14, s50, v27
  ds_read_b64_tr_b16 v[32:33], v11 offset:0
  ds_read_b64_tr_b16 v[34:35], v11 offset:1024
  ds_read_b64_tr_b16 v[36:37], v12 offset:0
  ds_read_b64_tr_b16 v[38:39], v12 offset:1024
  ds_read_b64_tr_b16 v[40:41], v13 offset:0
  ds_read_b64_tr_b16 v[42:43], v13 offset:1024
  ds_read_b64_tr_b16 v[44:45], v14 offset:0
  ds_read_b64_tr_b16 v[46:47], v14 offset:1024
  s_and_b32 s31, s43, 15
  s_bfe_u32 s32, s43, 0x8000c
  s_mov_b32 s16, s12
  s_mov_b32 s17, s13
  s_cmp_eq_u32 s31, 6
  s_cselect_b32 s16, s14, s16
  s_cselect_b32 s17, s15, s17
  s_cmp_eq_u32 s31, 1
  s_cselect_b32 s16, s20, s16
  s_cselect_b32 s17, s21, s17
  s_mov_b32 s18, 0x400000
  s_mov_b32 s45, 8192
  s_cmp_eq_u32 s31, 2
  s_cselect_b32 s16, s22, s16
  s_cselect_b32 s17, s23, s17
  s_cselect_b32 s18, 1835008, s18
  s_cselect_b32 s45, 3584, s45
  s_cselect_b64 vcc, -1, 0
  s_mov_b32 s19, 0x20000
  v_cndmask_b32 v4, v2, v3, vcc
  s_lshl_b32 s72, s45, 2
  s_lshl_b32 s33, s45, 4
  s_mul_i32 s33, s33, s29
  s_lshl_b32 s55, s32, 8
  s_add_u32 s55, s55, s33
  s_add_u32 s50, s50, 16384
  s_cmp_ge_u32 s50, 98304
  s_cselect_b32 s31, 98304, 0
  s_sub_u32 s50, s50, s31
  ds_read_b64_tr_b16 v[48:49], v11 offset:4096
  ds_read_b64_tr_b16 v[50:51], v11 offset:5120
  ds_read_b64_tr_b16 v[52:53], v12 offset:4096
  ds_read_b64_tr_b16 v[54:55], v12 offset:5120
  ds_read_b64_tr_b16 v[56:57], v13 offset:4096
  ds_read_b64_tr_b16 v[58:59], v13 offset:5120
  ds_read_b64_tr_b16 v[60:61], v14 offset:4096
  ds_read_b64_tr_b16 v[62:63], v14 offset:5120
  s_waitcnt lgkmcnt(8)
  v_mfma_f32_32x32x16_bf16 v[128:143], a[48:51], v[32:35], v[128:143]
  v_mfma_f32_32x32x16_bf16 v[192:207], a[176:179], v[32:35], v[192:207]
  v_mfma_f32_32x32x16_bf16 v[144:159], a[48:51], v[36:39], v[144:159]
  v_mfma_f32_32x32x16_bf16 v[208:223], a[176:179], v[36:39], v[208:223]
  s_add_u32 m0, s51, 65536
  s_mov_b32 s63, s55
  buffer_load_dwordx4 v4, s[16:19], s63 offen lds
  v_mfma_f32_32x32x16_bf16 v[160:175], a[48:51], v[40:43], v[160:175]
  v_mfma_f32_32x32x16_bf16 v[224:239], a[176:179], v[40:43], v[224:239]
  v_mfma_f32_32x32x16_bf16 v[176:191], a[48:51], v[44:47], v[176:191]
  v_mfma_f32_32x32x16_bf16 v[240:255], a[176:179], v[44:47], v[240:255]
  ds_read_b64_tr_b16 v[32:33], v11 offset:8192
  ds_read_b64_tr_b16 v[34:35], v11 offset:9216
  ds_read_b64_tr_b16 v[36:37], v12 offset:8192
  ds_read_b64_tr_b16 v[38:39], v12 offset:9216
  ds_read_b64_tr_b16 v[40:41], v13 offset:8192
  ds_read_b64_tr_b16 v[42:43], v13 offset:9216
  ds_read_b64_tr_b16 v[44:45], v14 offset:8192
  ds_read_b64_tr_b16 v[46:47], v14 offset:9216
  s_waitcnt lgkmcnt(8)
  v_mfma_f32_32x32x16_bf16 v[128:143], a[52:55], v[48:51], v[128:143]
  v_mfma_f32_32x32x16_bf16 v[192:207], a[180:183], v[48:51], v[192:207]
  v_mfma_f32_32x32x16_bf16 v[144:159], a[52:55], v[52:55], v[144:159]
  v_mfma_f32_32x32x16_bf16 v[208:223], a[180:183], v[52:55], v[208:223]
  s_add_u32 m0, s51, 66560
  s_add_u32 s63, s63, s72
  buffer_load_dwordx4 v4, s[16:19], s63 offen lds
  v_mfma_f32_32x32x16_bf16 v[160:175], a[52:55], v[56:59], v[160:175]
  v_mfma_f32_32x32x16_bf16 v[224:239], a[180:183], v[56:59], v[224:239]
  v_mfma_f32_32x32x16_bf16 v[176:191], a[52:55], v[60:63], v[176:191]
  v_mfma_f32_32x32x16_bf16 v[240:255], a[180:183], v[60:63], v[240:255]
  ds_read_b64_tr_b16 v[48:49], v11 offset:12288
  ds_read_b64_tr_b16 v[50:51], v11 offset:13312
  ds_read_b64_tr_b16 v[52:53], v12 offset:12288
  ds_read_b64_tr_b16 v[54:55], v12 offset:13312
  ds_read_b64_tr_b16 v[56:57], v13 offset:12288
  ds_read_b64_tr_b16 v[58:59], v13 offset:13312
  ds_read_b64_tr_b16 v[60:61], v14 offset:12288
  ds_read_b64_tr_b16 v[62:63], v14 offset:13312
  s_waitcnt lgkmcnt(8)
  v_mfma_f32_32x32x16_bf16 v[128:143], a[56:59], v[32:35], v[128:143]
  v_mfma_f32_32x32x16_bf16 v[192:207], a[184:187], v[32:35], v[192:207]
  v_mfma_f32_32x32x16_bf16 v[144:159], a[56:59], v[36:39], v[144:159]
  v_mfma_f32_32x32x16_bf16 v[208:223], a[184:187], v[36:39], v[208:223]
  s_add_u32 m0, s51, 67584
  s_add_u32 s63, s63, s72
  buffer_load_dwordx4 v4, s[16:19], s63 offen lds
  v_mfma_f32_32x32x16_bf16 v[160:175], a[56:59], v[40:43], v[160:175]
  v_mfma_f32_32x32x16_bf16 v[224:239], a[184:187], v[40:43], v[224:239]
  v_mfma_f32_32x32x16_bf16 v[176:191], a[56:59], v[44:47], v[176:191]
  v_mfma_f32_32x32x16_bf16 v[240:255], a[184:187], v[44:47], v[240:255]
  s_waitcnt lgkmcnt(0)
  v_mfma_f32_32x32x16_bf16 v[128:143], a[60:63], v[48:51], v[128:143]
  v_mfma_f32_32x32x16_bf16 v[192:207], a[188:191], v[48:51], v[192:207]
  v_mfma_f32_32x32x16_bf16 v[144:159], a[60:63], v[52:55], v[144:159]
  v_mfma_f32_32x32x16_bf16 v[208:223], a[188:191], v[52:55], v[208:223]
  s_add_u32 m0, s51, 68608
  s_add_u32 s63, s63, s72
  buffer_load_dwordx4 v4, s[16:19], s63 offen lds
  s_lshl_b32 s31, s45, 6
  s_add_u32 s55, s55, s31
  s_add_u32 s51, s51, 16384
  s_cmp_ge_u32 s51, 98304
  s_cselect_b32 s31, 98304, 0
  s_sub_u32 s51, s51, s31
  v_mfma_f32_32x32x16_bf16 v[160:175], a[60:63], v[56:59], v[160:175]
  v_mfma_f32_32x32x16_bf16 v[224:239], a[188:191], v[56:59], v[224:239]
  v_mfma_f32_32x32x16_bf16 v[176:191], a[60:63], v[60:63], v[176:191]
  v_mfma_f32_32x32x16_bf16 v[240:255], a[188:191], v[60:63], v[240:255]
  s_waitcnt vmcnt(16)
  s_barrier
  v_add_u32 v11, s50, v24
  v_add_u32 v12, s50, v25
  v_add_u32 v13, s50, v26
  v_add_u32 v14, s50, v27
  ds_read_b64_tr_b16 v[32:33], v11 offset:0
  ds_read_b64_tr_b16 v[34:35], v11 offset:1024
  ds_read_b64_tr_b16 v[36:37], v12 offset:0
  ds_read_b64_tr_b16 v[38:39], v12 offset:1024
  ds_read_b64_tr_b16 v[40:41], v13 offset:0
  ds_read_b64_tr_b16 v[42:43], v13 offset:1024
  ds_read_b64_tr_b16 v[44:45], v14 offset:0
  ds_read_b64_tr_b16 v[46:47], v14 offset:1024
  s_add_u32 s50, s50, 16384
  s_cmp_ge_u32 s50, 98304
  s_cselect_b32 s31, 98304, 0
  s_sub_u32 s50, s50, s31
  ds_read_b64_tr_b16 v[48:49], v11 offset:4096
  ds_read_b64_tr_b16 v[50:51], v11 offset:5120
  ds_read_b64_tr_b16 v[52:53], v12 offset:4096
  ds_read_b64_tr_b16 v[54:55], v12 offset:5120
  ds_read_b64_tr_b16 v[56:57], v13 offset:4096
  ds_read_b64_tr_b16 v[58:59], v13 offset:5120
  ds_read_b64_tr_b16 v[60:61], v14 offset:4096
  ds_read_b64_tr_b16 v[62:63], v14 offset:5120
  s_waitcnt lgkmcnt(8)
  v_mfma_f32_32x32x16_bf16 v[128:143], a[64:67], v[32:35], v[128:143]
  v_mfma_f32_32x32x16_bf16 v[192:207], a[192:195], v[32:35], v[192:207]
  v_mfma_f32_32x32x16_bf16 v[144:159], a[64:67], v[36:39], v[144:159]
  v_mfma_f32_32x32x16_bf16 v[208:223], a[192:195], v[36:39], v[208:223]
  s_add_u32 m0, s51, 65536
  s_mov_b32 s63, s55
  buffer_load_dwordx4 v4, s[16:19], s63 offen lds
  v_mfma_f32_32x32x16_bf16 v[160:175], a[64:67], v[40:43], v[160:175]
  v_mfma_f32_32x32x16_bf16 v[224:239], a[192:195], v[40:43], v[224:239]
  v_mfma_f32_32x32x16_bf16 v[176:191], a[64:67], v[44:47], v[176:191]
  v_mfma_f32_32x32x16_bf16 v[240:255], a[192:195], v[44:47], v[240:255]
  ds_read_b64_tr_b16 v[32:33], v11 offset:8192
  ds_read_b64_tr_b16 v[34:35], v11 offset:9216
  ds_read_b64_tr_b16 v[36:37], v12 offset:8192
  ds_read_b64_tr_b16 v[38:39], v12 offset:9216
  ds_read_b64_tr_b16 v[40:41], v13 offset:8192
  ds_read_b64_tr_b16 v[42:43], v13 offset:9216
  ds_read_b64_tr_b16 v[44:45], v14 offset:8192
  ds_read_b64_tr_b16 v[46:47], v14 offset:9216
  s_waitcnt lgkmcnt(8)
  v_mfma_f32_32x32x16_bf16 v[128:143], a[68:71], v[48:51], v[128:143]
  v_mfma_f32_32x32x16_bf16 v[192:207], a[196:199], v[48:51], v[192:207]
  v_mfma_f32_32x32x16_bf16 v[144:159], a[68:71], v[52:55], v[144:159]
  v_mfma_f32_32x32x16_bf16 v[208:223], a[196:199], v[52:55], v[208:223]
  s_add_u32 m0, s51, 66560
  s_add_u32 s63, s63, s72
  buffer_load_dwordx4 v4, s[16:19], s63 offen lds
  v_mfma_f32_32x32x16_bf16 v[160:175], a[68:71], v[56:59], v[160:175]
  v_mfma_f32_32x32x16_bf16 v[224:239], a[196:199], v[56:59], v[224:239]
  v_mfma_f32_32x32x16_bf16 v[176:191], a[68:71], v[60:63], v[176:191]
  v_mfma_f32_32x32x16_bf16 v[240:255], a[196:199], v[60:63], v[240:255]
  ds_read_b64_tr_b16 v[48:49], v11 offset:12288
  ds_read_b64_tr_b16 v[50:51], v11 offset:13312
  ds_read_b64_tr_b16 v[52:53], v12 offset:12288
  ds_read_b64_tr_b16 v[54:55], v12 offset:13312
  ds_read_b64_tr_b16 v[56:57], v13 offset:12288
  ds_read_b64_tr_b16 v[58:59], v13 offset:13312
  ds_read_b64_tr_b16 v[60:61], v14 offset:12288
  ds_read_b64_tr_b16 v[62:63], v14 offset:13312
  s_waitcnt lgkmcnt(8)
  v_mfma_f32_32x32x16_bf16 v[128:143], a[72:75], v[32:35], v[128:143]
  v_mfma_f32_32x32x16_bf16 v[192:207], a[200:203], v[32:35], v[192:207]
  v_mfma_f32_32x32x16_bf16 v[144:159], a[72:75], v[36:39], v[144:159]
  v_mfma_f32_32x32x16_bf16 v[208:223], a[200:203], v[36:39], v[208:223]
  s_add_u32 m0, s51, 67584
  s_add_u32 s63, s63, s72
  buffer_load_dwordx4 v4, s[16:19], s63 offen lds
  v_mfma_f32_32x32x16_bf16 v[160:175], a[72:75], v[40:43], v[160:175]
  v_mfma_f32_32x32x16_bf16 v[224:239], a[200:203], v[40:43], v[224:239]
  v_mfma_f32_32x32x16_bf16 v[176:191], a[72:75], v[44:47], v[176:191]
  v_mfma_f32_32x32x16_bf16 v[240:255], a[200:203], v[44:47], v[240:255]
  s_waitcnt lgkmcnt(0)
  v_mfma_f32_32x32x16_bf16 v[128:143], a[76:79], v[48:51], v[128:143]
  v_mfma_f32_32x32x16_bf16 v[192:207], a[204:207], v[48:51], v[192:207]
  v_mfma_f32_32x32x16_bf16 v[144:159], a[76:79], v[52:55], v[144:159]
  v_mfma_f32_32x32x16_bf16 v[208:223], a[204:207], v[52:55], v[208:223]
  s_add_u32 m0, s51, 68608
  s_add_u32 s63, s63, s72
  buffer_load_dwordx4 v4, s[16:19], s63 offen lds
  s_lshl_b32 s31, s45, 6
  s_add_u32 s55, s55, s31
  s_add_u32 s51, s51, 16384
  s_cmp_ge_u32 s51, 98304
  s_cselect_b32 s31, 98304, 0
  s_sub_u32 s51, s51, s31
  v_mfma_f32_32x32x16_bf16 v[160:175], a[76:79], v[56:59], v[160:175]
  v_mfma_f32_32x32x16_bf16 v[224:239], a[204:207], v[56:59], v[224:239]
  v_mfma_f32_32x32x16_bf16 v[176:191], a[76:79], v[60:63], v[176:191]
  v_mfma_f32_32x32x16_bf16 v[240:255], a[204:207], v[60:63], v[240:255]
  s_waitcnt vmcnt(16)
  s_barrier
  v_add_u32 v11, s50, v24
  v_add_u32 v12, s50, v25
  v_add_u32 v13, s50, v26
  v_add_u32 v14, s50, v27
  ds_read_b64_tr_b16 v[32:33], v11 offset:0
  ds_read_b64_tr_b16 v[34:35], v11 offset:1024
  ds_read_b64_tr_b16 v[36:37], v12 offset:0
  ds_read_b64_tr_b16 v[38:39], v12 offset:1024
  ds_read_b64_tr_b16 v[40:41], v13 offset:0
  ds_read_b64_tr_b16 v[42:43], v13 offset:1024
  ds_read_b64_tr_b16 v[44:45], v14 offset:0
  ds_read_b64_tr_b16 v[46:47], v14 offset:1024
  s_add_u32 s50, s50, 16384
  s_cmp_ge_u32 s50, 98304
  s_cselect_b32 s31, 98304, 0
  s_sub_u32 s50, s50, s31
  ds_read_b64_tr_b16 v[48:49], v11 offset:4096
  ds_read_b64_tr_b16 v[50:51], v11 offset:5120
  ds_read_b64_tr_b16 v[52:53], v12 offset:4096
  ds_read_b64_tr_b16 v[54:55], v12 offset:5120
  ds_read_b64_tr_b16 v[56:57], v13 offset:4096
  ds_read_b64_tr_b16 v[58:59], v13 offset:5120
  ds_read_b64_tr_b16 v[60:61], v14 offset:4096
  ds_read_b64_tr_b16 v[62:63], v14 offset:5120
  s_waitcnt lgkmcnt(8)
  v_mfma_f32_32x32x16_bf16 v[128:143], a[80:83], v[32:35], v[128:143]
  v_mfma_f32_32x32x16_bf16 v[192:207], a[208:211], v[32:35], v[192:207]
  v_mfma_f32_32x32x16_bf16 v[144:159], a[80:83], v[36:39], v[144:159]
  v_mfma_f32_32x32x16_bf16 v[208:223], a[208:211], v[36:39], v[208:223]
  s_add_u32 m0, s51, 65536
  s_mov_b32 s63, s55
  buffer_load_dwordx4 v4, s[16:19], s63 offen lds
  v_mfma_f32_32x32x16_bf16 v[160:175], a[80:83], v[40:43], v[160:175]
  v_mfma_f32_32x32x16_bf16 v[224:239], a[208:211], v[40:43], v[224:239]
  v_mfma_f32_32x32x16_bf16 v[176:191], a[80:83], v[44:47], v[176:191]
  v_mfma_f32_32x32x16_bf16 v[240:255], a[208:211], v[44:47], v[240:255]
  ds_read_b64_tr_b16 v[32:33], v11 offset:8192
  ds_read_b64_tr_b16 v[34:35], v11 offset:9216
  ds_read_b64_tr_b16 v[36:37], v12 offset:8192
  ds_read_b64_tr_b16 v[38:39], v12 offset:9216
  ds_read_b64_tr_b16 v[40:41], v13 offset:8192
  ds_read_b64_tr_b16 v[42:43], v13 offset:9216
  ds_read_b64_tr_b16 v[44:45], v14 offset:8192
  ds_read_b64_tr_b16 v[46:47], v14 offset:9216
  s_waitcnt lgkmcnt(8)
  v_mfma_f32_32x32x16_bf16 v[128:143], a[84:87], v[48:51], v[128:143]
  v_mfma_f32_32x32x16_bf16 v[192:207], a[212:215], v[48:51], v[192:207]
  v_mfma_f32_32x32x16_bf16 v[144:159], a[84:87], v[52:55], v[144:159]
  v_mfma_f32_32x32x16_bf16 v[208:223], a[212:215], v[52:55], v[208:223]
  s_add_u32 m0, s51, 66560
  s_add_u32 s63, s63, s72
  buffer_load_dwordx4 v4, s[16:19], s63 offen lds
  v_mfma_f32_32x32x16_bf16 v[160:175], a[84:87], v[56:59], v[160:175]
  v_mfma_f32_32x32x16_bf16 v[224:239], a[212:215], v[56:59], v[224:239]
  v_mfma_f32_32x32x16_bf16 v[176:191], a[84:87], v[60:63], v[176:191]
  v_mfma_f32_32x32x16_bf16 v[240:255], a[212:215], v[60:63], v[240:255]
  ds_read_b64_tr_b16 v[48:49], v11 offset:12288
  ds_read_b64_tr_b16 v[50:51], v11 offset:13312
  ds_read_b64_tr_b16 v[52:53], v12 offset:12288
  ds_read_b64_tr_b16 v[54:55], v12 offset:13312
  ds_read_b64_tr_b16 v[56:57], v13 offset:12288
  ds_read_b64_tr_b16 v[58:59], v13 offset:13312
  ds_read_b64_tr_b16 v[60:61], v14 offset:12288
  ds_read_b64_tr_b16 v[62:63], v14 offset:13312
  s_waitcnt lgkmcnt(8)
  v_mfma_f32_32x32x16_bf16 v[128:143], a[88:91], v[32:35], v[128:143]
  v_mfma_f32_32x32x16_bf16 v[192:207], a[216:219], v[32:35], v[192:207]
  v_mfma_f32_32x32x16_bf16 v[144:159], a[88:91], v[36:39], v[144:159]
  v_mfma_f32_32x32x16_bf16 v[208:223], a[216:219], v[36:39], v[208:223]
  s_add_u32 m0, s51, 67584
  s_add_u32 s63, s63, s72
  buffer_load_dwordx4 v4, s[16:19], s63 offen lds
  v_mfma_f32_32x32x16_bf16 v[160:175], a[88:91], v[40:43], v[160:175]
  v_mfma_f32_32x32x16_bf16 v[224:239], a[216:219], v[40:43], v[224:239]
  v_mfma_f32_32x32x16_bf16 v[176:191], a[88:91], v[44:47], v[176:191]
  v_mfma_f32_32x32x16_bf16 v[240:255], a[216:219], v[44:47], v[240:255]
  s_waitcnt lgkmcnt(0)
  v_mfma_f32_32x32x16_bf16 v[128:143], a[92:95], v[48:51], v[128:143]
  v_mfma_f32_32x32x16_bf16 v[192:207], a[220:223], v[48:51], v[192:207]
  v_mfma_f32_32x32x16_bf16 v[144:159], a[92:95], v[52:55], v[144:159]
  v_mfma_f32_32x32x16_bf16 v[208:223], a[220:223], v[52:55], v[208:223]
  s_add_u32 m0, s51, 68608
  s_add_u32 s63, s63, s72
  buffer_load_dwordx4 v4, s[16:19], s63 offen lds
  s_lshl_b32 s31, s45, 6
  s_add_u32 s55, s55, s31
  s_add_u32 s51, s51, 16384
  s_cmp_ge_u32 s51, 98304
  s_cselect_b32 s31, 98304, 0
  s_sub_u32 s51, s51, s31
  v_mfma_f32_32x32x16_bf16 v[160:175], a[92:95], v[56:59], v[160:175]
  v_mfma_f32_32x32x16_bf16 v[224:239], a[220:223], v[56:59], v[224:239]
  v_mfma_f32_32x32x16_bf16 v[176:191], a[92:95], v[60:63], v[176:191]
  v_mfma_f32_32x32x16_bf16 v[240:255], a[220:223], v[60:63], v[240:255]
  s_waitcnt vmcnt(16)
  s_barrier
  v_add_u32 v11, s50, v24
  v_add_u32 v12, s50, v25
  v_add_u32 v13, s50, v26
  v_add_u32 v14, s50, v27
  ds_read_b64_tr_b16 v[32:33], v11 offset:0
  ds_read_b64_tr_b16 v[34:35], v11 offset:1024
  ds_read_b64_tr_b16 v[36:37], v12 offset:0
  ds_read_b64_tr_b16 v[38:39], v12 offset:1024
  ds_read_b64_tr_b16 v[40:41], v13 offset:0
  ds_read_b64_tr_b16 v[42:43], v13 offset:1024
  ds_read_b64_tr_b16 v[44:45], v14 offset:0
  ds_read_b64_tr_b16 v[46:47], v14 offset:1024
  s_add_u32 s50, s50, 16384
  s_cmp_ge_u32 s50, 98304
  s_cselect_b32 s31, 98304, 0
  s_sub_u32 s50, s50, s31
  ds_read_b64_tr_b16 v[48:49], v11 offset:4096
  ds_read_b64_tr_b16 v[50:51], v11 offset:5120
  ds_read_b64_tr_b16 v[52:53], v12 offset:4096
  ds_read_b64_tr_b16 v[54:55], v12 offset:5120
  ds_read_b64_tr_b16 v[56:57], v13 offset:4096
  ds_read_b64_tr_b16 v[58:59], v13 offset:5120
  ds_read_b64_tr_b16 v[60:61], v14 offset:4096
  ds_read_b64_tr_b16 v[62:63], v14 offset:5120
  s_waitcnt lgkmcnt(8)
  v_mfma_f32_32x32x16_bf16 v[128:143], a[96:99], v[32:35], v[128:143]
  v_mfma_f32_32x32x16_bf16 v[192:207], a[224:227], v[32:35], v[192:207]
  v_mfma_f32_32x32x16_bf16 v[144:159], a[96:99], v[36:39], v[144:159]
  v_mfma_f32_32x32x16_bf16 v[208:223], a[224:227], v[36:39], v[208:223]
  s_add_u32 m0, s51, 65536
  s_mov_b32 s63, s55
  buffer_load_dwordx4 v4, s[16:19], s63 offen lds
  v_mfma_f32_32x32x16_bf16 v[160:175], a[96:99], v[40:43], v[160:175]
  v_mfma_f32_32x32x16_bf16 v[224:239], a[224:227], v[40:43], v[224:239]
  v_mfma_f32_32x32x16_bf16 v[176:191], a[96:99], v[44:47], v[176:191]
  v_mfma_f32_32x32x16_bf16 v[240:255], a[224:227], v[44:47], v[240:255]
  ds_read_b64_tr_b16 v[32:33], v11 offset:8192
  ds_read_b64_tr_b16 v[34:35], v11 offset:9216
  ds_read_b64_tr_b16 v[36:37], v12 offset:8192
  ds_read_b64_tr_b16 v[38:39], v12 offset:9216
  ds_read_b64_tr_b16 v[40:41], v13 offset:8192
  ds_read_b64_tr_b16 v[42:43], v13 offset:9216
  ds_read_b64_tr_b16 v[44:45], v14 offset:8192
  ds_read_b64_tr_b16 v[46:47], v14 offset:9216
  s_waitcnt lgkmcnt(8)
  v_mfma_f32_32x32x16_bf16 v[128:143], a[100:103], v[48:51], v[128:143]
  v_mfma_f32_32x32x16_bf16 v[192:207], a[228:231], v[48:51], v[192:207]
  v_mfma_f32_32x32x16_bf16 v[144:159], a[100:103], v[52:55], v[144:159]
  v_mfma_f32_32x32x16_bf16 v[208:223], a[228:231], v[52:55], v[208:223]
  s_add_u32 m0, s51, 66560
  s_add_u32 s63, s63, s72
  buffer_load_dwordx4 v4, s[16:19], s63 offen lds
  v_mfma_f32_32x32x16_bf16 v[160:175], a[100:103], v[56:59], v[160:175]
  v_mfma_f32_32x32x16_bf16 v[224:239], a[228:231], v[56:59], v[224:239]
  v_mfma_f32_32x32x16_bf16 v[176:191], a[100:103], v[60:63], v[176:191]
  v_mfma_f32_32x32x16_bf16 v[240:255], a[228:231], v[60:63], v[240:255]
  ds_read_b64_tr_b16 v[48:49], v11 offset:12288
  ds_read_b64_tr_b16 v[50:51], v11 offset:13312
  ds_read_b64_tr_b16 v[52:53], v12 offset:12288
  ds_read_b64_tr_b16 v[54:55], v12 offset:13312
  ds_read_b64_tr_b16 v[56:57], v13 offset:12288
  ds_read_b64_tr_b16 v[58:59], v13 offset:13312
  ds_read_b64_tr_b16 v[60:61], v14 offset:12288
  ds_read_b64_tr_b16 v[62:63], v14 offset:13312
  s_waitcnt lgkmcnt(8)
  v_mfma_f32_32x32x16_bf16 v[128:143], a[104:107], v[32:35], v[128:143]
  v_mfma_f32_32x32x16_bf16 v[192:207], a[232:235], v[32:35], v[192:207]
  v_mfma_f32_32x32x16_bf16 v[144:159], a[104:107], v[36:39], v[144:159]
  v_mfma_f32_32x32x16_bf16 v[208:223], a[232:235], v[36:39], v[208:223]
  s_add_u32 m0, s51, 67584
  s_add_u32 s63, s63, s72
  buffer_load_dwordx4 v4, s[16:19], s63 offen lds
  v_mfma_f32_32x32x16_bf16 v[160:175], a[104:107], v[40:43], v[160:175]
  v_mfma_f32_32x32x16_bf16 v[224:239], a[232:235], v[40:43], v[224:239]
  v_mfma_f32_32x32x16_bf16 v[176:191], a[104:107], v[44:47], v[176:191]
  v_mfma_f32_32x32x16_bf16 v[240:255], a[232:235], v[44:47], v[240:255]
  s_waitcnt lgkmcnt(0)
  v_mfma_f32_32x32x16_bf16 v[128:143], a[108:111], v[48:51], v[128:143]
  v_mfma_f32_32x32x16_bf16 v[192:207], a[236:239], v[48:51], v[192:207]
  v_mfma_f32_32x32x16_bf16 v[144:159], a[108:111], v[52:55], v[144:159]
  v_mfma_f32_32x32x16_bf16 v[208:223], a[236:239], v[52:55], v[208:223]
  s_add_u32 m0, s51, 68608
  s_add_u32 s63, s63, s72
  buffer_load_dwordx4 v4, s[16:19], s63 offen lds
  s_lshl_b32 s31, s45, 6
  s_add_u32 s55, s55, s31
  s_add_u32 s51, s51, 16384
  s_cmp_ge_u32 s51, 98304
  s_cselect_b32 s31, 98304, 0
  s_sub_u32 s51, s51, s31
  v_mfma_f32_32x32x16_bf16 v[160:175], a[108:111], v[56:59], v[160:175]
  v_mfma_f32_32x32x16_bf16 v[224:239], a[236:239], v[56:59], v[224:239]
  v_mfma_f32_32x32x16_bf16 v[176:191], a[108:111], v[60:63], v[176:191]
  v_mfma_f32_32x32x16_bf16 v[240:255], a[236:239], v[60:63], v[240:255]
  s_waitcnt vmcnt(16)
  s_barrier
  v_add_u32 v11, s50, v24
  v_add_u32 v12, s50, v25
  v_add_u32 v13, s50, v26
  v_add_u32 v14, s50, v27
  ds_read_b64_tr_b16 v[32:33], v11 offset:0
  ds_read_b64_tr_b16 v[34:35], v11 offset:1024
  ds_read_b64_tr_b16 v[36:37], v12 offset:0
  ds_read_b64_tr_b16 v[38:39], v12 offset:1024
  ds_read_b64_tr_b16 v[40:41], v13 offset:0
  ds_read_b64_tr_b16 v[42:43], v13 offset:1024
  ds_read_b64_tr_b16 v[44:45], v14 offset:0
  ds_read_b64_tr_b16 v[46:47], v14 offset:1024
  s_cmp_eq_u32 s87, 0
  s_mov_b32 s31, s87
  s_mov_b32 s87, 0
  s_cbranch_scc1 L_pt_45
  s_cmp_lg_u32 s29, 0
  s_cbranch_scc1 L_pt_45
  v_lshlrev_b32 v22, 7, v1
  v_mov_b32 v21, 1
  s_and_b32 s32, s83, 255
  s_lshr_b32 exec_lo, s83, 8
  s_mov_b32 exec_hi, 0
  v_cmp_eq_u32 vcc, s32, v17
  s_and_b64 exec, exec, vcc
  s_cbranch_execz L_pt_45x
  buffer_store_dword v21, v22, s[4:7], s31 offen sc1
L_pt_45x:
  s_mov_b64 exec, -1
L_pt_45:
  s_add_u32 s50, s50, 16384
  s_cmp_ge_u32 s50, 98304
  s_cselect_b32 s31, 98304, 0
  s_sub_u32 s50, s50, s31
  ds_read_b64_tr_b16 v[48:49], v11 offset:4096
  ds_read_b64_tr_b16 v[50:51], v11 offset:5120
  ds_read_b64_tr_b16 v[52:53], v12 offset:4096
  ds_read_b64_tr_b16 v[54:55], v12 offset:5120
  ds_read_b64_tr_b16 v[56:57], v13 offset:4096
  ds_read_b64_tr_b16 v[58:59], v13 offset:5120
  ds_read_b64_tr_b16 v[60:61], v14 offset:4096
  ds_read_b64_tr_b16 v[62:63], v14 offset:5120
  s_waitcnt lgkmcnt(8)
  v_mfma_f32_32x32x16_bf16 v[128:143], a[112:115], v[32:35], v[128:143]
  v_mfma_f32_32x32x16_bf16 v[192:207], a[240:243], v[32:35], v[192:207]
  v_mfma_f32_32x32x16_bf16 v[144:159], a[112:115], v[36:39], v[144:159]
  v_mfma_f32_32x32x16_bf16 v[208:223], a[240:243], v[36:39], v[208:223]
  s_add_u32 m0, s51, 65536
  s_mov_b32 s63, s55
  buffer_load_dwordx4 v4, s[16:19], s63 offen lds
  v_mfma_f32_32x32x16_bf16 v[160:175], a[112:115], v[40:43], v[160:175]
  v_mfma_f32_32x32x16_bf16 v[224:239], a[240:243], v[40:43], v[224:239]
  v_mfma_f32_32x32x16_bf16 v[176:191], a[112:115], v[44:47], v[176:191]
  v_mfma_f32_32x32x16_bf16 v[240:255], a[240:243], v[44:47], v[240:255]
  ds_read_b64_tr_b16 v[32:33], v11 offset:8192
  ds_read_b64_tr_b16 v[34:35], v11 offset:9216
  ds_read_b64_tr_b16 v[36:37], v12 offset:8192
  ds_read_b64_tr_b16 v[38:39], v12 offset:9216
  ds_read_b64_tr_b16 v[40:41], v13 offset:8192
  ds_read_b64_tr_b16 v[42:43], v13 offset:9216
  ds_read_b64_tr_b16 v[44:45], v14 offset:8192
  ds_read_b64_tr_b16 v[46:47], v14 offset:9216
  s_waitcnt lgkmcnt(8)
  v_mfma_f32_32x32x16_bf16 v[128:143], a[116:119], v[48:51], v[128:143]
  v_mfma_f32_32x32x16_bf16 v[192:207], a[244:247], v[48:51], v[192:207]
  v_mfma_f32_32x32x16_bf16 v[144:159], a[116:119], v[52:55], v[144:159]
  v_mfma_f32_32x32x16_bf16 v[208:223], a[244:247], v[52:55], v[208:223]
  s_add_u32 m0, s51, 66560
  s_add_u32 s63, s63, s72
  buffer_load_dwordx4 v4, s[16:19], s63 offen lds
  v_mfma_f32_32x32x16_bf16 v[160:175], a[116:119], v[56:59], v[160:175]
  v_mfma_f32_32x32x16_bf16 v[224:239], a[244:247], v[56:59], v[224:239]
  v_mfma_f32_32x32x16_bf16 v[176:191], a[116:119], v[60:63], v[176:191]
  v_mfma_f32_32x32x16_bf16 v[240:255], a[244:247], v[60:63], v[240:255]
  ds_read_b64_tr_b16 v[48:49], v11 offset:12288
  ds_read_b64_tr_b16 v[50:51], v11 offset:13312
  ds_read_b64_tr_b16 v[52:53], v12 offset:12288
  ds_read_b64_tr_b16 v[54:55], v12 offset:13312
  ds_read_b64_tr_b16 v[56:57], v13 offset:12288
  ds_read_b64_tr_b16 v[58:59], v13 offset:13312
  ds_read_b64_tr_b16 v[60:61], v14 offset:12288
  ds_read_b64_tr_b16 v[62:63], v14 offset:13312
  s_waitcnt lgkmcnt(8)
  v_mfma_f32_32x32x16_bf16 v[128:143], a[120:123], v[32:35], v[128:143]
  v_mfma_f32_32x32x16_bf16 v[192:207], a[248:251], v[32:35], v[192:207]
  v_mfma_f32_32x32x16_bf16 v[144:159], a[120:123], v[36:39], v[144:159]
  v_mfma_f32_32x32x16_bf16 v[208:223], a[248:251], v[36:39], v[208:223]
  s_add_u32 m0, s51, 67584
  s_add_u32 s63, s63, s72
  buffer_load_dwordx4 v4, s[16:19], s63 offen lds
  v_mfma_f32_32x32x16_bf16 v[160:175], a[120:123], v[40:43], v[160:175]
  v_mfma_f32_32x32x16_bf16 v[224:239], a[248:251], v[40:43], v[224:239]
  v_mfma_f32_32x32x16_bf16 v[176:191], a[120:123], v[44:47], v[176:191]
  v_mfma_f32_32x32x16_bf16 v[240:255], a[248:251], v[44:47], v[240:255]
  s_waitcnt lgkmcnt(0)
  v_mfma_f32_32x32x16_bf16 v[128:143], a[124:127], v[48:51], v[128:143]
  v_mfma_f32_32x32x16_bf16 v[192:207], a[252:255], v[48:51], v[192:207]
  v_mfma_f32_32x32x16_bf16 v[144:159], a[124:127], v[52:55], v[144:159]
  v_mfma_f32_32x32x16_bf16 v[208:223], a[252:255], v[52:55], v[208:223]
  s_add_u32 m0, s51, 68608
  s_add_u32 s63, s63, s72
  buffer_load_dwordx4 v4, s[16:19], s63 offen lds
  s_lshl_b32 s31, s45, 6
  s_add_u32 s55, s55, s31
  s_add_u32 s51, s51, 16384
  s_cmp_ge_u32 s51, 98304
  s_cselect_b32 s31, 98304, 0
  s_sub_u32 s51, s51, s31
  v_mfma_f32_32x32x16_bf16 v[160:175], a[124:127], v[56:59], v[160:175]
  v_mfma_f32_32x32x16_bf16 v[224:239], a[252:255], v[56:59], v[224:239]
  v_mfma_f32_32x32x16_bf16 v[176:191], a[124:127], v[60:63], v[176:191]
  v_mfma_f32_32x32x16_bf16 v[240:255], a[252:255], v[60:63], v[240:255]
  s_nop 15
  s_bfe_u32 s61, s41, 0x8000c
  s_lshl_b32 s56, s42, 8
  s_add_u32 s56, s56, s61
  s_lshl_b32 s56, s56, 13
  s_add_u32 s88, s56, 133961728
  s_mov_b32 s90, 262144
  s_lshl_b32 s85, s61, 6
  s_add_u32 s85, s85, 0
  s_lshl_b32 s68, s61, 7
  s_add_u32 s68, s68, 34944
  s_mov_b32 s86, 279
  s_mov_b32 s93, 511
  s_add_u32 s56, s56, 33554432
  v_lshrrev_b32 v21, 5, v1
  v_bfe_u32 v22, v1, 3, 1
  v_bfe_u32 v23, v1, 4, 1
  v_and_b32 v30, 7, v1
  v_lshl_add_u32 v30, v23, 3, v30
  v_lshl_add_u32 v30, v21, 4, v30
  v_lshlrev_b32 v18, 4, v30
  v_lshl_add_u32 v18, v22, 10, v18
  s_lshl_b32 s31, s29, 14
  s_add_u32 s31, s31, 0
  v_add_u32 v18, s31, v18
  v_lshlrev_b32 v21, 4, v1
  v_add_u32 v22, s31, v21
  v_cvt_pk_bf16_f32 v64, v128, v129
  v_cvt_pk_bf16_f32 v65, v130, v131
  v_cvt_pk_bf16_f32 v66, v136, v137
  v_cvt_pk_bf16_f32 v67, v138, v139
  ds_write_b128 v18, v[64:67] offset:0
  v_cvt_pk_bf16_f32 v68, v132, v133
  v_cvt_pk_bf16_f32 v69, v134, v135
  v_cvt_pk_bf16_f32 v70, v140, v141
  v_cvt_pk_bf16_f32 v71, v142, v143
  ds_write_b128 v18, v[68:71] offset:512
  v_cvt_pk_bf16_f32 v72, v144, v145
  v_cvt_pk_bf16_f32 v73, v146, v147
  v_cvt_pk_bf16_f32 v74, v152, v153
  v_cvt_pk_bf16_f32 v75, v154, v155
  ds_write_b128 v18, v[72:75] offset:2048
  v_cvt_pk_bf16_f32 v76, v148, v149
  v_cvt_pk_bf16_f32 v77, v150, v151
  v_cvt_pk_bf16_f32 v78, v156, v157
  v_cvt_pk_bf16_f32 v79, v158, v159
  ds_write_b128 v18, v[76:79] offset:2560
  v_cvt_pk_bf16_f32 v64, v160, v161
  v_cvt_pk_bf16_f32 v65, v162, v163
  v_cvt_pk_bf16_f32 v66, v168, v169
  v_cvt_pk_bf16_f32 v67, v170, v171
  ds_write_b128 v18, v[64:67] offset:4096
  v_cvt_pk_bf16_f32 v68, v164, v165
  v_cvt_pk_bf16_f32 v69, v166, v167
  v_cvt_pk_bf16_f32 v70, v172, v173
  v_cvt_pk_bf16_f32 v71, v174, v175
  ds_write_b128 v18, v[68:71] offset:4608
  v_cvt_pk_bf16_f32 v72, v176, v177
  v_cvt_pk_bf16_f32 v73, v178, v179
  v_cvt_pk_bf16_f32 v74, v184, v185
  v_cvt_pk_bf16_f32 v75, v186, v187
  ds_write_b128 v18, v[72:75] offset:6144
  v_cvt_pk_bf16_f32 v76, v180, v181
  v_cvt_pk_bf16_f32 v77, v182, v183
  v_cvt_pk_bf16_f32 v78, v188, v189
  v_cvt_pk_bf16_f32 v79, v190, v191
  ds_write_b128 v18, v[76:79] offset:6656
  v_cvt_pk_bf16_f32 v64, v192, v193
  v_cvt_pk_bf16_f32 v65, v194, v195
  v_cvt_pk_bf16_f32 v66, v200, v201
  v_cvt_pk_bf16_f32 v67, v202, v203
  ds_write_b128 v18, v[64:67] offset:8192
  v_cvt_pk_bf16_f32 v68, v196, v197
  v_cvt_pk_bf16_f32 v69, v198, v199
  v_cvt_pk_bf16_f32 v70, v204, v205
  v_cvt_pk_bf16_f32 v71, v206, v207
  ds_write_b128 v18, v[68:71] offset:8704
  v_cvt_pk_bf16_f32 v72, v208, v209
  v_cvt_pk_bf16_f32 v73, v210, v211
  v_cvt_pk_bf16_f32 v74, v216, v217
  v_cvt_pk_bf16_f32 v75, v218, v219
  ds_write_b128 v18, v[72:75] offset:10240
  v_cvt_pk_bf16_f32 v76, v212, v213
  v_cvt_pk_bf16_f32 v77, v214, v215
  v_cvt_pk_bf16_f32 v78, v220, v221
  v_cvt_pk_bf16_f32 v79, v222, v223
  ds_write_b128 v18, v[76:79] offset:10752
  v_cvt_pk_bf16_f32 v64, v224, v225
  v_cvt_pk_bf16_f32 v65, v226, v227
  v_cvt_pk_bf16_f32 v66, v232, v233
  v_cvt_pk_bf16_f32 v67, v234, v235
  ds_write_b128 v18, v[64:67] offset:12288
  v_cvt_pk_bf16_f32 v68, v228, v229
  v_cvt_pk_bf16_f32 v69, v230, v231
  v_cvt_pk_bf16_f32 v70, v236, v237
  v_cvt_pk_bf16_f32 v71, v238, v239
  ds_write_b128 v18, v[68:71] offset:12800
  v_cvt_pk_bf16_f32 v72, v240, v241
  v_cvt_pk_bf16_f32 v73, v242, v243
  v_cvt_pk_bf16_f32 v74, v248, v249
  v_cvt_pk_bf16_f32 v75, v250, v251
  ds_write_b128 v18, v[72:75] offset:14336
  v_cvt_pk_bf16_f32 v76, v244, v245
  v_cvt_pk_bf16_f32 v77, v246, v247
  v_cvt_pk_bf16_f32 v78, v252, v253
  v_cvt_pk_bf16_f32 v79, v254, v255
  ds_write_b128 v18, v[76:79] offset:14848
  s_lshl_b32 s31, s29, 19
  s_add_u32 s62, s56, s31
  ds_read_b128 v[64:67], v22 offset:0
  ds_read_b128 v[68:71], v22 offset:1024
  ds_read_b128 v[72:75], v22 offset:2048
  ds_read_b128 v[76:79], v22 offset:3072
  ds_read_b128 v[80:83], v22 offset:4096
  ds_read_b128 v[84:87], v22 offset:5120
  ds_read_b128 v[88:91], v22 offset:6144
  ds_read_b128 v[92:95], v22 offset:7168
  ds_read_b128 v[96:99], v22 offset:8192
  ds_read_b128 v[100:103], v22 offset:9216
  ds_read_b128 v[104:107], v22 offset:10240
  ds_read_b128 v[108:111], v22 offset:11264
  ds_read_b128 v[112:115], v22 offset:12288
  ds_read_b128 v[116:119], v22 offset:13312
  ds_read_b128 v[120:123], v22 offset:14336
  ds_read_b128 v[124:127], v22 offset:15360
  s_waitcnt lgkmcnt(15)
  buffer_store_dwordx4 v[64:67], v21, s[4:7], s62 offen offset:0 sc1
  s_waitcnt lgkmcnt(14)
  buffer_store_dwordx4 v[68:71], v21, s[4:7], s62 offen offset:1024 sc1
  s_waitcnt lgkmcnt(13)
  buffer_store_dwordx4 v[72:75], v21, s[4:7], s62 offen offset:2048 sc1
  s_waitcnt lgkmcnt(12)
  buffer_store_dwordx4 v[76:79], v21, s[4:7], s62 offen offset:3072 sc1
  s_add_u32 s62, s62, 4096
  s_waitcnt lgkmcnt(11)
  buffer_store_dwordx4 v[80:83], v21, s[4:7], s62 offen offset:0 sc1
  s_waitcnt lgkmcnt(10)
  buffer_store_dwordx4 v[84:87], v21, s[4:7], s62 offen offset:1024 sc1
  s_waitcnt lgkmcnt(9)
  buffer_store_dwordx4 v[88:91], v21, s[4:7], s62 offen offset:2048 sc1
  s_waitcnt lgkmcnt(8)
  buffer_store_dwordx4 v[92:95], v21, s[4:7], s62 offen offset:3072 sc1
  s_add_u32 s62, s62, 258048
  s_waitcnt lgkmcnt(7)
  buffer_store_dwordx4 v[96:99], v21, s[4:7], s62 offen offset:0 sc1
  s_waitcnt lgkmcnt(6)
  buffer_store_dwordx4 v[100:103], v21, s[4:7], s62 offen offset:1024 sc1
  s_waitcnt lgkmcnt(5)
  buffer_store_dwordx4 v[104:107], v21, s[4:7], s62 offen offset:2048 sc1
  s_waitcnt lgkmcnt(4)
  buffer_store_dwordx4 v[108:111], v21, s[4:7], s62 offen offset:3072 sc1
  s_add_u32 s62, s62, 4096
  s_waitcnt lgkmcnt(3)
  buffer_store_dwordx4 v[112:115], v21, s[4:7], s62 offen offset:0 sc1
  s_waitcnt lgkmcnt(2)
  buffer_store_dwordx4 v[116:119], v21, s[4:7], s62 offen offset:1024 sc1
  s_waitcnt lgkmcnt(1)
  buffer_store_dwordx4 v[120:123], v21, s[4:7], s62 offen offset:2048 sc1
  s_waitcnt lgkmcnt(0)
  buffer_store_dwordx4 v[124:127], v21, s[4:7], s62 offen offset:3072 sc1
  s_add_u32 s62, s62, 4096
L_g1n:
  s_cmp_lg_u32 s42, 0
  s_cbranch_scc1 L_g1n2
  s_waitcnt vmcnt(0)
  s_barrier
  s_cmp_eq_u32 s93, 0
  s_cbranch_scc1 L_ps_46
  s_mov_b32 s31, s93
  s_mov_b32 s87, s68
  s_mov_b32 s83, s86
  s_mov_b32 s93, 0
  s_cmp_lg_u32 s29, 0
  s_cbranch_scc1 L_ps_46
  v_mov_b32 v17, 1
  v_mul_lo_u32 v22, v1, s90
  v_add_u32 v22, s88, v22
  v_writelane_b32 v22, s85, 0
  s_mov_b32 exec_lo, s31
  s_mov_b32 exec_hi, 0
  buffer_atomic_add v17, v22, s[4:7], 0 offen sc0
  s_mov_b64 exec, -1
L_ps_46:
L_g1n2:
  s_and_b32 s31, s24, 15
  s_cmp_lg_u32 s31, 10
  s_cbranch_scc1 L_g1t
  s_waitcnt vmcnt(0)
  s_barrier
  s_cmp_eq_u32 s93, 0
  s_cbranch_scc1 L_ps_47
  s_mov_b32 s31, s93
  s_mov_b32 s87, s68
  s_mov_b32 s83, s86
  s_mov_b32 s93, 0
  s_cmp_lg_u32 s29, 0
  s_cbranch_scc1 L_ps_47
  v_mov_b32 v17, 1
  v_mul_lo_u32 v22, v1, s90
  v_add_u32 v22, s88, v22
  v_writelane_b32 v22, s85, 0
  s_mov_b32 exec_lo, s31
  s_mov_b32 exec_hi, 0
  buffer_atomic_add v17, v22, s[4:7], 0 offen sc0
  s_mov_b64 exec, -1
L_ps_47:
  s_waitcnt vmcnt(0)
  s_cmp_eq_u32 s87, 0
  s_mov_b32 s31, s87
  s_mov_b32 s87, 0
  s_cbranch_scc1 L_pt_48
  s_cmp_lg_u32 s29, 0
  s_cbranch_scc1 L_pt_48
  v_lshlrev_b32 v22, 7, v1
  v_mov_b32 v21, 1
  s_and_b32 s32, s83, 255
  s_lshr_b32 exec_lo, s83, 8
  s_mov_b32 exec_hi, 0
  v_cmp_eq_u32 vcc, s32, v17
  s_and_b64 exec, exec, vcc
  s_cbranch_execz L_pt_48x
  buffer_store_dword v21, v22, s[4:7], s31 offen sc1
L_pt_48x:
  s_mov_b64 exec, -1
L_pt_48:
  s_mov_b32 s12, s4
  s_mov_b32 s13, s5
  s_mov_b32 s14, 268435456
  s_mov_b32 s15, 0x20000
  s_mov_b32 s20, s4
  s_mov_b32 s21, s5
  s_mov_b32 s22, 268435456
  s_mov_b32 s23, 0x20000
  s_mov_b32 s24, s4
  s_mov_b32 s25, s5
  s_mov_b32 s26, 268435456
  s_mov_b32 s27, 0x20000
  s_branch L_done
L_sp:
  s_mov_b32 s58, 34816
  s_cmp_lg_u32 s29, 0
  s_cbranch_scc1 L_wfx_50
  s_mov_b32 s32, 0
  s_mov_b64 exec, 1
L_wf_49:
  buffer_load_dword v21, v20, s[4:7], s58 offen sc1
  s_add_u32 s32, s32, 1
  s_waitcnt vmcnt(0)
  v_readfirstlane_b32 s31, v21
  s_cmp_gt_u32 s32, 0x40000
  s_cbranch_scc1 L_wfx_50
  s_cmp_ge_u32 s31, 1
  s_cbranch_scc1 L_wfx_50
  s_sleep 8
  s_branch L_wf_49
L_wfx_50:
  s_mov_b64 exec, -1
  s_lshl_b32 s58, s42, 6
  s_add_u32 s61, s58, 12288
  s_lshl_b32 s58, s42, 7
  s_add_u32 s87, s58, 32768
  s_add_u32 s58, s58, 28672
  s_cmp_lg_u32 s29, 0
  s_cbranch_scc1 L_wfx_52
  s_mov_b32 s32, 0
  s_mov_b64 exec, 1
L_wf_51:
  buffer_load_dword v21, v20, s[4:7], s58 offen sc1
  s_add_u32 s32, s32, 1
  s_waitcnt vmcnt(0)
  v_readfirstlane_b32 s31, v21
  s_cmp_gt_u32 s32, 0x40000
  s_cbranch_scc1 L_wfx_52
  s_cmp_ge_u32 s31, 1
  s_cbranch_scc1 L_wfx_52
  s_sleep 8
  s_branch L_wf_51
L_wfx_52:
  s_mov_b64 exec, -1
  s_barrier
  s_load_dwordx2 s[32:33], s[0:1], 72
  s_waitcnt lgkmcnt(0)
  s_mov_b32 s12, s32
  s_mov_b32 s13, s33
  s_mov_b32 s14, 8388608
  s_mov_b32 s15, 0x20000
  s_mov_b32 s16, s4
  s_mov_b32 s17, s5
  s_mov_b32 s18, 268435456
  s_mov_b32 s19, 0x20000
  s_load_dwordx2 s[32:33], s[0:1], 80
  s_waitcnt lgkmcnt(0)
  s_mov_b32 s20, s32
  s_mov_b32 s21, s33
  s_mov_b32 s22, 4096
  s_mov_b32 s23, 0x20000
  s_lshl_b32 s46, s42, 19
  s_mov_b32 s44, 4096
  s_lshl_b32 s31, s43, 8
  s_add_u32 s47, s31, 92274688
  s_mov_b32 s45, 1792
  s_mov_b32 s48, 32
  s_mul_i32 s56, s42, 229376
  s_add_u32 s56, s56, s31
  s_add_u32 s68, s56, 83886080
  s_add_u32 s56, s56, 96468992
  s_lshl_b32 s69, s42, 8
  s_mov_b32 s57, 1792
  s_mov_b32 s49, 3
  s_branch L_gs
L_ob:
  s_lshl_b32 s41, s42, 2
  s_add_u32 s41, s41, s43
  s_lshl_b32 s58, s42, 7
  s_add_u32 s58, s58, 32768
  s_cmp_lg_u32 s29, 0
  s_cbranch_scc1 L_wfx_54
  s_mov_b32 s32, 0
  s_mov_b64 exec, 1
L_wf_53:
  buffer_load_dword v21, v20, s[4:7], s58 offen sc1
  s_add_u32 s32, s32, 1
  s_waitcnt vmcnt(0)
  v_readfirstlane_b32 s31, v21
  s_cmp_gt_u32 s32, 0x40000
  s_cbranch_scc1 L_wfx_54
  s_cmp_ge_u32 s31, 1
  s_cbranch_scc1 L_wfx_54
  s_sleep 8
  s_branch L_wf_53
L_wfx_54:
  s_mov_b64 exec, -1
  s_barrier
  s_mov_b32 s12, s4
  s_mov_b32 s13, s5
  s_mov_b32 s14, 268435456
  s_mov_b32 s15, 0x20000
  s_load_dwordx2 s[32:33], s[0:1], 88
  s_waitcnt lgkmcnt(0)
  s_mov_b32 s16, s32
  s_mov_b32 s17, s33
  s_mov_b32 s18, 917504
  s_mov_b32 s19, 0x20000
  s_mul_i32 s46, s42, 229376
  s_add_u32 s46, s46, 96468992
  s_mov_b32 s44, 1792
  s_lshl_b32 s47, s43, 8
  s_mov_b32 s45, 1024
  s_mov_b32 s48, 14
  s_lshl_b32 s56, s42, 17
  s_add_u32 s56, s56, s47
  s_add_u32 s56, s56, 100663296
  s_mov_b32 s57, 1024
  s_lshl_b32 s61, s41, 4
  s_add_u32 s61, s61, 14336
  s_mov_b32 s49, 4
  s_branch L_gs
L_att:
  s_load_dwordx2 s[32:33], s[0:1], 40
  s_waitcnt lgkmcnt(0)
  s_mov_b32 s16, s32
  s_mov_b32 s17, s33
  s_mov_b32 s18, 4194304
  s_mov_b32 s19, 0x20000
  v_lshrrev_b32 v21, 4, v1
  v_lshlrev_b32 v22, 10, v21
  v_and_b32 v23, 15, v1
  v_lshlrev_b32 v21, 2, v21
  v_xor_b32 v23, v23, v21
  v_lshl_add_u32 v4, v23, 4, v22
  s_lshl_b32 s63, s43, 17
  s_lshl_b32 s31, s29, 8
  s_add_u32 s63, s63, s31
  s_lshl_b32 s51, s29, 15
  s_add_u32 m0, s51, 0
  s_nop 0
  buffer_load_dwordx4 v4, s[16:19], s63 offen lds
  s_add_u32 s63, s63, 4096
  s_add_u32 m0, s51, 1024
  s_nop 0
  buffer_load_dwordx4 v4, s[16:19], s63 offen lds
  s_add_u32 s63, s63, 4096
  s_add_u32 m0, s51, 2048
  s_nop 0
  buffer_load_dwordx4 v4, s[16:19], s63 offen lds
  s_add_u32 s63, s63, 4096
  s_add_u32 m0, s51, 3072
  s_nop 0
  buffer_load_dwordx4 v4, s[16:19], s63 offen lds
  s_add_u32 s63, s63, 4096
  s_add_u32 m0, s51, 4096
  s_nop 0
  buffer_load_dwordx4 v4, s[16:19], s63 offen lds
  s_add_u32 s63, s63, 4096
  s_add_u32 m0, s51, 5120
  s_nop 0
  buffer_load_dwordx4 v4, s[16:19], s63 offen lds
  s_add_u32 s63, s63, 4096
  s_add_u32 m0, s51, 6144
  s_nop 0
  buffer_load_dwordx4 v4, s[16:19], s63 offen lds
  s_add_u32 s63, s63, 4096
  s_add_u32 m0, s51, 7168
  s_nop 0
  buffer_load_dwordx4 v4, s[16:19], s63 offen lds
  s_add_u32 s63, s63, 4096
  s_add_u32 m0, s51, 8192
  s_nop 0
  buffer_load_dwordx4 v4, s[16:19], s63 offen lds
  s_add_u32 s63, s63, 4096
  s_add_u32 m0, s51, 9216
  s_nop 0
  buffer_load_dwordx4 v4, s[16:19], s63 offen lds
  s_add_u32 s63, s63, 4096
  s_add_u32 m0, s51, 10240
  s_nop 0
  buffer_load_dwordx4 v4, s[16:19], s63 offen lds
  s_add_u32 s63, s63, 4096
  s_add_u32 m0, s51, 11264
  s_nop 0
  buffer_load_dwordx4 v4, s[16:19], s63 offen lds
  s_add_u32 s63, s63, 4096
  s_add_u32 m0, s51, 12288
  s_nop 0
  buffer_load_dwordx4 v4, s[16:19], s63 offen lds
  s_add_u32 s63, s63, 4096
  s_add_u32 m0, s51, 13312
  s_nop 0
  buffer_load_dwordx4 v4, s[16:19], s63 offen lds
  s_add_u32 s63, s63, 4096
  s_add_u32 m0, s51, 14336
  s_nop 0
  buffer_load_dwordx4 v4, s[16:19], s63 offen lds
  s_add_u32 s63, s63, 4096
  s_add_u32 m0, s51, 15360
  s_nop 0
  buffer_load_dwordx4 v4, s[16:19], s63 offen lds
  s_add_u32 s63, s63, 4096
  s_add_u32 m0, s51, 16384
  s_nop 0
  buffer_load_dwordx4 v4, s[16:19], s63 offen lds
  s_add_u32 s63, s63, 4096
  s_add_u32 m0, s51, 17408
  s_nop 0
  buffer_load_dwordx4 v4, s[16:19], s63 offen lds
  s_add_u32 s63, s63, 4096
  s_add_u32 m0, s51, 18432
  s_nop 0
  buffer_load_dwordx4 v4, s[16:19], s63 offen lds
  s_add_u32 s63, s63, 4096
  s_add_u32 m0, s51, 19456
  s_nop 0
  buffer_load_dwordx4 v4, s[16:19], s63 offen lds
  s_add_u32 s63, s63, 4096
  s_add_u32 m0, s51, 20480
  s_nop 0
  buffer_load_dwordx4 v4, s[16:19], s63 offen lds
  s_add_u32 s63, s63, 4096
  s_add_u32 m0, s51, 21504
  s_nop 0
  buffer_load_dwordx4 v4, s[16:19], s63 offen lds
  s_add_u32 s63, s63, 4096
  s_add_u32 m0, s51, 22528
  s_nop 0
  buffer_load_dwordx4 v4, s[16:19], s63 offen lds
  s_add_u32 s63, s63, 4096
  s_add_u32 m0, s51, 23552
  s_nop 0
  buffer_load_dwordx4 v4, s[16:19], s63 offen lds
  s_add_u32 s63, s63, 4096
  s_add_u32 m0, s51, 24576
  s_nop 0
  buffer_load_dwordx4 v4, s[16:19], s63 offen lds
  s_add_u32 s63, s63, 4096
  s_add_u32 m0, s51, 25600
  s_nop 0
  buffer_load_dwordx4 v4, s[16:19], s63 offen lds
  s_add_u32 s63, s63, 4096
  s_add_u32 m0, s51, 26624
  s_nop 0
  buffer_load_dwordx4 v4, s[16:19], s63 offen lds
  s_add_u32 s63, s63, 4096
  s_add_u32 m0, s51, 27648
  s_nop 0
  buffer_load_dwordx4 v4, s[16:19], s63 offen lds
  s_add_u32 s63, s63, 4096
  s_add_u32 m0, s51, 28672
  s_nop 0
  buffer_load_dwordx4 v4, s[16:19], s63 offen lds
  s_add_u32 s63, s63, 4096
  s_add_u32 m0, s51, 29696
  s_nop 0
  buffer_load_dwordx4 v4, s[16:19], s63 offen lds
  s_add_u32 s63, s63, 4096
  s_add_u32 m0, s51, 30720
  s_nop 0
  buffer_load_dwordx4 v4, s[16:19], s63 offen lds
  s_add_u32 s63, s63, 4096
  s_add_u32 m0, s51, 31744
  s_nop 0
  buffer_load_dwordx4 v4, s[16:19], s63 offen lds
  s_add_u32 s63, s63, 4096
  s_lshl_b32 s31, s60, 7
  v_xor_b32 v11, s31, v9
  v_subrev_u32 v11, 16384, v11
  v_add_u32 v11, s51, v11
  v_xor_b32 v12, 64, v11
  v_xor_b32 v13, 128, v11
  v_xor_b32 v14, 192, v11
  s_lshl_b32 s31, s59, 13
  s_sub_u32 s31, 131072, s31
  v_add_u32 v15, s31, v5
  v_lshrrev_b32 v21, 4, v1
  v_and_b32 v22, 15, v1
  v_lshrrev_b32 v23, 1, v21
  v_and_b32 v24, 1, v21
  v_lshlrev_b32 v25, 10, v23
  v_lshl_add_u32 v25, v24, 8, v25
  v_lshl_add_u32 v25, v22, 4, v25
  v_lshlrev_b32 v26, 4, v1
  v_lshrrev_b32 v27, 2, v22
  v_and_b32 v28, 1, v22
  v_lshl_add_u32 v27, v27, 1, v28
  v_lshlrev_b32 v27, 8, v27
  v_lshl_add_u32 v27, v21, 4, v27
  s_lshl_b32 s31, s60, 4
  v_add_u32 v28, s31, v22
  v_bfe_u32 v29, v28, 1, 3
  v_xor_b32 v29, v29, v21
  v_lshlrev_b32 v28, 7, v28
  v_lshl_add_u32 v29, v29, 4, v28
  s_lshl_b32 s31, s59, 12
  s_add_u32 s31, s31, 131072
  v_add_u32 v29, s31, v29
  v_lshlrev_b32 v30, 2, v21
  v_mov_b32 v31, 0xff800000
  s_mov_b32 s73, 0x3e0293ee
  s_lshl_b32 s31, s60, 4
  v_add_u32 v19, s31, v22
  v_sub_u32 v19, v19, v30
  s_lshl_b32 s61, s43, 5
  s_add_u32 s61, s61, 13312
  s_mov_b32 s69, 0
  s_lshl_b32 s58, s43, 7
  s_add_u32 s58, s58, 34944
  s_cmp_lg_u32 s29, 0
  s_cbranch_scc1 L_wfx_56
  s_mov_b32 s32, 0
  s_mov_b64 exec, 1
L_wf_55:
  buffer_load_dword v21, v20, s[4:7], s58 offen sc1
  s_add_u32 s32, s32, 1
  s_waitcnt vmcnt(0)
  v_readfirstlane_b32 s31, v21
  s_cmp_gt_u32 s32, 0x40000
  s_cbranch_scc1 L_wfx_56
  s_cmp_ge_u32 s31, 1
  s_cbranch_scc1 L_wfx_56
  s_sleep 8
  s_branch L_wf_55
L_wfx_56:
  s_mov_b64 exec, -1
L_ftc:
  s_cmp_lg_u32 s29, 0
  s_cbranch_scc1 L_ar_57
  v_mov_b32 v17, 1
  v_mov_b32 v21, 0
  s_mov_b64 exec, 1
  buffer_atomic_add v17, v21, s[4:7], s61 offen sc0
  s_mov_b64 exec, -1
L_ar_57:
L_ftl:
  s_waitcnt vmcnt(0)
  s_cmp_lg_u32 s29, 0
  v_mov_b32 v21, 139264
  s_cbranch_scc1 L_bt_58
  s_mov_b64 exec, 1
  ds_write_b32 v21, v17
  s_mov_b64 exec, -1
  s_waitcnt lgkmcnt(0)
L_bt_58:
  s_barrier
  ds_read_b32 v22, v21
  s_waitcnt lgkmcnt(0)
  v_readfirstlane_b32 s42, v22
  s_barrier
  s_cmp_ge_u32 s42, 64
  s_cbranch_scc1 L_done
  s_lshl_b32 s32, s42, 5
  s_add_u32 s32, s32, s43
  s_lshl_b32 s46, s32, 13
  s_add_u32 s33, s46, 16777216
  s_lshl_b32 s31, s60, 9
  s_add_u32 s34, s46, s31
  s_add_u32 s34, s34, 50331648
  s_lshl_b32 s31, s59, 12
  s_add_u32 s35, s46, s31
  s_add_u32 s35, s35, 33554432
  s_add_u32 s37, s33, 4096
  s_add_u32 s38, s34, 4096
  buffer_load_dwordx4 v[64:67], v25, s[4:7], s33 offen offset:0 sc1
  buffer_load_dwordx4 v[68:71], v25, s[4:7], s33 offen offset:2048 sc1
  buffer_load_dwordx4 v[72:75], v25, s[4:7], s37 offen offset:0 sc1
  buffer_load_dwordx4 v[76:79], v25, s[4:7], s37 offen offset:2048 sc1
  buffer_load_dwordx4 v[80:83], v25, s[4:7], s33 offen offset:512 sc1
  buffer_load_dwordx4 v[84:87], v25, s[4:7], s33 offen offset:2560 sc1
  buffer_load_dwordx4 v[88:91], v25, s[4:7], s37 offen offset:512 sc1
  buffer_load_dwordx4 v[92:95], v25, s[4:7], s37 offen offset:2560 sc1
  buffer_load_dwordx4 v[96:99], v25, s[4:7], s34 offen offset:0 sc1
  buffer_load_dwordx4 v[100:103], v25, s[4:7], s34 offen offset:2048 sc1
  buffer_load_dwordx4 v[104:107], v25, s[4:7], s38 offen offset:0 sc1
  buffer_load_dwordx4 v[108:111], v25, s[4:7], s38 offen offset:2048 sc1
  buffer_load_dwordx4 v[112:115], v26, s[4:7], s35 offen offset:0 sc1
  buffer_load_dwordx4 v[116:119], v26, s[4:7], s35 offen offset:1024 sc1
  buffer_load_dwordx4 v[120:123], v26, s[4:7], s35 offen offset:2048 sc1
  buffer_load_dwordx4 v[124:127], v26, s[4:7], s35 offen offset:3072 sc1
  s_add_u32 s31, s42, 6
  s_cmp_gt_u32 s69, s31
  s_cselect_b32 s82, 1, 0
  s_cbranch_scc0 L_ftnp
  s_cmp_lg_u32 s29, 0
  s_cbranch_scc1 L_ar_59
  v_mov_b32 v17, 1
  v_mov_b32 v21, 0
  s_mov_b64 exec, 1
  buffer_atomic_add v17, v21, s[4:7], s61 offen sc0
  s_mov_b64 exec, -1
L_ar_59:
L_ftnp:
  s_cmp_gt_u32 s69, s42
  s_cbranch_scc0 L_ftw
  s_add_u32 s36, s46, 134217728
  s_lshl_b32 s31, s59, 11
  s_add_u32 s37, s36, s31
  buffer_load_dwordx4 v[128:131], v27, s[4:7], s36 offen offset:0 sc1
  buffer_load_dwordx4 v[132:135], v27, s[4:7], s36 offen offset:64 sc1
  buffer_load_dwordx4 v[136:139], v27, s[4:7], s36 offen offset:128 sc1
  buffer_load_dwordx4 v[140:143], v27, s[4:7], s36 offen offset:192 sc1
  buffer_load_dwordx4 v[144:147], v26, s[4:7], s37 offen offset:2048 sc1
  buffer_load_dwordx4 v[148:151], v26, s[4:7], s37 offen offset:3072 sc1
  v_accvgpr_write_b32 a0, 0
  v_accvgpr_write_b32 a1, 0
  v_accvgpr_write_b32 a2, 0
  v_accvgpr_write_b32 a3, 0
  v_accvgpr_write_b32 a4, 0
  v_accvgpr_write_b32 a5, 0
  v_accvgpr_write_b32 a6, 0
  v_accvgpr_write_b32 a7, 0
  v_accvgpr_write_b32 a8, 0
  v_accvgpr_write_b32 a9, 0
  v_accvgpr_write_b32 a10, 0
  v_accvgpr_write_b32 a11, 0
  v_accvgpr_write_b32 a12, 0
  v_accvgpr_write_b32 a13, 0
  v_accvgpr_write_b32 a14, 0
  v_accvgpr_write_b32 a15, 0
  v_accvgpr_write_b32 a16, 0
  v_accvgpr_write_b32 a17, 0
  v_accvgpr_write_b32 a18, 0
  v_accvgpr_write_b32 a19, 0
  v_accvgpr_write_b32 a20, 0
  v_accvgpr_write_b32 a21, 0
  v_accvgpr_write_b32 a22, 0
  v_accvgpr_write_b32 a23, 0
  v_accvgpr_write_b32 a24, 0
  v_accvgpr_write_b32 a25, 0
  v_accvgpr_write_b32 a26, 0
  v_accvgpr_write_b32 a27, 0
  v_accvgpr_write_b32 a28, 0
  v_accvgpr_write_b32 a29, 0
  v_accvgpr_write_b32 a30, 0
  v_accvgpr_write_b32 a31, 0
  v_accvgpr_write_b32 a32, 0
  v_accvgpr_write_b32 a33, 0
  v_accvgpr_write_b32 a34, 0
  v_accvgpr_write_b32 a35, 0
  v_accvgpr_write_b32 a36, 0
  v_accvgpr_write_b32 a37, 0
  v_accvgpr_write_b32 a38, 0
  v_accvgpr_write_b32 a39, 0
  v_accvgpr_write_b32 a40, 0
  v_accvgpr_write_b32 a41, 0
  v_accvgpr_write_b32 a42, 0
  v_accvgpr_write_b32 a43, 0
  v_accvgpr_write_b32 a44, 0
  v_accvgpr_write_b32 a45, 0
  v_accvgpr_write_b32 a46, 0
  v_accvgpr_write_b32 a47, 0
  v_accvgpr_write_b32 a48, 0
  v_accvgpr_write_b32 a49, 0
  v_accvgpr_write_b32 a50, 0
  v_accvgpr_write_b32 a51, 0
  v_accvgpr_write_b32 a52, 0
  v_accvgpr_write_b32 a53, 0
  v_accvgpr_write_b32 a54, 0
  v_accvgpr_write_b32 a55, 0
  v_accvgpr_write_b32 a56, 0
  v_accvgpr_write_b32 a57, 0
  v_accvgpr_write_b32 a58, 0
  v_accvgpr_write_b32 a59, 0
  v_accvgpr_write_b32 a60, 0
  v_accvgpr_write_b32 a61, 0
  v_accvgpr_write_b32 a62, 0
  v_accvgpr_write_b32 a63, 0
  s_waitcnt vmcnt(6)
  v_mfma_f32_16x16x32_bf16 v[152:155], v[64:67], v[96:99], 0
  v_mfma_f32_16x16x32_bf16 v[152:155], v[68:71], v[100:103], v[152:155]
  v_mfma_f32_16x16x32_bf16 v[152:155], v[72:75], v[104:107], v[152:155]
  v_mfma_f32_16x16x32_bf16 v[152:155], v[76:79], v[108:111], v[152:155]
  v_mfma_f32_16x16x32_bf16 v[156:159], v[80:83], v[96:99], 0
  v_mfma_f32_16x16x32_bf16 v[156:159], v[84:87], v[100:103], v[156:159]
  v_mfma_f32_16x16x32_bf16 v[156:159], v[88:91], v[104:107], v[156:159]
  v_mfma_f32_16x16x32_bf16 v[156:159], v[92:95], v[108:111], v[156:159]
  s_nop 7
  v_cmp_le_i32 vcc, 0, v19
  s_nop 1
  v_cndmask_b32 v152, v31, v152, vcc
  v_cmp_le_i32 vcc, 1, v19
  s_nop 1
  v_cndmask_b32 v153, v31, v153, vcc
  v_cmp_le_i32 vcc, 2, v19
  s_nop 1
  v_cndmask_b32 v154, v31, v154, vcc
  v_cmp_le_i32 vcc, 3, v19
  s_nop 1
  v_cndmask_b32 v155, v31, v155, vcc
  v_cmp_le_i32 vcc, 16, v19
  s_nop 1
  v_cndmask_b32 v156, v31, v156, vcc
  v_cmp_le_i32 vcc, 17, v19
  s_nop 1
  v_cndmask_b32 v157, v31, v157, vcc
  v_cmp_le_i32 vcc, 18, v19
  s_nop 1
  v_cndmask_b32 v158, v31, v158, vcc
  v_cmp_le_i32 vcc, 19, v19
  s_nop 1
  v_cndmask_b32 v159, v31, v159, vcc
  s_branch L_ftgo
L_ftw:
  v_accvgpr_write_b32 a0, 0
  v_accvgpr_write_b32 a1, 0
  v_accvgpr_write_b32 a2, 0
  v_accvgpr_write_b32 a3, 0
  v_accvgpr_write_b32 a4, 0
  v_accvgpr_write_b32 a5, 0
  v_accvgpr_write_b32 a6, 0
  v_accvgpr_write_b32 a7, 0
  v_accvgpr_write_b32 a8, 0
  v_accvgpr_write_b32 a9, 0
  v_accvgpr_write_b32 a10, 0
  v_accvgpr_write_b32 a11, 0
  v_accvgpr_write_b32 a12, 0
  v_accvgpr_write_b32 a13, 0
  v_accvgpr_write_b32 a14, 0
  v_accvgpr_write_b32 a15, 0
  v_accvgpr_write_b32 a16, 0
  v_accvgpr_write_b32 a17, 0
  v_accvgpr_write_b32 a18, 0
  v_accvgpr_write_b32 a19, 0
  v_accvgpr_write_b32 a20, 0
  v_accvgpr_write_b32 a21, 0
  v_accvgpr_write_b32 a22, 0
  v_accvgpr_write_b32 a23, 0
  v_accvgpr_write_b32 a24, 0
  v_accvgpr_write_b32 a25, 0
  v_accvgpr_write_b32 a26, 0
  v_accvgpr_write_b32 a27, 0
  v_accvgpr_write_b32 a28, 0
  v_accvgpr_write_b32 a29, 0
  v_accvgpr_write_b32 a30, 0
  v_accvgpr_write_b32 a31, 0
  v_accvgpr_write_b32 a32, 0
  v_accvgpr_write_b32 a33, 0
  v_accvgpr_write_b32 a34, 0
  v_accvgpr_write_b32 a35, 0
  v_accvgpr_write_b32 a36, 0
  v_accvgpr_write_b32 a37, 0
  v_accvgpr_write_b32 a38, 0
  v_accvgpr_write_b32 a39, 0
  v_accvgpr_write_b32 a40, 0
  v_accvgpr_write_b32 a41, 0
  v_accvgpr_write_b32 a42, 0
  v_accvgpr_write_b32 a43, 0
  v_accvgpr_write_b32 a44, 0
  v_accvgpr_write_b32 a45, 0
  v_accvgpr_write_b32 a46, 0
  v_accvgpr_write_b32 a47, 0
  v_accvgpr_write_b32 a48, 0
  v_accvgpr_write_b32 a49, 0
  v_accvgpr_write_b32 a50, 0
  v_accvgpr_write_b32 a51, 0
  v_accvgpr_write_b32 a52, 0
  v_accvgpr_write_b32 a53, 0
  v_accvgpr_write_b32 a54, 0
  v_accvgpr_write_b32 a55, 0
  v_accvgpr_write_b32 a56, 0
  v_accvgpr_write_b32 a57, 0
  v_accvgpr_write_b32 a58, 0
  v_accvgpr_write_b32 a59, 0
  v_accvgpr_write_b32 a60, 0
  v_accvgpr_write_b32 a61, 0
  v_accvgpr_write_b32 a62, 0
  v_accvgpr_write_b32 a63, 0
  s_waitcnt vmcnt(0)
  v_mfma_f32_16x16x32_bf16 v[152:155], v[64:67], v[96:99], 0
  v_mfma_f32_16x16x32_bf16 v[152:155], v[68:71], v[100:103], v[152:155]
  v_mfma_f32_16x16x32_bf16 v[152:155], v[72:75], v[104:107], v[152:155]
  v_mfma_f32_16x16x32_bf16 v[152:155], v[76:79], v[108:111], v[152:155]
  v_mfma_f32_16x16x32_bf16 v[156:159], v[80:83], v[96:99], 0
  v_mfma_f32_16x16x32_bf16 v[156:159], v[84:87], v[100:103], v[156:159]
  v_mfma_f32_16x16x32_bf16 v[156:159], v[88:91], v[104:107], v[156:159]
  v_mfma_f32_16x16x32_bf16 v[156:159], v[92:95], v[108:111], v[156:159]
  s_nop 7
  v_cmp_le_i32 vcc, 0, v19
  s_nop 1
  v_cndmask_b32 v152, v31, v152, vcc
  v_cmp_le_i32 vcc, 1, v19
  s_nop 1
  v_cndmask_b32 v153, v31, v153, vcc
  v_cmp_le_i32 vcc, 2, v19
  s_nop 1
  v_cndmask_b32 v154, v31, v154, vcc
  v_cmp_le_i32 vcc, 3, v19
  s_nop 1
  v_cndmask_b32 v155, v31, v155, vcc
  v_cmp_le_i32 vcc, 16, v19
  s_nop 1
  v_cndmask_b32 v156, v31, v156, vcc
  v_cmp_le_i32 vcc, 17, v19
  s_nop 1
  v_cndmask_b32 v157, v31, v157, vcc
  v_cmp_le_i32 vcc, 18, v19
  s_nop 1
  v_cndmask_b32 v158, v31, v158, vcc
  v_cmp_le_i32 vcc, 19, v19
  s_nop 1
  v_cndmask_b32 v159, v31, v159, vcc
  s_lshl_b32 s58, s43, 6
  s_add_u32 s58, s58, 8192
  s_add_u32 s68, s42, 1
  s_cmp_lg_u32 s29, 0
  s_cbranch_scc1 L_wfx_61
  s_mov_b32 s32, 0
  s_mov_b64 exec, 1
L_wf_60:
  buffer_load_dword v21, v20, s[4:7], s58 offen sc1
  s_add_u32 s32, s32, 1
  s_waitcnt vmcnt(0)
  v_readfirstlane_b32 s31, v21
  s_cmp_gt_u32 s32, 0x40000
  s_cbranch_scc1 L_wfx_61
  s_cmp_ge_u32 s31, s68
  s_cbranch_scc1 L_wfx_61
  s_sleep 1
  s_branch L_wf_60
L_wfx_61:
  s_mov_b64 exec, -1
  v_mov_b32 v22, 139264
  s_cmp_lg_u32 s29, 0
  s_cbranch_scc1 L_ftb
  s_mov_b64 exec, 1
  ds_write_b32 v22, v21
  s_mov_b64 exec, -1
  s_waitcnt lgkmcnt(0)
L_ftb:
  s_barrier
  s_add_u32 s36, s46, 134217728
  s_lshl_b32 s31, s59, 11
  s_add_u32 s37, s36, s31
  buffer_load_dwordx4 v[128:131], v27, s[4:7], s36 offen offset:0 sc1
  buffer_load_dwordx4 v[132:135], v27, s[4:7], s36 offen offset:64 sc1
  buffer_load_dwordx4 v[136:139], v27, s[4:7], s36 offen offset:128 sc1
  buffer_load_dwordx4 v[140:143], v27, s[4:7], s36 offen offset:192 sc1
  buffer_load_dwordx4 v[144:147], v26, s[4:7], s37 offen offset:2048 sc1
  buffer_load_dwordx4 v[148:151], v26, s[4:7], s37 offen offset:3072 sc1
  ds_read_b32 v22, v22
  s_waitcnt lgkmcnt(0)
  v_readfirstlane_b32 s69, v22
L_ftgo:
  s_waitcnt vmcnt(2)
  v_mfma_f32_16x16x32_bf16 v[160:163], v[128:131], v[96:99], 0
  v_mfma_f32_16x16x32_bf16 v[160:163], v[132:135], v[100:103], v[160:163]
  v_mfma_f32_16x16x32_bf16 v[160:163], v[136:139], v[104:107], v[160:163]
  v_mfma_f32_16x16x32_bf16 v[160:163], v[140:143], v[108:111], v[160:163]
  v_max_f32 v180, v152, v153
  v_max3_f32 v180, v180, v154, v155
  v_max3_f32 v180, v180, v156, v157
  v_max3_f32 v180, v180, v158, v159
  s_nop 4
  v_max3_f32 v180, v180, v160, v161
  v_mov_b32 v181, v180
  s_nop 1
  v_permlane16_swap_b32 v180, v181
  v_max_f32 v180, v180, v181
  v_mov_b32 v181, v180
  s_nop 1
  v_permlane32_swap_b32 v180, v181
  v_max_f32 v180, v180, v181
  v_mul_f32 v180, s73, v180
  v_fma_f32 v152, v152, s73, -v180
  v_fma_f32 v153, v153, s73, -v180
  v_fma_f32 v154, v154, s73, -v180
  v_fma_f32 v155, v155, s73, -v180
  v_fma_f32 v156, v156, s73, -v180
  v_fma_f32 v157, v157, s73, -v180
  v_fma_f32 v158, v158, s73, -v180
  v_fma_f32 v159, v159, s73, -v180
  v_fma_f32 v160, v160, s73, -v180
  v_fma_f32 v161, v161, s73, -v180
  v_exp_f32 v152, v152
  v_exp_f32 v153, v153
  v_exp_f32 v154, v154
  v_exp_f32 v155, v155
  v_exp_f32 v156, v156
  v_exp_f32 v157, v157
  v_exp_f32 v158, v158
  v_exp_f32 v159, v159
  v_exp_f32 v160, v160
  v_exp_f32 v161, v161
  s_nop 0
  v_add_f32 v180, v152, v153
  v_add_f32 v180, v180, v154
  v_add_f32 v180, v180, v155
  v_add_f32 v180, v180, v156
  v_add_f32 v180, v180, v157
  v_add_f32 v180, v180, v158
  v_add_f32 v180, v180, v159
  v_add_f32 v180, v180, v160
  v_add_f32 v180, v180, v161
  v_mov_b32 v181, v180
  s_nop 1
  v_permlane16_swap_b32 v180, v181
  v_add_f32 v180, v180, v181
  v_mov_b32 v181, v180
  s_nop 1
  v_permlane32_swap_b32 v180, v181
  v_add_f32 v180, v180, v181
  v_rcp_f32 v180, v180
  s_nop 0
  v_mul_f32 v152, v152, v180
  v_mul_f32 v153, v153, v180
  v_mul_f32 v154, v154, v180
  v_mul_f32 v155, v155, v180
  v_mul_f32 v156, v156, v180
  v_mul_f32 v157, v157, v180
  v_mul_f32 v158, v158, v180
  v_mul_f32 v159, v159, v180
  v_mul_f32 v160, v160, v180
  v_mul_f32 v161, v161, v180
  v_cvt_pk_bf16_f32 v164, v152, v153
  v_cvt_pk_bf16_f32 v165, v154, v155
  v_cvt_pk_bf16_f32 v166, v156, v157
  v_cvt_pk_bf16_f32 v167, v158, v159
  v_cvt_pk_bf16_f32 v168, v160, v161
  v_mov_b32 v169, 0
  s_waitcnt vmcnt(0)
  s_nop 0
  v_mfma_f32_16x16x32_bf16 v[184:187], v[112:115], v[164:167], 0
  v_mfma_f32_16x16x32_bf16 v[188:191], v[116:119], v[164:167], 0
  v_mfma_f32_16x16x32_bf16 v[192:195], v[120:123], v[164:167], 0
  v_mfma_f32_16x16x32_bf16 v[196:199], v[124:127], v[164:167], 0
  v_mfma_f32_16x16x16_bf16 v[184:187], v[144:145], v[168:169], v[184:187]
  v_mfma_f32_16x16x16_bf16 v[188:191], v[146:147], v[168:169], v[188:191]
  v_mfma_f32_16x16x16_bf16 v[192:195], v[148:149], v[168:169], v[192:195]
  v_mfma_f32_16x16x16_bf16 v[196:199], v[150:151], v[168:169], v[196:199]
  s_nop 7
  v_xor_b32 v28, 64, v29
  v_cvt_pk_bf16_f32 v172, v184, v185
  v_cvt_pk_bf16_f32 v173, v186, v187
  v_cvt_pk_bf16_f32 v174, v188, v189
  v_cvt_pk_bf16_f32 v175, v190, v191
  ds_write_b128 v29, v[172:175]
  v_cvt_pk_bf16_f32 v176, v192, v193
  v_cvt_pk_bf16_f32 v177, v194, v195
  v_cvt_pk_bf16_f32 v178, v196, v197
  v_cvt_pk_bf16_f32 v179, v198, v199
  ds_write_b128 v28, v[176:179]
  s_waitcnt lgkmcnt(0)
  s_barrier
  v_xor_b32 v16, 0, v15
  ds_read_b128 v[200:203], v16 offset:0
  ds_read_b64_tr_b16 v[204:205], v11 offset:0
  ds_read_b64_tr_b16 v[206:207], v11 offset:1024
  ds_read_b64_tr_b16 v[208:209], v12 offset:0
  ds_read_b64_tr_b16 v[210:211], v12 offset:1024
  ds_read_b64_tr_b16 v[212:213], v13 offset:0
  ds_read_b64_tr_b16 v[214:215], v13 offset:1024
  ds_read_b64_tr_b16 v[216:217], v14 offset:0
  ds_read_b64_tr_b16 v[218:219], v14 offset:1024
  v_xor_b32 v16, 32, v15
  ds_read_b128 v[220:223], v16 offset:0
  ds_read_b64_tr_b16 v[224:225], v11 offset:4096
  ds_read_b64_tr_b16 v[226:227], v11 offset:5120
  ds_read_b64_tr_b16 v[228:229], v12 offset:4096
  ds_read_b64_tr_b16 v[230:231], v12 offset:5120
  ds_read_b64_tr_b16 v[232:233], v13 offset:4096
  ds_read_b64_tr_b16 v[234:235], v13 offset:5120
  ds_read_b64_tr_b16 v[236:237], v14 offset:4096
  ds_read_b64_tr_b16 v[238:239], v14 offset:5120
  s_waitcnt lgkmcnt(9)
  v_mfma_f32_32x32x16_bf16 a[0:15], v[204:207], v[200:203], a[0:15]
  v_mfma_f32_32x32x16_bf16 a[16:31], v[208:211], v[200:203], a[16:31]
  v_mfma_f32_32x32x16_bf16 a[32:47], v[212:215], v[200:203], a[32:47]
  v_mfma_f32_32x32x16_bf16 a[48:63], v[216:219], v[200:203], a[48:63]
  v_xor_b32 v16, 64, v15
  ds_read_b128 v[200:203], v16 offset:0
  ds_read_b64_tr_b16 v[204:205], v11 offset:8192
  ds_read_b64_tr_b16 v[206:207], v11 offset:9216
  ds_read_b64_tr_b16 v[208:209], v12 offset:8192
  ds_read_b64_tr_b16 v[210:211], v12 offset:9216
  ds_read_b64_tr_b16 v[212:213], v13 offset:8192
  ds_read_b64_tr_b16 v[214:215], v13 offset:9216
  ds_read_b64_tr_b16 v[216:217], v14 offset:8192
  ds_read_b64_tr_b16 v[218:219], v14 offset:9216
  s_waitcnt lgkmcnt(9)
  v_mfma_f32_32x32x16_bf16 a[0:15], v[224:227], v[220:223], a[0:15]
  v_mfma_f32_32x32x16_bf16 a[16:31], v[228:231], v[220:223], a[16:31]
  v_mfma_f32_32x32x16_bf16 a[32:47], v[232:235], v[220:223], a[32:47]
  v_mfma_f32_32x32x16_bf16 a[48:63], v[236:239], v[220:223], a[48:63]
  v_xor_b32 v16, 96, v15
  ds_read_b128 v[220:223], v16 offset:0
  ds_read_b64_tr_b16 v[224:225], v11 offset:12288
  ds_read_b64_tr_b16 v[226:227], v11 offset:13312
  ds_read_b64_tr_b16 v[228:229], v12 offset:12288
  ds_read_b64_tr_b16 v[230:231], v12 offset:13312
  ds_read_b64_tr_b16 v[232:233], v13 offset:12288
  ds_read_b64_tr_b16 v[234:235], v13 offset:13312
  ds_read_b64_tr_b16 v[236:237], v14 offset:12288
  ds_read_b64_tr_b16 v[238:239], v14 offset:13312
  s_waitcnt lgkmcnt(9)
  v_mfma_f32_32x32x16_bf16 a[0:15], v[204:207], v[200:203], a[0:15]
  v_mfma_f32_32x32x16_bf16 a[16:31], v[208:211], v[200:203], a[16:31]
  v_mfma_f32_32x32x16_bf16 a[32:47], v[212:215], v[200:203], a[32:47]
  v_mfma_f32_32x32x16_bf16 a[48:63], v[216:219], v[200:203], a[48:63]
  v_xor_b32 v16, 0, v15
  ds_read_b128 v[200:203], v16 offset:4096
  ds_read_b64_tr_b16 v[204:205], v11 offset:16384
  ds_read_b64_tr_b16 v[206:207], v11 offset:17408
  ds_read_b64_tr_b16 v[208:209], v12 offset:16384
  ds_read_b64_tr_b16 v[210:211], v12 offset:17408
  ds_read_b64_tr_b16 v[212:213], v13 offset:16384
  ds_read_b64_tr_b16 v[214:215], v13 offset:17408
  ds_read_b64_tr_b16 v[216:217], v14 offset:16384
  ds_read_b64_tr_b16 v[218:219], v14 offset:17408
  s_waitcnt lgkmcnt(9)
  v_mfma_f32_32x32x16_bf16 a[0:15], v[224:227], v[220:223], a[0:15]
  v_mfma_f32_32x32x16_bf16 a[16:31], v[228:231], v[220:223], a[16:31]
  v_mfma_f32_32x32x16_bf16 a[32:47], v[232:235], v[220:223], a[32:47]
  v_mfma_f32_32x32x16_bf16 a[48:63], v[236:239], v[220:223], a[48:63]
  v_xor_b32 v16, 32, v15
  ds_read_b128 v[220:223], v16 offset:4096
  ds_read_b64_tr_b16 v[224:225], v11 offset:20480
  ds_read_b64_tr_b16 v[226:227], v11 offset:21504
  ds_read_b64_tr_b16 v[228:229], v12 offset:20480
  ds_read_b64_tr_b16 v[230:231], v12 offset:21504
  ds_read_b64_tr_b16 v[232:233], v13 offset:20480
  ds_read_b64_tr_b16 v[234:235], v13 offset:21504
  ds_read_b64_tr_b16 v[236:237], v14 offset:20480
  ds_read_b64_tr_b16 v[238:239], v14 offset:21504
  s_waitcnt lgkmcnt(9)
  v_mfma_f32_32x32x16_bf16 a[0:15], v[204:207], v[200:203], a[0:15]
  v_mfma_f32_32x32x16_bf16 a[16:31], v[208:211], v[200:203], a[16:31]
  v_mfma_f32_32x32x16_bf16 a[32:47], v[212:215], v[200:203], a[32:47]
  v_mfma_f32_32x32x16_bf16 a[48:63], v[216:219], v[200:203], a[48:63]
  v_xor_b32 v16, 64, v15
  ds_read_b128 v[200:203], v16 offset:4096
  ds_read_b64_tr_b16 v[204:205], v11 offset:24576
  ds_read_b64_tr_b16 v[206:207], v11 offset:25600
  ds_read_b64_tr_b16 v[208:209], v12 offset:24576
  ds_read_b64_tr_b16 v[210:211], v12 offset:25600
  ds_read_b64_tr_b16 v[212:213], v13 offset:24576
  ds_read_b64_tr_b16 v[214:215], v13 offset:25600
  ds_read_b64_tr_b16 v[216:217], v14 offset:24576
  ds_read_b64_tr_b16 v[218:219], v14 offset:25600
  s_waitcnt lgkmcnt(9)
  v_mfma_f32_32x32x16_bf16 a[0:15], v[224:227], v[220:223], a[0:15]
  v_mfma_f32_32x32x16_bf16 a[16:31], v[228:231], v[220:223], a[16:31]
  v_mfma_f32_32x32x16_bf16 a[32:47], v[232:235], v[220:223], a[32:47]
  v_mfma_f32_32x32x16_bf16 a[48:63], v[236:239], v[220:223], a[48:63]
  v_xor_b32 v16, 96, v15
  ds_read_b128 v[220:223], v16 offset:4096
  ds_read_b64_tr_b16 v[224:225], v11 offset:28672
  ds_read_b64_tr_b16 v[226:227], v11 offset:29696
  ds_read_b64_tr_b16 v[228:229], v12 offset:28672
  ds_read_b64_tr_b16 v[230:231], v12 offset:29696
  ds_read_b64_tr_b16 v[232:233], v13 offset:28672
  ds_read_b64_tr_b16 v[234:235], v13 offset:29696
  ds_read_b64_tr_b16 v[236:237], v14 offset:28672
  ds_read_b64_tr_b16 v[238:239], v14 offset:29696
  s_waitcnt lgkmcnt(9)
  v_mfma_f32_32x32x16_bf16 a[0:15], v[204:207], v[200:203], a[0:15]
  v_mfma_f32_32x32x16_bf16 a[16:31], v[208:211], v[200:203], a[16:31]
  v_mfma_f32_32x32x16_bf16 a[32:47], v[212:215], v[200:203], a[32:47]
  v_mfma_f32_32x32x16_bf16 a[48:63], v[216:219], v[200:203], a[48:63]
  s_waitcnt lgkmcnt(0)
  v_mfma_f32_32x32x16_bf16 a[0:15], v[224:227], v[220:223], a[0:15]
  v_mfma_f32_32x32x16_bf16 a[16:31], v[228:231], v[220:223], a[16:31]
  v_mfma_f32_32x32x16_bf16 a[32:47], v[232:235], v[220:223], a[32:47]
  v_mfma_f32_32x32x16_bf16 a[48:63], v[236:239], v[220:223], a[48:63]
  s_lshl_b32 s62, s46, 2
  s_lshl_b32 s31, s29, 13
  s_add_u32 s62, s62, s31
  s_add_u32 s62, s62, 167772160
  s_add_u32 s63, s62, 4096
  s_nop 7
  v_accvgpr_read_b32 v152, a0
  v_accvgpr_read_b32 v153, a1
  v_accvgpr_read_b32 v154, a2
  v_accvgpr_read_b32 v155, a3
  v_accvgpr_read_b32 v156, a4
  v_accvgpr_read_b32 v157, a5
  v_accvgpr_read_b32 v158, a6
  v_accvgpr_read_b32 v159, a7
  v_cvt_pk_bf16_f32 v160, v152, v153
  v_cvt_pk_bf16_f32 v161, v154, v155
  v_cvt_pk_bf16_f32 v162, v156, v157
  v_cvt_pk_bf16_f32 v163, v158, v159
  buffer_store_dwordx4 v[160:163], v26, s[4:7], s62 offen offset:0 sc1
  v_accvgpr_read_b32 v164, a8
  v_accvgpr_read_b32 v165, a9
  v_accvgpr_read_b32 v166, a10
  v_accvgpr_read_b32 v167, a11
  v_accvgpr_read_b32 v168, a12
  v_accvgpr_read_b32 v169, a13
  v_accvgpr_read_b32 v170, a14
  v_accvgpr_read_b32 v171, a15
  v_cvt_pk_bf16_f32 v172, v164, v165
  v_cvt_pk_bf16_f32 v173, v166, v167
  v_cvt_pk_bf16_f32 v174, v168, v169
  v_cvt_pk_bf16_f32 v175, v170, v171
  buffer_store_dwordx4 v[172:175], v26, s[4:7], s62 offen offset:1024 sc1
  v_accvgpr_read_b32 v152, a16
  v_accvgpr_read_b32 v153, a17
  v_accvgpr_read_b32 v154, a18
  v_accvgpr_read_b32 v155, a19
  v_accvgpr_read_b32 v156, a20
  v_accvgpr_read_b32 v157, a21
  v_accvgpr_read_b32 v158, a22
  v_accvgpr_read_b32 v159, a23
  v_cvt_pk_bf16_f32 v160, v152, v153
  v_cvt_pk_bf16_f32 v161, v154, v155
  v_cvt_pk_bf16_f32 v162, v156, v157
  v_cvt_pk_bf16_f32 v163, v158, v159
  buffer_store_dwordx4 v[160:163], v26, s[4:7], s62 offen offset:2048 sc1
  v_accvgpr_read_b32 v164, a24
  v_accvgpr_read_b32 v165, a25
  v_accvgpr_read_b32 v166, a26
  v_accvgpr_read_b32 v167, a27
  v_accvgpr_read_b32 v168, a28
  v_accvgpr_read_b32 v169, a29
  v_accvgpr_read_b32 v170, a30
  v_accvgpr_read_b32 v171, a31
  v_cvt_pk_bf16_f32 v172, v164, v165
  v_cvt_pk_bf16_f32 v173, v166, v167
  v_cvt_pk_bf16_f32 v174, v168, v169
  v_cvt_pk_bf16_f32 v175, v170, v171
  buffer_store_dwordx4 v[172:175], v26, s[4:7], s62 offen offset:3072 sc1
  v_accvgpr_read_b32 v152, a32
  v_accvgpr_read_b32 v153, a33
  v_accvgpr_read_b32 v154, a34
  v_accvgpr_read_b32 v155, a35
  v_accvgpr_read_b32 v156, a36
  v_accvgpr_read_b32 v157, a37
  v_accvgpr_read_b32 v158, a38
  v_accvgpr_read_b32 v159, a39
  v_cvt_pk_bf16_f32 v160, v152, v153
  v_cvt_pk_bf16_f32 v161, v154, v155
  v_cvt_pk_bf16_f32 v162, v156, v157
  v_cvt_pk_bf16_f32 v163, v158, v159
  buffer_store_dwordx4 v[160:163], v26, s[4:7], s63 offen offset:0 sc1
  v_accvgpr_read_b32 v164, a40
  v_accvgpr_read_b32 v165, a41
  v_accvgpr_read_b32 v166, a42
  v_accvgpr_read_b32 v167, a43
  v_accvgpr_read_b32 v168, a44
  v_accvgpr_read_b32 v169, a45
  v_accvgpr_read_b32 v170, a46
  v_accvgpr_read_b32 v171, a47
  v_cvt_pk_bf16_f32 v172, v164, v165
  v_cvt_pk_bf16_f32 v173, v166, v167
  v_cvt_pk_bf16_f32 v174, v168, v169
  v_cvt_pk_bf16_f32 v175, v170, v171
  buffer_store_dwordx4 v[172:175], v26, s[4:7], s63 offen offset:1024 sc1
  v_accvgpr_read_b32 v152, a48
  v_accvgpr_read_b32 v153, a49
  v_accvgpr_read_b32 v154, a50
  v_accvgpr_read_b32 v155, a51
  v_accvgpr_read_b32 v156, a52
  v_accvgpr_read_b32 v157, a53
  v_accvgpr_read_b32 v158, a54
  v_accvgpr_read_b32 v159, a55
  v_cvt_pk_bf16_f32 v160, v152, v153
  v_cvt_pk_bf16_f32 v161, v154, v155
  v_cvt_pk_bf16_f32 v162, v156, v157
  v_cvt_pk_bf16_f32 v163, v158, v159
  buffer_store_dwordx4 v[160:163], v26, s[4:7], s63 offen offset:2048 sc1
  v_accvgpr_read_b32 v164, a56
  v_accvgpr_read_b32 v165, a57
  v_accvgpr_read_b32 v166, a58
  v_accvgpr_read_b32 v167, a59
  v_accvgpr_read_b32 v168, a60
  v_accvgpr_read_b32 v169, a61
  v_accvgpr_read_b32 v170, a62
  v_accvgpr_read_b32 v171, a63
  v_cvt_pk_bf16_f32 v172, v164, v165
  v_cvt_pk_bf16_f32 v173, v166, v167
  v_cvt_pk_bf16_f32 v174, v168, v169
  v_cvt_pk_bf16_f32 v175, v170, v171
  buffer_store_dwordx4 v[172:175], v26, s[4:7], s63 offen offset:3072 sc1
  s_lshl_b32 s58, s42, 5
  s_add_u32 s58, s58, 16640
  s_lshl_b32 s68, s42, 7
  s_add_u32 s68, s68, 20480
  s_waitcnt vmcnt(0)
  s_barrier
  s_cmp_lg_u32 s29, 0
  s_cbranch_scc1 L_sg_62
  v_mov_b32 v21, 1
  s_mov_b64 exec, 1
  buffer_atomic_add v21, v20, s[4:7], s58 offen sc0
  s_waitcnt vmcnt(0)
  v_cmp_eq_u32 vcc, 31, v21
  v_mov_b32 v21, 1
  s_and_b64 exec, exec, vcc
  s_cbranch_execz L_sg_62x
  buffer_store_dword v21, v20, s[4:7], s68 offen sc1
L_sg_62x:
  s_mov_b64 exec, -1
L_sg_62:
  s_cmp_eq_u32 s82, 1
  s_cbranch_scc1 L_ftl
  s_branch L_ftc
L_g3:
  s_load_dwordx2 s[32:33], s[0:1], 0
  s_waitcnt lgkmcnt(0)
  s_mov_b32 s20, s32
  s_mov_b32 s21, s33
  s_mov_b32 s22, 2097152
  s_mov_b32 s23, 0x20000
  s_load_dwordx2 s[32:33], s[0:1], 96
  s_waitcnt lgkmcnt(0)
  s_mov_b32 s24, s32
  s_mov_b32 s25, s33
  s_mov_b32 s26, 2097152
  s_mov_b32 s27, 0x20000
  s_and_b32 s58, s42, 0xfc
  s_lshr_b32 s31, s43, 1
  s_add_u32 s58, s58, s31
  s_lshl_b32 s58, s58, 4
  s_add_u32 s58, s58, 14336
  s_cmp_lg_u32 s29, 0
  s_cbranch_scc1 L_wfx_64
  s_mov_b32 s32, 0
  s_mov_b64 exec, 1
L_wf_63:
  buffer_load_dword v21, v20, s[4:7], s58 offen sc1
  s_add_u32 s32, s32, 1
  s_waitcnt vmcnt(0)
  v_readfirstlane_b32 s31, v21
  s_cmp_gt_u32 s32, 0x40000
  s_cbranch_scc1 L_wfx_64
  s_cmp_ge_u32 s31, 1
  s_cbranch_scc1 L_wfx_64
  s_sleep 8
  s_branch L_wf_63
L_wfx_64:
  s_mov_b64 exec, -1
  s_barrier
  v_lshlrev_b32 v26, 4, v1
  s_lshl_b32 s31, s43, 2
  s_add_u32 s31, s31, s29
  s_lshl_b32 s62, s42, 20
  s_lshl_b32 s32, s31, 10
  s_add_u32 s62, s62, s32
  s_add_u32 s62, s62, 167772160
  v_and_b32 v24, 31, v1
  v_lshrrev_b32 v22, 5, v1
  v_lshlrev_b32 v23, 10, v24
  v_lshl_add_u32 v23, v22, 4, v23
  s_lshl_b32 s56, s42, 15
  s_lshl_b32 s32, s31, 5
  s_add_u32 s56, s56, s32
  s_add_u32 s68, s56, 100663296
  buffer_load_dwordx4 v[192:195], v23, s[20:23], s56 offen
  buffer_load_dwordx4 v[196:199], v23, s[4:7], s68 offen sc1
  s_mov_b32 s73, 0x00003f80
  s_mov_b32 s74, 0x3f800000
  v_mov_b32 v32, 0
  v_mov_b32 v33, 0
  v_mov_b32 v34, 0
  v_mov_b32 v35, 0
  v_mov_b32 v36, 0
  v_mov_b32 v37, 0
  v_mov_b32 v38, 0
  v_mov_b32 v39, 0
  s_lshl_b32 s58, s42, 7
  s_add_u32 s58, s58, 20480
  s_cmp_lg_u32 s29, 0
  s_cbranch_scc1 L_wfx_66
  s_mov_b32 s32, 0
  s_mov_b64 exec, 1
L_wf_65:
  buffer_load_dword v21, v20, s[4:7], s58 offen sc1
  s_add_u32 s32, s32, 1
  s_waitcnt vmcnt(0)
  v_readfirstlane_b32 s31, v21
  s_cmp_gt_u32 s32, 0x40000
  s_cbranch_scc1 L_wfx_66
  s_cmp_ge_u32 s31, 1
  s_cbranch_scc1 L_wfx_66
  s_sleep 2
  s_branch L_wf_65
L_wfx_66:
  s_mov_b64 exec, -1
  s_barrier
L_redl:
  buffer_load_dwordx4 v[64:67], v26, s[4:7], s62 offen sc1
  s_add_u32 s62, s62, 32768
  buffer_load_dwordx4 v[68:71], v26, s[4:7], s62 offen sc1
  s_add_u32 s62, s62, 32768
  buffer_load_dwordx4 v[72:75], v26, s[4:7], s62 offen sc1
  s_add_u32 s62, s62, 32768
  buffer_load_dwordx4 v[76:79], v26, s[4:7], s62 offen sc1
  s_add_u32 s62, s62, 32768
  buffer_load_dwordx4 v[80:83], v26, s[4:7], s62 offen sc1
  s_add_u32 s62, s62, 32768
  buffer_load_dwordx4 v[84:87], v26, s[4:7], s62 offen sc1
  s_add_u32 s62, s62, 32768
  buffer_load_dwordx4 v[88:91], v26, s[4:7], s62 offen sc1
  s_add_u32 s62, s62, 32768
  buffer_load_dwordx4 v[92:95], v26, s[4:7], s62 offen sc1
  s_add_u32 s62, s62, 32768
  buffer_load_dwordx4 v[96:99], v26, s[4:7], s62 offen sc1
  s_add_u32 s62, s62, 32768
  buffer_load_dwordx4 v[100:103], v26, s[4:7], s62 offen sc1
  s_add_u32 s62, s62, 32768
  buffer_load_dwordx4 v[104:107], v26, s[4:7], s62 offen sc1
  s_add_u32 s62, s62, 32768
  buffer_load_dwordx4 v[108:111], v26, s[4:7], s62 offen sc1
  s_add_u32 s62, s62, 32768
  buffer_load_dwordx4 v[112:115], v26, s[4:7], s62 offen sc1
  s_add_u32 s62, s62, 32768
  buffer_load_dwordx4 v[116:119], v26, s[4:7], s62 offen sc1
  s_add_u32 s62, s62, 32768
  buffer_load_dwordx4 v[120:123], v26, s[4:7], s62 offen sc1
  s_add_u32 s62, s62, 32768
  buffer_load_dwordx4 v[124:127], v26, s[4:7], s62 offen sc1
  s_add_u32 s62, s62, 32768
  buffer_load_dwordx4 v[128:131], v26, s[4:7], s62 offen sc1
  s_add_u32 s62, s62, 32768
  buffer_load_dwordx4 v[132:135], v26, s[4:7], s62 offen sc1
  s_add_u32 s62, s62, 32768
  buffer_load_dwordx4 v[136:139], v26, s[4:7], s62 offen sc1
  s_add_u32 s62, s62, 32768
  buffer_load_dwordx4 v[140:143], v26, s[4:7], s62 offen sc1
  s_add_u32 s62, s62, 32768
  buffer_load_dwordx4 v[144:147], v26, s[4:7], s62 offen sc1
  s_add_u32 s62, s62, 32768
  buffer_load_dwordx4 v[148:151], v26, s[4:7], s62 offen sc1
  s_add_u32 s62, s62, 32768
  buffer_load_dwordx4 v[152:155], v26, s[4:7], s62 offen sc1
  s_add_u32 s62, s62, 32768
  buffer_load_dwordx4 v[156:159], v26, s[4:7], s62 offen sc1
  s_add_u32 s62, s62, 32768
  buffer_load_dwordx4 v[160:163], v26, s[4:7], s62 offen sc1
  s_add_u32 s62, s62, 32768
  buffer_load_dwordx4 v[164:167], v26, s[4:7], s62 offen sc1
  s_add_u32 s62, s62, 32768
  buffer_load_dwordx4 v[168:171], v26, s[4:7], s62 offen sc1
  s_add_u32 s62, s62, 32768
  buffer_load_dwordx4 v[172:175], v26, s[4:7], s62 offen sc1
  s_add_u32 s62, s62, 32768
  buffer_load_dwordx4 v[176:179], v26, s[4:7], s62 offen sc1
  s_add_u32 s62, s62, 32768
  buffer_load_dwordx4 v[180:183], v26, s[4:7], s62 offen sc1
  s_add_u32 s62, s62, 32768
  buffer_load_dwordx4 v[184:187], v26, s[4:7], s62 offen sc1
  s_add_u32 s62, s62, 32768
  buffer_load_dwordx4 v[188:191], v26, s[4:7], s62 offen sc1
  s_add_u32 s62, s62, 32768
  s_waitcnt vmcnt(31)
  v_dot2_f32_bf16 v32, v64, s73, v32
  v_dot2_f32_bf16 v33, v64, s74, v33
  v_dot2_f32_bf16 v34, v65, s73, v34
  v_dot2_f32_bf16 v35, v65, s74, v35
  v_dot2_f32_bf16 v36, v66, s73, v36
  v_dot2_f32_bf16 v37, v66, s74, v37
  v_dot2_f32_bf16 v38, v67, s73, v38
  v_dot2_f32_bf16 v39, v67, s74, v39
  s_waitcnt vmcnt(30)
  v_dot2_f32_bf16 v32, v68, s73, v32
  v_dot2_f32_bf16 v33, v68, s74, v33
  v_dot2_f32_bf16 v34, v69, s73, v34
  v_dot2_f32_bf16 v35, v69, s74, v35
  v_dot2_f32_bf16 v36, v70, s73, v36
  v_dot2_f32_bf16 v37, v70, s74, v37
  v_dot2_f32_bf16 v38, v71, s73, v38
  v_dot2_f32_bf16 v39, v71, s74, v39
  s_waitcnt vmcnt(29)
  v_dot2_f32_bf16 v32, v72, s73, v32
  v_dot2_f32_bf16 v33, v72, s74, v33
  v_dot2_f32_bf16 v34, v73, s73, v34
  v_dot2_f32_bf16 v35, v73, s74, v35
  v_dot2_f32_bf16 v36, v74, s73, v36
  v_dot2_f32_bf16 v37, v74, s74, v37
  v_dot2_f32_bf16 v38, v75, s73, v38
  v_dot2_f32_bf16 v39, v75, s74, v39
  s_waitcnt vmcnt(28)
  v_dot2_f32_bf16 v32, v76, s73, v32
  v_dot2_f32_bf16 v33, v76, s74, v33
  v_dot2_f32_bf16 v34, v77, s73, v34
  v_dot2_f32_bf16 v35, v77, s74, v35
  v_dot2_f32_bf16 v36, v78, s73, v36
  v_dot2_f32_bf16 v37, v78, s74, v37
  v_dot2_f32_bf16 v38, v79, s73, v38
  v_dot2_f32_bf16 v39, v79, s74, v39
  s_waitcnt vmcnt(27)
  v_dot2_f32_bf16 v32, v80, s73, v32
  v_dot2_f32_bf16 v33, v80, s74, v33
  v_dot2_f32_bf16 v34, v81, s73, v34
  v_dot2_f32_bf16 v35, v81, s74, v35
  v_dot2_f32_bf16 v36, v82, s73, v36
  v_dot2_f32_bf16 v37, v82, s74, v37
  v_dot2_f32_bf16 v38, v83, s73, v38
  v_dot2_f32_bf16 v39, v83, s74, v39
  s_waitcnt vmcnt(26)
  v_dot2_f32_bf16 v32, v84, s73, v32
  v_dot2_f32_bf16 v33, v84, s74, v33
  v_dot2_f32_bf16 v34, v85, s73, v34
  v_dot2_f32_bf16 v35, v85, s74, v35
  v_dot2_f32_bf16 v36, v86, s73, v36
  v_dot2_f32_bf16 v37, v86, s74, v37
  v_dot2_f32_bf16 v38, v87, s73, v38
  v_dot2_f32_bf16 v39, v87, s74, v39
  s_waitcnt vmcnt(25)
  v_dot2_f32_bf16 v32, v88, s73, v32
  v_dot2_f32_bf16 v33, v88, s74, v33
  v_dot2_f32_bf16 v34, v89, s73, v34
  v_dot2_f32_bf16 v35, v89, s74, v35
  v_dot2_f32_bf16 v36, v90, s73, v36
  v_dot2_f32_bf16 v37, v90, s74, v37
  v_dot2_f32_bf16 v38, v91, s73, v38
  v_dot2_f32_bf16 v39, v91, s74, v39
  s_waitcnt vmcnt(24)
  v_dot2_f32_bf16 v32, v92, s73, v32
  v_dot2_f32_bf16 v33, v92, s74, v33
  v_dot2_f32_bf16 v34, v93, s73, v34
  v_dot2_f32_bf16 v35, v93, s74, v35
  v_dot2_f32_bf16 v36, v94, s73, v36
  v_dot2_f32_bf16 v37, v94, s74, v37
  v_dot2_f32_bf16 v38, v95, s73, v38
  v_dot2_f32_bf16 v39, v95, s74, v39
  s_waitcnt vmcnt(23)
  v_dot2_f32_bf16 v32, v96, s73, v32
  v_dot2_f32_bf16 v33, v96, s74, v33
  v_dot2_f32_bf16 v34, v97, s73, v34
  v_dot2_f32_bf16 v35, v97, s74, v35
  v_dot2_f32_bf16 v36, v98, s73, v36
  v_dot2_f32_bf16 v37, v98, s74, v37
  v_dot2_f32_bf16 v38, v99, s73, v38
  v_dot2_f32_bf16 v39, v99, s74, v39
  s_waitcnt vmcnt(22)
  v_dot2_f32_bf16 v32, v100, s73, v32
  v_dot2_f32_bf16 v33, v100, s74, v33
  v_dot2_f32_bf16 v34, v101, s73, v34
  v_dot2_f32_bf16 v35, v101, s74, v35
  v_dot2_f32_bf16 v36, v102, s73, v36
  v_dot2_f32_bf16 v37, v102, s74, v37
  v_dot2_f32_bf16 v38, v103, s73, v38
  v_dot2_f32_bf16 v39, v103, s74, v39
  s_waitcnt vmcnt(21)
  v_dot2_f32_bf16 v32, v104, s73, v32
  v_dot2_f32_bf16 v33, v104, s74, v33
  v_dot2_f32_bf16 v34, v105, s73, v34
  v_dot2_f32_bf16 v35, v105, s74, v35
  v_dot2_f32_bf16 v36, v106, s73, v36
  v_dot2_f32_bf16 v37, v106, s74, v37
  v_dot2_f32_bf16 v38, v107, s73, v38
  v_dot2_f32_bf16 v39, v107, s74, v39
  s_waitcnt vmcnt(20)
  v_dot2_f32_bf16 v32, v108, s73, v32
  v_dot2_f32_bf16 v33, v108, s74, v33
  v_dot2_f32_bf16 v34, v109, s73, v34
  v_dot2_f32_bf16 v35, v109, s74, v35
  v_dot2_f32_bf16 v36, v110, s73, v36
  v_dot2_f32_bf16 v37, v110, s74, v37
  v_dot2_f32_bf16 v38, v111, s73, v38
  v_dot2_f32_bf16 v39, v111, s74, v39
  s_waitcnt vmcnt(19)
  v_dot2_f32_bf16 v32, v112, s73, v32
  v_dot2_f32_bf16 v33, v112, s74, v33
  v_dot2_f32_bf16 v34, v113, s73, v34
  v_dot2_f32_bf16 v35, v113, s74, v35
  v_dot2_f32_bf16 v36, v114, s73, v36
  v_dot2_f32_bf16 v37, v114, s74, v37
  v_dot2_f32_bf16 v38, v115, s73, v38
  v_dot2_f32_bf16 v39, v115, s74, v39
  s_waitcnt vmcnt(18)
  v_dot2_f32_bf16 v32, v116, s73, v32
  v_dot2_f32_bf16 v33, v116, s74, v33
  v_dot2_f32_bf16 v34, v117, s73, v34
  v_dot2_f32_bf16 v35, v117, s74, v35
  v_dot2_f32_bf16 v36, v118, s73, v36
  v_dot2_f32_bf16 v37, v118, s74, v37
  v_dot2_f32_bf16 v38, v119, s73, v38
  v_dot2_f32_bf16 v39, v119, s74, v39
  s_waitcnt vmcnt(17)
  v_dot2_f32_bf16 v32, v120, s73, v32
  v_dot2_f32_bf16 v33, v120, s74, v33
  v_dot2_f32_bf16 v34, v121, s73, v34
  v_dot2_f32_bf16 v35, v121, s74, v35
  v_dot2_f32_bf16 v36, v122, s73, v36
  v_dot2_f32_bf16 v37, v122, s74, v37
  v_dot2_f32_bf16 v38, v123, s73, v38
  v_dot2_f32_bf16 v39, v123, s74, v39
  s_waitcnt vmcnt(16)
  v_dot2_f32_bf16 v32, v124, s73, v32
  v_dot2_f32_bf16 v33, v124, s74, v33
  v_dot2_f32_bf16 v34, v125, s73, v34
  v_dot2_f32_bf16 v35, v125, s74, v35
  v_dot2_f32_bf16 v36, v126, s73, v36
  v_dot2_f32_bf16 v37, v126, s74, v37
  v_dot2_f32_bf16 v38, v127, s73, v38
  v_dot2_f32_bf16 v39, v127, s74, v39
  s_waitcnt vmcnt(15)
  v_dot2_f32_bf16 v32, v128, s73, v32
  v_dot2_f32_bf16 v33, v128, s74, v33
  v_dot2_f32_bf16 v34, v129, s73, v34
  v_dot2_f32_bf16 v35, v129, s74, v35
  v_dot2_f32_bf16 v36, v130, s73, v36
  v_dot2_f32_bf16 v37, v130, s74, v37
  v_dot2_f32_bf16 v38, v131, s73, v38
  v_dot2_f32_bf16 v39, v131, s74, v39
  s_waitcnt vmcnt(14)
  v_dot2_f32_bf16 v32, v132, s73, v32
  v_dot2_f32_bf16 v33, v132, s74, v33
  v_dot2_f32_bf16 v34, v133, s73, v34
  v_dot2_f32_bf16 v35, v133, s74, v35
  v_dot2_f32_bf16 v36, v134, s73, v36
  v_dot2_f32_bf16 v37, v134, s74, v37
  v_dot2_f32_bf16 v38, v135, s73, v38
  v_dot2_f32_bf16 v39, v135, s74, v39
  s_waitcnt vmcnt(13)
  v_dot2_f32_bf16 v32, v136, s73, v32
  v_dot2_f32_bf16 v33, v136, s74, v33
  v_dot2_f32_bf16 v34, v137, s73, v34
  v_dot2_f32_bf16 v35, v137, s74, v35
  v_dot2_f32_bf16 v36, v138, s73, v36
  v_dot2_f32_bf16 v37, v138, s74, v37
  v_dot2_f32_bf16 v38, v139, s73, v38
  v_dot2_f32_bf16 v39, v139, s74, v39
  s_waitcnt vmcnt(12)
  v_dot2_f32_bf16 v32, v140, s73, v32
  v_dot2_f32_bf16 v33, v140, s74, v33
  v_dot2_f32_bf16 v34, v141, s73, v34
  v_dot2_f32_bf16 v35, v141, s74, v35
  v_dot2_f32_bf16 v36, v142, s73, v36
  v_dot2_f32_bf16 v37, v142, s74, v37
  v_dot2_f32_bf16 v38, v143, s73, v38
  v_dot2_f32_bf16 v39, v143, s74, v39
  s_waitcnt vmcnt(11)
  v_dot2_f32_bf16 v32, v144, s73, v32
  v_dot2_f32_bf16 v33, v144, s74, v33
  v_dot2_f32_bf16 v34, v145, s73, v34
  v_dot2_f32_bf16 v35, v145, s74, v35
  v_dot2_f32_bf16 v36, v146, s73, v36
  v_dot2_f32_bf16 v37, v146, s74, v37
  v_dot2_f32_bf16 v38, v147, s73, v38
  v_dot2_f32_bf16 v39, v147, s74, v39
  s_waitcnt vmcnt(10)
  v_dot2_f32_bf16 v32, v148, s73, v32
  v_dot2_f32_bf16 v33, v148, s74, v33
  v_dot2_f32_bf16 v34, v149, s73, v34
  v_dot2_f32_bf16 v35, v149, s74, v35
  v_dot2_f32_bf16 v36, v150, s73, v36
  v_dot2_f32_bf16 v37, v150, s74, v37
  v_dot2_f32_bf16 v38, v151, s73, v38
  v_dot2_f32_bf16 v39, v151, s74, v39
  s_waitcnt vmcnt(9)
  v_dot2_f32_bf16 v32, v152, s73, v32
  v_dot2_f32_bf16 v33, v152, s74, v33
  v_dot2_f32_bf16 v34, v153, s73, v34
  v_dot2_f32_bf16 v35, v153, s74, v35
  v_dot2_f32_bf16 v36, v154, s73, v36
  v_dot2_f32_bf16 v37, v154, s74, v37
  v_dot2_f32_bf16 v38, v155, s73, v38
  v_dot2_f32_bf16 v39, v155, s74, v39
  s_waitcnt vmcnt(8)
  v_dot2_f32_bf16 v32, v156, s73, v32
  v_dot2_f32_bf16 v33, v156, s74, v33
  v_dot2_f32_bf16 v34, v157, s73, v34
  v_dot2_f32_bf16 v35, v157, s74, v35
  v_dot2_f32_bf16 v36, v158, s73, v36
  v_dot2_f32_bf16 v37, v158, s74, v37
  v_dot2_f32_bf16 v38, v159, s73, v38
  v_dot2_f32_bf16 v39, v159, s74, v39
  s_waitcnt vmcnt(7)
  v_dot2_f32_bf16 v32, v160, s73, v32
  v_dot2_f32_bf16 v33, v160, s74, v33
  v_dot2_f32_bf16 v34, v161, s73, v34
  v_dot2_f32_bf16 v35, v161, s74, v35
  v_dot2_f32_bf16 v36, v162, s73, v36
  v_dot2_f32_bf16 v37, v162, s74, v37
  v_dot2_f32_bf16 v38, v163, s73, v38
  v_dot2_f32_bf16 v39, v163, s74, v39
  s_waitcnt vmcnt(6)
  v_dot2_f32_bf16 v32, v164, s73, v32
  v_dot2_f32_bf16 v33, v164, s74, v33
  v_dot2_f32_bf16 v34, v165, s73, v34
  v_dot2_f32_bf16 v35, v165, s74, v35
  v_dot2_f32_bf16 v36, v166, s73, v36
  v_dot2_f32_bf16 v37, v166, s74, v37
  v_dot2_f32_bf16 v38, v167, s73, v38
  v_dot2_f32_bf16 v39, v167, s74, v39
  s_waitcnt vmcnt(5)
  v_dot2_f32_bf16 v32, v168, s73, v32
  v_dot2_f32_bf16 v33, v168, s74, v33
  v_dot2_f32_bf16 v34, v169, s73, v34
  v_dot2_f32_bf16 v35, v169, s74, v35
  v_dot2_f32_bf16 v36, v170, s73, v36
  v_dot2_f32_bf16 v37, v170, s74, v37
  v_dot2_f32_bf16 v38, v171, s73, v38
  v_dot2_f32_bf16 v39, v171, s74, v39
  s_waitcnt vmcnt(4)
  v_dot2_f32_bf16 v32, v172, s73, v32
  v_dot2_f32_bf16 v33, v172, s74, v33
  v_dot2_f32_bf16 v34, v173, s73, v34
  v_dot2_f32_bf16 v35, v173, s74, v35
  v_dot2_f32_bf16 v36, v174, s73, v36
  v_dot2_f32_bf16 v37, v174, s74, v37
  v_dot2_f32_bf16 v38, v175, s73, v38
  v_dot2_f32_bf16 v39, v175, s74, v39
  s_waitcnt vmcnt(3)
  v_dot2_f32_bf16 v32, v176, s73, v32
  v_dot2_f32_bf16 v33, v176, s74, v33
  v_dot2_f32_bf16 v34, v177, s73, v34
  v_dot2_f32_bf16 v35, v177, s74, v35
  v_dot2_f32_bf16 v36, v178, s73, v36
  v_dot2_f32_bf16 v37, v178, s74, v37
  v_dot2_f32_bf16 v38, v179, s73, v38
  v_dot2_f32_bf16 v39, v179, s74, v39
  s_waitcnt vmcnt(2)
  v_dot2_f32_bf16 v32, v180, s73, v32
  v_dot2_f32_bf16 v33, v180, s74, v33
  v_dot2_f32_bf16 v34, v181, s73, v34
  v_dot2_f32_bf16 v35, v181, s74, v35
  v_dot2_f32_bf16 v36, v182, s73, v36
  v_dot2_f32_bf16 v37, v182, s74, v37
  v_dot2_f32_bf16 v38, v183, s73, v38
  v_dot2_f32_bf16 v39, v183, s74, v39
  s_waitcnt vmcnt(1)
  v_dot2_f32_bf16 v32, v184, s73, v32
  v_dot2_f32_bf16 v33, v184, s74, v33
  v_dot2_f32_bf16 v34, v185, s73, v34
  v_dot2_f32_bf16 v35, v185, s74, v35
  v_dot2_f32_bf16 v36, v186, s73, v36
  v_dot2_f32_bf16 v37, v186, s74, v37
  v_dot2_f32_bf16 v38, v187, s73, v38
  v_dot2_f32_bf16 v39, v187, s74, v39
  s_waitcnt vmcnt(0)
  v_dot2_f32_bf16 v32, v188, s73, v32
  v_dot2_f32_bf16 v33, v188, s74, v33
  v_dot2_f32_bf16 v34, v189, s73, v34
  v_dot2_f32_bf16 v35, v189, s74, v35
  v_dot2_f32_bf16 v36, v190, s73, v36
  v_dot2_f32_bf16 v37, v190, s74, v37
  v_dot2_f32_bf16 v38, v191, s73, v38
  v_dot2_f32_bf16 v39, v191, s74, v39
  s_nop 3
  v_cvt_pk_bf16_f32 v40, v32, v33
  v_lshlrev_b32 v28, 16, v40
  v_and_b32 v29, 0xffff0000, v40
  v_lshlrev_b32 v30, 16, v192
  v_and_b32 v31, 0xffff0000, v192
  v_add_f32 v28, v28, v30
  v_add_f32 v29, v29, v31
  v_cvt_pk_bf16_f32 v40, v28, v29
  v_lshlrev_b32 v28, 16, v40
  v_and_b32 v29, 0xffff0000, v40
  v_lshlrev_b32 v30, 16, v196
  v_and_b32 v31, 0xffff0000, v196
  v_add_f32 v28, v28, v30
  v_add_f32 v29, v29, v31
  v_cvt_pk_bf16_f32 v40, v28, v29
  v_cvt_pk_bf16_f32 v41, v34, v35
  v_lshlrev_b32 v28, 16, v41
  v_and_b32 v29, 0xffff0000, v41
  v_lshlrev_b32 v30, 16, v193
  v_and_b32 v31, 0xffff0000, v193
  v_add_f32 v28, v28, v30
  v_add_f32 v29, v29, v31
  v_cvt_pk_bf16_f32 v41, v28, v29
  v_lshlrev_b32 v28, 16, v41
  v_and_b32 v29, 0xffff0000, v41
  v_lshlrev_b32 v30, 16, v197
  v_and_b32 v31, 0xffff0000, v197
  v_add_f32 v28, v28, v30
  v_add_f32 v29, v29, v31
  v_cvt_pk_bf16_f32 v41, v28, v29
  v_cvt_pk_bf16_f32 v42, v36, v37
  v_lshlrev_b32 v28, 16, v42
  v_and_b32 v29, 0xffff0000, v42
  v_lshlrev_b32 v30, 16, v194
  v_and_b32 v31, 0xffff0000, v194
  v_add_f32 v28, v28, v30
  v_add_f32 v29, v29, v31
  v_cvt_pk_bf16_f32 v42, v28, v29
  v_lshlrev_b32 v28, 16, v42
  v_and_b32 v29, 0xffff0000, v42
  v_lshlrev_b32 v30, 16, v198
  v_and_b32 v31, 0xffff0000, v198
  v_add_f32 v28, v28, v30
  v_add_f32 v29, v29, v31
  v_cvt_pk_bf16_f32 v42, v28, v29
  v_cvt_pk_bf16_f32 v43, v38, v39
  v_lshlrev_b32 v28, 16, v43
  v_and_b32 v29, 0xffff0000, v43
  v_lshlrev_b32 v30, 16, v195
  v_and_b32 v31, 0xffff0000, v195
  v_add_f32 v28, v28, v30
  v_add_f32 v29, v29, v31
  v_cvt_pk_bf16_f32 v43, v28, v29
  v_lshlrev_b32 v28, 16, v43
  v_and_b32 v29, 0xffff0000, v43
  v_lshlrev_b32 v30, 16, v199
  v_and_b32 v31, 0xffff0000, v199
  v_add_f32 v28, v28, v30
  v_add_f32 v29, v29, v31
  v_cvt_pk_bf16_f32 v43, v28, v29
  buffer_store_dwordx4 v[40:43], v23, s[24:27], s56 offen
  s_sub_u32 s82, s82, 1
  s_cmp_eq_u32 s82, 0
  s_cbranch_scc1 L_done
  s_add_u32 s43, s43, 1
  v_lshlrev_b32 v26, 4, v1
  s_lshl_b32 s31, s43, 2
  s_add_u32 s31, s31, s29
  s_lshl_b32 s62, s42, 20
  s_lshl_b32 s32, s31, 10
  s_add_u32 s62, s62, s32
  s_add_u32 s62, s62, 167772160
  v_and_b32 v24, 31, v1
  v_lshrrev_b32 v22, 5, v1
  v_lshlrev_b32 v23, 10, v24
  v_lshl_add_u32 v23, v22, 4, v23
  s_lshl_b32 s56, s42, 15
  s_lshl_b32 s32, s31, 5
  s_add_u32 s56, s56, s32
  s_add_u32 s68, s56, 100663296
  buffer_load_dwordx4 v[192:195], v23, s[20:23], s56 offen
  buffer_load_dwordx4 v[196:199], v23, s[4:7], s68 offen sc1
  s_mov_b32 s73, 0x00003f80
  s_mov_b32 s74, 0x3f800000
  v_mov_b32 v32, 0
  v_mov_b32 v33, 0
  v_mov_b32 v34, 0
  v_mov_b32 v35, 0
  v_mov_b32 v36, 0
  v_mov_b32 v37, 0
  v_mov_b32 v38, 0
  v_mov_b32 v39, 0
  s_branch L_redl
L_gs:
  v_lshrrev_b32 v21, 3, v1
  v_mul_lo_u32 v21, v21, s44
  v_and_b32 v22, 7, v1
  v_lshrrev_b32 v23, 4, v1
  v_xor_b32 v22, v22, v23
  v_lshl_add_u32 v2, v22, 4, v21
  v_xor_b32 v3, 64, v2
  v_lshrrev_b32 v21, 4, v1
  v_mul_lo_u32 v22, v21, s45
  v_and_b32 v23, 15, v1
  v_lshlrev_b32 v21, 2, v21
  v_xor_b32 v23, v23, v21
  v_lshl_add_u32 v4, v23, 4, v22
  s_lshl_b32 s71, s44, 3
  s_lshl_b32 s72, s45, 2
  s_lshl_b32 s31, s44, 5
  s_mul_i32 s31, s31, s29
  s_add_u32 s54, s46, s31
  s_lshl_b32 s31, s45, 4
  s_mul_i32 s31, s31, s29
  s_add_u32 s55, s47, s31
  s_lshl_b32 s51, s29, 12
  s_mov_b32 s50, 0
  s_mov_b32 s85, s54
  s_mov_b32 s86, s55
  s_mov_b32 s83, s48
  s_mul_i32 s84, s48, s82
  s_mov_b32 s93, 0
  s_add_u32 m0, s51, 0
  s_mov_b32 s62, s54
  buffer_load_dwordx4 v2, s[12:15], s62 offen sc1 lds
  s_add_u32 m0, s51, 1024
  s_add_u32 s62, s62, s71
  buffer_load_dwordx4 v3, s[12:15], s62 offen sc1 lds
  s_add_u32 m0, s51, 2048
  s_add_u32 s62, s62, s71
  buffer_load_dwordx4 v2, s[12:15], s62 offen sc1 lds
  s_add_u32 m0, s51, 3072
  s_add_u32 s62, s62, s71
  buffer_load_dwordx4 v3, s[12:15], s62 offen sc1 lds
  s_add_u32 m0, s51, 16384
  s_mov_b32 s63, s55
  buffer_load_dwordx4 v4, s[16:19], s63 offen sc1 lds
  s_add_u32 m0, s51, 17408
  s_add_u32 s63, s63, s72
  buffer_load_dwordx4 v4, s[16:19], s63 offen sc1 lds
  s_add_u32 m0, s51, 18432
  s_add_u32 s63, s63, s72
  buffer_load_dwordx4 v4, s[16:19], s63 offen sc1 lds
  s_add_u32 m0, s51, 19456
  s_add_u32 s63, s63, s72
  buffer_load_dwordx4 v4, s[16:19], s63 offen sc1 lds
  s_add_u32 s54, s54, 128
  s_lshl_b32 s31, s45, 6
  s_add_u32 s55, s55, s31
  s_add_u32 s51, s51, 32768
  s_and_b32 s51, s51, 131071
  s_sub_u32 s84, s84, 1
  s_sub_u32 s83, s83, 1
  s_cmp_eq_u32 s83, 0
  s_cselect_b32 s31, s95, 0
  s_cselect_b32 s32, s94, 0
  s_add_u32 s86, s86, s31
  s_add_u32 s85, s85, s32
  s_cmp_eq_u32 s83, 0
  s_cselect_b32 s54, s85, s54
  s_cselect_b32 s55, s86, s55
  s_cselect_b32 s83, s48, s83
  s_add_u32 m0, s51, 0
  s_mov_b32 s62, s54
  buffer_load_dwordx4 v2, s[12:15], s62 offen sc1 lds
  s_add_u32 m0, s51, 1024
  s_add_u32 s62, s62, s71
  buffer_load_dwordx4 v3, s[12:15], s62 offen sc1 lds
  s_add_u32 m0, s51, 2048
  s_add_u32 s62, s62, s71
  buffer_load_dwordx4 v2, s[12:15], s62 offen sc1 lds
  s_add_u32 m0, s51, 3072
  s_add_u32 s62, s62, s71
  buffer_load_dwordx4 v3, s[12:15], s62 offen sc1 lds
  s_add_u32 m0, s51, 16384
  s_mov_b32 s63, s55
  buffer_load_dwordx4 v4, s[16:19], s63 offen sc1 lds
  s_add_u32 m0, s51, 17408
  s_add_u32 s63, s63, s72
  buffer_load_dwordx4 v4, s[16:19], s63 offen sc1 lds
  s_add_u32 m0, s51, 18432
  s_add_u32 s63, s63, s72
  buffer_load_dwordx4 v4, s[16:19], s63 offen sc1 lds
  s_add_u32 m0, s51, 19456
  s_add_u32 s63, s63, s72
  buffer_load_dwordx4 v4, s[16:19], s63 offen sc1 lds
  s_add_u32 s54, s54, 128
  s_lshl_b32 s31, s45, 6
  s_add_u32 s55, s55, s31
  s_add_u32 s51, s51, 32768
  s_and_b32 s51, s51, 131071
  s_sub_u32 s84, s84, 1
  s_sub_u32 s83, s83, 1
  s_cmp_eq_u32 s83, 0
  s_cselect_b32 s31, s95, 0
  s_cselect_b32 s32, s94, 0
  s_add_u32 s86, s86, s31
  s_add_u32 s85, s85, s32
  s_cmp_eq_u32 s83, 0
  s_cselect_b32 s54, s85, s54
  s_cselect_b32 s55, s86, s55
  s_cselect_b32 s83, s48, s83
  s_add_u32 m0, s51, 0
  s_mov_b32 s62, s54
  buffer_load_dwordx4 v2, s[12:15], s62 offen sc1 lds
  s_add_u32 m0, s51, 1024
  s_add_u32 s62, s62, s71
  buffer_load_dwordx4 v3, s[12:15], s62 offen sc1 lds
  s_add_u32 m0, s51, 2048
  s_add_u32 s62, s62, s71
  buffer_load_dwordx4 v2, s[12:15], s62 offen sc1 lds
  s_add_u32 m0, s51, 3072
  s_add_u32 s62, s62, s71
  buffer_load_dwordx4 v3, s[12:15], s62 offen sc1 lds
  s_add_u32 m0, s51, 16384
  s_mov_b32 s63, s55
  buffer_load_dwordx4 v4, s[16:19], s63 offen sc1 lds
  s_add_u32 m0, s51, 17408
  s_add_u32 s63, s63, s72
  buffer_load_dwordx4 v4, s[16:19], s63 offen sc1 lds
  s_add_u32 m0, s51, 18432
  s_add_u32 s63, s63, s72
  buffer_load_dwordx4 v4, s[16:19], s63 offen sc1 lds
  s_add_u32 m0, s51, 19456
  s_add_u32 s63, s63, s72
  buffer_load_dwordx4 v4, s[16:19], s63 offen sc1 lds
  s_add_u32 s54, s54, 128
  s_lshl_b32 s31, s45, 6
  s_add_u32 s55, s55, s31
  s_add_u32 s51, s51, 32768
  s_and_b32 s51, s51, 131071
  s_sub_u32 s84, s84, 1
  s_sub_u32 s83, s83, 1
  s_cmp_eq_u32 s83, 0
  s_cselect_b32 s31, s95, 0
  s_cselect_b32 s32, s94, 0
  s_add_u32 s86, s86, s31
  s_add_u32 s85, s85, s32
  s_cmp_eq_u32 s83, 0
  s_cselect_b32 s54, s85, s54
  s_cselect_b32 s55, s86, s55
  s_cselect_b32 s83, s48, s83
L_st:
  v_accvgpr_write_b32 a0, 0
  v_accvgpr_write_b32 a1, 0
  v_accvgpr_write_b32 a2, 0
  v_accvgpr_write_b32 a3, 0
  v_accvgpr_write_b32 a4, 0
  v_accvgpr_write_b32 a5, 0
  v_accvgpr_write_b32 a6, 0
  v_accvgpr_write_b32 a7, 0
  v_accvgpr_write_b32 a8, 0
  v_accvgpr_write_b32 a9, 0
  v_accvgpr_write_b32 a10, 0
  v_accvgpr_write_b32 a11, 0
  v_accvgpr_write_b32 a12, 0
  v_accvgpr_write_b32 a13, 0
  v_accvgpr_write_b32 a14, 0
  v_accvgpr_write_b32 a15, 0
  v_accvgpr_write_b32 a16, 0
  v_accvgpr_write_b32 a17, 0
  v_accvgpr_write_b32 a18, 0
  v_accvgpr_write_b32 a19, 0
  v_accvgpr_write_b32 a20, 0
  v_accvgpr_write_b32 a21, 0
  v_accvgpr_write_b32 a22, 0
  v_accvgpr_write_b32 a23, 0
  v_accvgpr_write_b32 a24, 0
  v_accvgpr_write_b32 a25, 0
  v_accvgpr_write_b32 a26, 0
  v_accvgpr_write_b32 a27, 0
  v_accvgpr_write_b32 a28, 0
  v_accvgpr_write_b32 a29, 0
  v_accvgpr_write_b32 a30, 0
  v_accvgpr_write_b32 a31, 0
  v_accvgpr_write_b32 a32, 0
  v_accvgpr_write_b32 a33, 0
  v_accvgpr_write_b32 a34, 0
  v_accvgpr_write_b32 a35, 0
  v_accvgpr_write_b32 a36, 0
  v_accvgpr_write_b32 a37, 0
  v_accvgpr_write_b32 a38, 0
  v_accvgpr_write_b32 a39, 0
  v_accvgpr_write_b32 a40, 0
  v_accvgpr_write_b32 a41, 0
  v_accvgpr_write_b32 a42, 0
  v_accvgpr_write_b32 a43, 0
  v_accvgpr_write_b32 a44, 0
  v_accvgpr_write_b32 a45, 0
  v_accvgpr_write_b32 a46, 0
  v_accvgpr_write_b32 a47, 0
  v_accvgpr_write_b32 a48, 0
  v_accvgpr_write_b32 a49, 0
  v_accvgpr_write_b32 a50, 0
  v_accvgpr_write_b32 a51, 0
  v_accvgpr_write_b32 a52, 0
  v_accvgpr_write_b32 a53, 0
  v_accvgpr_write_b32 a54, 0
  v_accvgpr_write_b32 a55, 0
  v_accvgpr_write_b32 a56, 0
  v_accvgpr_write_b32 a57, 0
  v_accvgpr_write_b32 a58, 0
  v_accvgpr_write_b32 a59, 0
  v_accvgpr_write_b32 a60, 0
  v_accvgpr_write_b32 a61, 0
  v_accvgpr_write_b32 a62, 0
  v_accvgpr_write_b32 a63, 0
  s_mov_b32 s92, 0
L_gl_s:
  s_cmp_eq_u32 s84, 0
  s_cbranch_scc1 L_gn_s
  s_cmp_lt_u32 s92, 3
  s_cselect_b32 s31, s93, 0
  s_cmp_lg_u32 s31, 0
  s_cbranch_scc1 L_gl_sa
  s_waitcnt vmcnt(16)
  s_barrier
  s_cmp_eq_u32 s93, 0
  s_cbranch_scc1 L_ps_67
  s_cmp_eq_u32 s93, 1
  s_cselect_b32 s31, 15, 1
  s_mov_b32 s93, 0
  s_cmp_lg_u32 s29, 0
  s_cbranch_scc1 L_ps_67
  v_mov_b32 v21, 1
  v_lshlrev_b32 v22, 18, v1
  s_mov_b32 exec_lo, s31
  s_mov_b32 exec_hi, 0
  buffer_atomic_add v21, v22, s[4:7], s88 offen
  s_mov_b64 exec, -1
L_ps_67:
  s_branch L_gl_sb
L_gl_sa:
  s_waitcnt vmcnt(24)
  s_barrier
L_gl_sb:
  v_add_u32 v11, s50, v5
  v_add_u32 v12, s50, v6
  v_add_u32 v13, s50, v7
  v_add_u32 v14, s50, v8
  v_add_u32 v15, s50, v9
  v_add_u32 v16, s50, v10
  ds_read_b128 v[32:35], v11 offset:0
  ds_read_b128 v[36:39], v11 offset:4096
  ds_read_b64_tr_b16 v[40:41], v15 offset:0
  ds_read_b64_tr_b16 v[42:43], v15 offset:1024
  ds_read_b64_tr_b16 v[44:45], v16 offset:0
  ds_read_b64_tr_b16 v[46:47], v16 offset:1024
  s_add_u32 s50, s50, 32768
  s_and_b32 s50, s50, 131071
  s_add_u32 m0, s51, 0
  s_mov_b32 s62, s54
  buffer_load_dwordx4 v2, s[12:15], s62 offen sc1 lds
  ds_read_b128 v[48:51], v12 offset:0
  ds_read_b128 v[52:55], v12 offset:4096
  ds_read_b64_tr_b16 v[56:57], v15 offset:4096
  ds_read_b64_tr_b16 v[58:59], v15 offset:5120
  ds_read_b64_tr_b16 v[60:61], v16 offset:4096
  ds_read_b64_tr_b16 v[62:63], v16 offset:5120
  s_waitcnt lgkmcnt(6)
  v_mfma_f32_32x32x16_bf16 a[0:15], v[40:43], v[32:35], a[0:15]
  s_add_u32 m0, s51, 1024
  s_add_u32 s62, s62, s71
  buffer_load_dwordx4 v3, s[12:15], s62 offen sc1 lds
  v_mfma_f32_32x32x16_bf16 a[16:31], v[44:47], v[32:35], a[16:31]
  v_mfma_f32_32x32x16_bf16 a[32:47], v[40:43], v[36:39], a[32:47]
  s_add_u32 m0, s51, 2048
  s_add_u32 s62, s62, s71
  buffer_load_dwordx4 v2, s[12:15], s62 offen sc1 lds
  v_mfma_f32_32x32x16_bf16 a[48:63], v[44:47], v[36:39], a[48:63]
  ds_read_b128 v[32:35], v13 offset:0
  ds_read_b128 v[36:39], v13 offset:4096
  ds_read_b64_tr_b16 v[40:41], v15 offset:8192
  ds_read_b64_tr_b16 v[42:43], v15 offset:9216
  ds_read_b64_tr_b16 v[44:45], v16 offset:8192
  ds_read_b64_tr_b16 v[46:47], v16 offset:9216
  s_waitcnt lgkmcnt(6)
  v_mfma_f32_32x32x16_bf16 a[0:15], v[56:59], v[48:51], a[0:15]
  s_add_u32 m0, s51, 3072
  s_add_u32 s62, s62, s71
  buffer_load_dwordx4 v3, s[12:15], s62 offen sc1 lds
  v_mfma_f32_32x32x16_bf16 a[16:31], v[60:63], v[48:51], a[16:31]
  v_mfma_f32_32x32x16_bf16 a[32:47], v[56:59], v[52:55], a[32:47]
  s_add_u32 m0, s51, 16384
  s_mov_b32 s63, s55
  buffer_load_dwordx4 v4, s[16:19], s63 offen sc1 lds
  v_mfma_f32_32x32x16_bf16 a[48:63], v[60:63], v[52:55], a[48:63]
  ds_read_b128 v[48:51], v14 offset:0
  ds_read_b128 v[52:55], v14 offset:4096
  ds_read_b64_tr_b16 v[56:57], v15 offset:12288
  ds_read_b64_tr_b16 v[58:59], v15 offset:13312
  ds_read_b64_tr_b16 v[60:61], v16 offset:12288
  ds_read_b64_tr_b16 v[62:63], v16 offset:13312
  s_waitcnt lgkmcnt(6)
  v_mfma_f32_32x32x16_bf16 a[0:15], v[40:43], v[32:35], a[0:15]
  s_add_u32 m0, s51, 17408
  s_add_u32 s63, s63, s72
  buffer_load_dwordx4 v4, s[16:19], s63 offen sc1 lds
  v_mfma_f32_32x32x16_bf16 a[16:31], v[44:47], v[32:35], a[16:31]
  v_mfma_f32_32x32x16_bf16 a[32:47], v[40:43], v[36:39], a[32:47]
  s_add_u32 m0, s51, 18432
  s_add_u32 s63, s63, s72
  buffer_load_dwordx4 v4, s[16:19], s63 offen sc1 lds
  v_mfma_f32_32x32x16_bf16 a[48:63], v[44:47], v[36:39], a[48:63]
  s_waitcnt lgkmcnt(0)
  v_mfma_f32_32x32x16_bf16 a[0:15], v[56:59], v[48:51], a[0:15]
  s_add_u32 m0, s51, 19456
  s_add_u32 s63, s63, s72
  buffer_load_dwordx4 v4, s[16:19], s63 offen sc1 lds
  s_add_u32 s54, s54, 128
  s_lshl_b32 s31, s45, 6
  s_add_u32 s55, s55, s31
  s_add_u32 s51, s51, 32768
  s_and_b32 s51, s51, 131071
  s_sub_u32 s84, s84, 1
  s_sub_u32 s83, s83, 1
  s_cmp_eq_u32 s83, 0
  s_cselect_b32 s31, s95, 0
  s_cselect_b32 s32, s94, 0
  s_add_u32 s86, s86, s31
  s_add_u32 s85, s85, s32
  s_cmp_eq_u32 s83, 0
  s_cselect_b32 s54, s85, s54
  s_cselect_b32 s55, s86, s55
  s_cselect_b32 s83, s48, s83
  v_mfma_f32_32x32x16_bf16 a[16:31], v[60:63], v[48:51], a[16:31]
  v_mfma_f32_32x32x16_bf16 a[32:47], v[56:59], v[52:55], a[32:47]
  v_mfma_f32_32x32x16_bf16 a[48:63], v[60:63], v[52:55], a[48:63]
  s_add_u32 s92, s92, 1
  s_cmp_lt_u32 s92, s48
  s_cbranch_scc1 L_gl_s
  s_branch L_gx_s
L_gn_s:
  s_waitcnt vmcnt(16)
  s_barrier
  v_add_u32 v11, s50, v5
  v_add_u32 v12, s50, v6
  v_add_u32 v13, s50, v7
  v_add_u32 v14, s50, v8
  v_add_u32 v15, s50, v9
  v_add_u32 v16, s50, v10
  ds_read_b128 v[32:35], v11 offset:0
  ds_read_b128 v[36:39], v11 offset:4096
  ds_read_b64_tr_b16 v[40:41], v15 offset:0
  ds_read_b64_tr_b16 v[42:43], v15 offset:1024
  ds_read_b64_tr_b16 v[44:45], v16 offset:0
  ds_read_b64_tr_b16 v[46:47], v16 offset:1024
  s_add_u32 s50, s50, 32768
  s_and_b32 s50, s50, 131071
  ds_read_b128 v[48:51], v12 offset:0
  ds_read_b128 v[52:55], v12 offset:4096
  ds_read_b64_tr_b16 v[56:57], v15 offset:4096
  ds_read_b64_tr_b16 v[58:59], v15 offset:5120
  ds_read_b64_tr_b16 v[60:61], v16 offset:4096
  ds_read_b64_tr_b16 v[62:63], v16 offset:5120
  s_waitcnt lgkmcnt(6)
  v_mfma_f32_32x32x16_bf16 a[0:15], v[40:43], v[32:35], a[0:15]
  v_mfma_f32_32x32x16_bf16 a[16:31], v[44:47], v[32:35], a[16:31]
  v_mfma_f32_32x32x16_bf16 a[32:47], v[40:43], v[36:39], a[32:47]
  v_mfma_f32_32x32x16_bf16 a[48:63], v[44:47], v[36:39], a[48:63]
  ds_read_b128 v[32:35], v13 offset:0
  ds_read_b128 v[36:39], v13 offset:4096
  ds_read_b64_tr_b16 v[40:41], v15 offset:8192
  ds_read_b64_tr_b16 v[42:43], v15 offset:9216
  ds_read_b64_tr_b16 v[44:45], v16 offset:8192
  ds_read_b64_tr_b16 v[46:47], v16 offset:9216
  s_waitcnt lgkmcnt(6)
  v_mfma_f32_32x32x16_bf16 a[0:15], v[56:59], v[48:51], a[0:15]
  v_mfma_f32_32x32x16_bf16 a[16:31], v[60:63], v[48:51], a[16:31]
  v_mfma_f32_32x32x16_bf16 a[32:47], v[56:59], v[52:55], a[32:47]
  v_mfma_f32_32x32x16_bf16 a[48:63], v[60:63], v[52:55], a[48:63]
  ds_read_b128 v[48:51], v14 offset:0
  ds_read_b128 v[52:55], v14 offset:4096
  ds_read_b64_tr_b16 v[56:57], v15 offset:12288
  ds_read_b64_tr_b16 v[58:59], v15 offset:13312
  ds_read_b64_tr_b16 v[60:61], v16 offset:12288
  ds_read_b64_tr_b16 v[62:63], v16 offset:13312
  s_waitcnt lgkmcnt(6)
  v_mfma_f32_32x32x16_bf16 a[0:15], v[40:43], v[32:35], a[0:15]
  v_mfma_f32_32x32x16_bf16 a[16:31], v[44:47], v[32:35], a[16:31]
  v_mfma_f32_32x32x16_bf16 a[32:47], v[40:43], v[36:39], a[32:47]
  v_mfma_f32_32x32x16_bf16 a[48:63], v[44:47], v[36:39], a[48:63]
  s_waitcnt lgkmcnt(0)
  v_mfma_f32_32x32x16_bf16 a[0:15], v[56:59], v[48:51], a[0:15]
  v_mfma_f32_32x32x16_bf16 a[16:31], v[60:63], v[48:51], a[16:31]
  v_mfma_f32_32x32x16_bf16 a[32:47], v[56:59], v[52:55], a[32:47]
  v_mfma_f32_32x32x16_bf16 a[48:63], v[60:63], v[52:55], a[48:63]
  s_waitcnt vmcnt(8)
  s_barrier
  v_add_u32 v11, s50, v5
  v_add_u32 v12, s50, v6
  v_add_u32 v13, s50, v7
  v_add_u32 v14, s50, v8
  v_add_u32 v15, s50, v9
  v_add_u32 v16, s50, v10
  ds_read_b128 v[32:35], v11 offset:0
  ds_read_b128 v[36:39], v11 offset:4096
  ds_read_b64_tr_b16 v[40:41], v15 offset:0
  ds_read_b64_tr_b16 v[42:43], v15 offset:1024
  ds_read_b64_tr_b16 v[44:45], v16 offset:0
  ds_read_b64_tr_b16 v[46:47], v16 offset:1024
  s_add_u32 s50, s50, 32768
  s_and_b32 s50, s50, 131071
  ds_read_b128 v[48:51], v12 offset:0
  ds_read_b128 v[52:55], v12 offset:4096
  ds_read_b64_tr_b16 v[56:57], v15 offset:4096
  ds_read_b64_tr_b16 v[58:59], v15 offset:5120
  ds_read_b64_tr_b16 v[60:61], v16 offset:4096
  ds_read_b64_tr_b16 v[62:63], v16 offset:5120
  s_waitcnt lgkmcnt(6)
  v_mfma_f32_32x32x16_bf16 a[0:15], v[40:43], v[32:35], a[0:15]
  v_mfma_f32_32x32x16_bf16 a[16:31], v[44:47], v[32:35], a[16:31]
  v_mfma_f32_32x32x16_bf16 a[32:47], v[40:43], v[36:39], a[32:47]
  v_mfma_f32_32x32x16_bf16 a[48:63], v[44:47], v[36:39], a[48:63]
  ds_read_b128 v[32:35], v13 offset:0
  ds_read_b128 v[36:39], v13 offset:4096
  ds_read_b64_tr_b16 v[40:41], v15 offset:8192
  ds_read_b64_tr_b16 v[42:43], v15 offset:9216
  ds_read_b64_tr_b16 v[44:45], v16 offset:8192
  ds_read_b64_tr_b16 v[46:47], v16 offset:9216
  s_waitcnt lgkmcnt(6)
  v_mfma_f32_32x32x16_bf16 a[0:15], v[56:59], v[48:51], a[0:15]
  v_mfma_f32_32x32x16_bf16 a[16:31], v[60:63], v[48:51], a[16:31]
  v_mfma_f32_32x32x16_bf16 a[32:47], v[56:59], v[52:55], a[32:47]
  v_mfma_f32_32x32x16_bf16 a[48:63], v[60:63], v[52:55], a[48:63]
  ds_read_b128 v[48:51], v14 offset:0
  ds_read_b128 v[52:55], v14 offset:4096
  ds_read_b64_tr_b16 v[56:57], v15 offset:12288
  ds_read_b64_tr_b16 v[58:59], v15 offset:13312
  ds_read_b64_tr_b16 v[60:61], v16 offset:12288
  ds_read_b64_tr_b16 v[62:63], v16 offset:13312
  s_waitcnt lgkmcnt(6)
  v_mfma_f32_32x32x16_bf16 a[0:15], v[40:43], v[32:35], a[0:15]
  v_mfma_f32_32x32x16_bf16 a[16:31], v[44:47], v[32:35], a[16:31]
  v_mfma_f32_32x32x16_bf16 a[32:47], v[40:43], v[36:39], a[32:47]
  v_mfma_f32_32x32x16_bf16 a[48:63], v[44:47], v[36:39], a[48:63]
  s_waitcnt lgkmcnt(0)
  v_mfma_f32_32x32x16_bf16 a[0:15], v[56:59], v[48:51], a[0:15]
  v_mfma_f32_32x32x16_bf16 a[16:31], v[60:63], v[48:51], a[16:31]
  v_mfma_f32_32x32x16_bf16 a[32:47], v[56:59], v[52:55], a[32:47]
  v_mfma_f32_32x32x16_bf16 a[48:63], v[60:63], v[52:55], a[48:63]
  s_waitcnt vmcnt(0)
  s_barrier
  v_add_u32 v11, s50, v5
  v_add_u32 v12, s50, v6
  v_add_u32 v13, s50, v7
  v_add_u32 v14, s50, v8
  v_add_u32 v15, s50, v9
  v_add_u32 v16, s50, v10
  ds_read_b128 v[32:35], v11 offset:0
  ds_read_b128 v[36:39], v11 offset:4096
  ds_read_b64_tr_b16 v[40:41], v15 offset:0
  ds_read_b64_tr_b16 v[42:43], v15 offset:1024
  ds_read_b64_tr_b16 v[44:45], v16 offset:0
  ds_read_b64_tr_b16 v[46:47], v16 offset:1024
  s_add_u32 s50, s50, 32768
  s_and_b32 s50, s50, 131071
  ds_read_b128 v[48:51], v12 offset:0
  ds_read_b128 v[52:55], v12 offset:4096
  ds_read_b64_tr_b16 v[56:57], v15 offset:4096
  ds_read_b64_tr_b16 v[58:59], v15 offset:5120
  ds_read_b64_tr_b16 v[60:61], v16 offset:4096
  ds_read_b64_tr_b16 v[62:63], v16 offset:5120
  s_waitcnt lgkmcnt(6)
  v_mfma_f32_32x32x16_bf16 a[0:15], v[40:43], v[32:35], a[0:15]
  v_mfma_f32_32x32x16_bf16 a[16:31], v[44:47], v[32:35], a[16:31]
  v_mfma_f32_32x32x16_bf16 a[32:47], v[40:43], v[36:39], a[32:47]
  v_mfma_f32_32x32x16_bf16 a[48:63], v[44:47], v[36:39], a[48:63]
  ds_read_b128 v[32:35], v13 offset:0
  ds_read_b128 v[36:39], v13 offset:4096
  ds_read_b64_tr_b16 v[40:41], v15 offset:8192
  ds_read_b64_tr_b16 v[42:43], v15 offset:9216
  ds_read_b64_tr_b16 v[44:45], v16 offset:8192
  ds_read_b64_tr_b16 v[46:47], v16 offset:9216
  s_waitcnt lgkmcnt(6)
  v_mfma_f32_32x32x16_bf16 a[0:15], v[56:59], v[48:51], a[0:15]
  v_mfma_f32_32x32x16_bf16 a[16:31], v[60:63], v[48:51], a[16:31]
  v_mfma_f32_32x32x16_bf16 a[32:47], v[56:59], v[52:55], a[32:47]
  v_mfma_f32_32x32x16_bf16 a[48:63], v[60:63], v[52:55], a[48:63]
  ds_read_b128 v[48:51], v14 offset:0
  ds_read_b128 v[52:55], v14 offset:4096
  ds_read_b64_tr_b16 v[56:57], v15 offset:12288
  ds_read_b64_tr_b16 v[58:59], v15 offset:13312
  ds_read_b64_tr_b16 v[60:61], v16 offset:12288
  ds_read_b64_tr_b16 v[62:63], v16 offset:13312
  s_waitcnt lgkmcnt(6)
  v_mfma_f32_32x32x16_bf16 a[0:15], v[40:43], v[32:35], a[0:15]
  v_mfma_f32_32x32x16_bf16 a[16:31], v[44:47], v[32:35], a[16:31]
  v_mfma_f32_32x32x16_bf16 a[32:47], v[40:43], v[36:39], a[32:47]
  v_mfma_f32_32x32x16_bf16 a[48:63], v[44:47], v[36:39], a[48:63]
  s_waitcnt lgkmcnt(0)
  v_mfma_f32_32x32x16_bf16 a[0:15], v[56:59], v[48:51], a[0:15]
  v_mfma_f32_32x32x16_bf16 a[16:31], v[60:63], v[48:51], a[16:31]
  v_mfma_f32_32x32x16_bf16 a[32:47], v[56:59], v[52:55], a[32:47]
  v_mfma_f32_32x32x16_bf16 a[48:63], v[60:63], v[52:55], a[48:63]
L_gx_s:
  s_nop 15
  v_and_b32 v21, 31, v1
  v_lshrrev_b32 v22, 5, v1
  v_and_b32 v23, 15, v1
  s_lshl_b32 s31, s60, 3
  v_or_b32 v22, s31, v22
  v_xor_b32 v22, v22, v23
  v_lshlrev_b32 v18, 8, v21
  v_lshl_add_u32 v18, v22, 4, v18
  s_lshl_b32 s31, s59, 14
  s_add_u32 s31, s31, 131072
  v_add_u32 v18, s31, v18
  v_accvgpr_read_b32 v64, a0
  v_accvgpr_read_b32 v65, a1
  v_accvgpr_read_b32 v66, a2
  v_accvgpr_read_b32 v67, a3
  v_accvgpr_read_b32 v68, a4
  v_accvgpr_read_b32 v69, a5
  v_accvgpr_read_b32 v70, a6
  v_accvgpr_read_b32 v71, a7
  v_cvt_pk_bf16_f32 v72, v64, v65
  v_cvt_pk_bf16_f32 v73, v66, v67
  v_cvt_pk_bf16_f32 v74, v68, v69
  v_cvt_pk_bf16_f32 v75, v70, v71
  ds_write_b128 v18, v[72:75] offset:0
  v_accvgpr_read_b32 v88, a32
  v_accvgpr_read_b32 v89, a33
  v_accvgpr_read_b32 v90, a34
  v_accvgpr_read_b32 v91, a35
  v_accvgpr_read_b32 v92, a36
  v_accvgpr_read_b32 v93, a37
  v_accvgpr_read_b32 v94, a38
  v_accvgpr_read_b32 v95, a39
  v_cvt_pk_bf16_f32 v96, v88, v89
  v_cvt_pk_bf16_f32 v97, v90, v91
  v_cvt_pk_bf16_f32 v98, v92, v93
  v_cvt_pk_bf16_f32 v99, v94, v95
  ds_write_b128 v18, v[96:99] offset:8192
  v_xor_b32 v19, 32, v18
  v_accvgpr_read_b32 v64, a8
  v_accvgpr_read_b32 v65, a9
  v_accvgpr_read_b32 v66, a10
  v_accvgpr_read_b32 v67, a11
  v_accvgpr_read_b32 v68, a12
  v_accvgpr_read_b32 v69, a13
  v_accvgpr_read_b32 v70, a14
  v_accvgpr_read_b32 v71, a15
  v_cvt_pk_bf16_f32 v72, v64, v65
  v_cvt_pk_bf16_f32 v73, v66, v67
  v_cvt_pk_bf16_f32 v74, v68, v69
  v_cvt_pk_bf16_f32 v75, v70, v71
  ds_write_b128 v19, v[72:75] offset:0
  v_accvgpr_read_b32 v88, a40
  v_accvgpr_read_b32 v89, a41
  v_accvgpr_read_b32 v90, a42
  v_accvgpr_read_b32 v91, a43
  v_accvgpr_read_b32 v92, a44
  v_accvgpr_read_b32 v93, a45
  v_accvgpr_read_b32 v94, a46
  v_accvgpr_read_b32 v95, a47
  v_cvt_pk_bf16_f32 v96, v88, v89
  v_cvt_pk_bf16_f32 v97, v90, v91
  v_cvt_pk_bf16_f32 v98, v92, v93
  v_cvt_pk_bf16_f32 v99, v94, v95
  ds_write_b128 v19, v[96:99] offset:8192
  v_xor_b32 v19, 64, v18
  v_accvgpr_read_b32 v64, a16
  v_accvgpr_read_b32 v65, a17
  v_accvgpr_read_b32 v66, a18
  v_accvgpr_read_b32 v67, a19
  v_accvgpr_read_b32 v68, a20
  v_accvgpr_read_b32 v69, a21
  v_accvgpr_read_b32 v70, a22
  v_accvgpr_read_b32 v71, a23
  v_cvt_pk_bf16_f32 v72, v64, v65
  v_cvt_pk_bf16_f32 v73, v66, v67
  v_cvt_pk_bf16_f32 v74, v68, v69
  v_cvt_pk_bf16_f32 v75, v70, v71
  ds_write_b128 v19, v[72:75] offset:0
  v_accvgpr_read_b32 v88, a48
  v_accvgpr_read_b32 v89, a49
  v_accvgpr_read_b32 v90, a50
  v_accvgpr_read_b32 v91, a51
  v_accvgpr_read_b32 v92, a52
  v_accvgpr_read_b32 v93, a53
  v_accvgpr_read_b32 v94, a54
  v_accvgpr_read_b32 v95, a55
  v_cvt_pk_bf16_f32 v96, v88, v89
  v_cvt_pk_bf16_f32 v97, v90, v91
  v_cvt_pk_bf16_f32 v98, v92, v93
  v_cvt_pk_bf16_f32 v99, v94, v95
  ds_write_b128 v19, v[96:99] offset:8192
  v_xor_b32 v19, 96, v18
  v_accvgpr_read_b32 v64, a24
  v_accvgpr_read_b32 v65, a25
  v_accvgpr_read_b32 v66, a26
  v_accvgpr_read_b32 v67, a27
  v_accvgpr_read_b32 v68, a28
  v_accvgpr_read_b32 v69, a29
  v_accvgpr_read_b32 v70, a30
  v_accvgpr_read_b32 v71, a31
  v_cvt_pk_bf16_f32 v72, v64, v65
  v_cvt_pk_bf16_f32 v73, v66, v67
  v_cvt_pk_bf16_f32 v74, v68, v69
  v_cvt_pk_bf16_f32 v75, v70, v71
  ds_write_b128 v19, v[72:75] offset:0
  v_accvgpr_read_b32 v88, a56
  v_accvgpr_read_b32 v89, a57
  v_accvgpr_read_b32 v90, a58
  v_accvgpr_read_b32 v91, a59
  v_accvgpr_read_b32 v92, a60
  v_accvgpr_read_b32 v93, a61
  v_accvgpr_read_b32 v94, a62
  v_accvgpr_read_b32 v95, a63
  v_cvt_pk_bf16_f32 v96, v88, v89
  v_cvt_pk_bf16_f32 v97, v90, v91
  v_cvt_pk_bf16_f32 v98, v92, v93
  v_cvt_pk_bf16_f32 v99, v94, v95
  ds_write_b128 v19, v[96:99] offset:8192
  s_cmp_eq_u32 s49, 4
  s_cbranch_scc0 L_gate
  v_lshrrev_b32 v21, 4, v1
  v_and_b32 v22, 15, v1
  v_mul_lo_u32 v23, v21, s57
  v_lshl_add_u32 v23, v22, 4, v23
  s_lshl_b32 s31, s29, 5
  s_mul_i32 s32, s31, s57
  s_add_u32 s62, s56, s32
  s_add_u32 s63, s68, s32
  s_lshl_b32 s33, s57, 2
  v_xor_b32 v24, v22, v21
  v_lshlrev_b32 v25, 8, v21
  v_lshl_add_u32 v25, v24, 4, v25
  s_lshl_b32 s34, s29, 13
  s_add_u32 s34, s34, 131072
  v_add_u32 v25, s34, v25
  v_lshlrev_b32 v26, 1, v21
  s_lshl_b32 s34, s29, 6
  s_add_u32 s34, s34, s69
  s_waitcnt lgkmcnt(0)
  s_barrier
  v_xor_b32 v27, 0, v25
  ds_read_b128 v[64:67], v27 offset:0
  v_xor_b32 v27, 64, v25
  ds_read_b128 v[68:71], v27 offset:1024
  v_xor_b32 v27, 128, v25
  ds_read_b128 v[72:75], v27 offset:2048
  v_xor_b32 v27, 192, v25
  ds_read_b128 v[76:79], v27 offset:3072
  v_xor_b32 v27, 0, v25
  ds_read_b128 v[80:83], v27 offset:4096
  v_xor_b32 v27, 64, v25
  ds_read_b128 v[84:87], v27 offset:5120
  v_xor_b32 v27, 128, v25
  ds_read_b128 v[88:91], v27 offset:6144
  v_xor_b32 v27, 192, v25
  ds_read_b128 v[92:95], v27 offset:7168
  s_waitcnt lgkmcnt(7)
  buffer_store_dwordx4 v[64:67], v23, s[4:7], s62 offen sc1
  s_add_u32 s62, s62, s33
  s_waitcnt lgkmcnt(6)
  buffer_store_dwordx4 v[68:71], v23, s[4:7], s62 offen sc1
  s_add_u32 s62, s62, s33
  s_waitcnt lgkmcnt(5)
  buffer_store_dwordx4 v[72:75], v23, s[4:7], s62 offen sc1
  s_add_u32 s62, s62, s33
  s_waitcnt lgkmcnt(4)
  buffer_store_dwordx4 v[76:79], v23, s[4:7], s62 offen sc1
  s_add_u32 s62, s62, s33
  s_waitcnt lgkmcnt(3)
  buffer_store_dwordx4 v[80:83], v23, s[4:7], s62 offen sc1
  s_add_u32 s62, s62, s33
  s_waitcnt lgkmcnt(2)
  buffer_store_dwordx4 v[84:87], v23, s[4:7], s62 offen sc1
  s_add_u32 s62, s62, s33
  s_waitcnt lgkmcnt(1)
  buffer_store_dwordx4 v[88:91], v23, s[4:7], s62 offen sc1
  s_add_u32 s62, s62, s33
  s_waitcnt lgkmcnt(0)
  buffer_store_dwordx4 v[92:95], v23, s[4:7], s62 offen sc1
  s_add_u32 s62, s62, s33
L_nt2:
  s_mov_b32 s88, s61
  s_mov_b32 s93, 2
  s_branch L_drain
L_gate:
  v_lshrrev_b32 v21, 4, v1
  v_and_b32 v22, 15, v1
  v_mul_lo_u32 v23, v21, s57
  v_lshl_add_u32 v23, v22, 4, v23
  s_lshl_b32 s31, s29, 5
  s_mul_i32 s32, s31, s57
  s_add_u32 s62, s56, s32
  s_add_u32 s63, s68, s32
  s_lshl_b32 s33, s57, 2
  v_xor_b32 v24, v22, v21
  v_lshlrev_b32 v25, 8, v21
  v_lshl_add_u32 v25, v24, 4, v25
  s_lshl_b32 s34, s29, 13
  s_add_u32 s34, s34, 131072
  v_add_u32 v25, s34, v25
  v_lshlrev_b32 v26, 1, v21
  s_lshl_b32 s34, s29, 6
  s_add_u32 s34, s34, s69
  s_mov_b32 s35, s63
  s_mov_b32 s36, s62
  buffer_load_dwordx4 v[96:99], v23, s[4:7], s35 offen sc1
  s_add_u32 s35, s35, s33
  buffer_load_ushort v128, v26, s[20:23], s34 offen offset:0
  buffer_load_dwordx4 v[100:103], v23, s[4:7], s35 offen sc1
  s_add_u32 s35, s35, s33
  buffer_load_ushort v129, v26, s[20:23], s34 offen offset:8
  buffer_load_dwordx4 v[104:107], v23, s[4:7], s35 offen sc1
  s_add_u32 s35, s35, s33
  buffer_load_ushort v130, v26, s[20:23], s34 offen offset:16
  buffer_load_dwordx4 v[108:111], v23, s[4:7], s35 offen sc1
  s_add_u32 s35, s35, s33
  buffer_load_ushort v131, v26, s[20:23], s34 offen offset:24
  buffer_load_dwordx4 v[112:115], v23, s[4:7], s35 offen sc1
  s_add_u32 s35, s35, s33
  buffer_load_ushort v132, v26, s[20:23], s34 offen offset:32
  buffer_load_dwordx4 v[116:119], v23, s[4:7], s35 offen sc1
  s_add_u32 s35, s35, s33
  buffer_load_ushort v133, v26, s[20:23], s34 offen offset:40
  buffer_load_dwordx4 v[120:123], v23, s[4:7], s35 offen sc1
  s_add_u32 s35, s35, s33
  buffer_load_ushort v134, v26, s[20:23], s34 offen offset:48
  buffer_load_dwordx4 v[124:127], v23, s[4:7], s35 offen sc1
  s_add_u32 s35, s35, s33
  buffer_load_ushort v135, v26, s[20:23], s34 offen offset:56
  s_waitcnt lgkmcnt(0)
  s_barrier
  v_xor_b32 v27, 0, v25
  ds_read_b128 v[64:67], v27 offset:0
  v_xor_b32 v27, 64, v25
  ds_read_b128 v[68:71], v27 offset:1024
  v_xor_b32 v27, 128, v25
  ds_read_b128 v[72:75], v27 offset:2048
  v_xor_b32 v27, 192, v25
  ds_read_b128 v[76:79], v27 offset:3072
  v_xor_b32 v27, 0, v25
  ds_read_b128 v[80:83], v27 offset:4096
  v_xor_b32 v27, 64, v25
  ds_read_b128 v[84:87], v27 offset:5120
  v_xor_b32 v27, 128, v25
  ds_read_b128 v[88:91], v27 offset:6144
  v_xor_b32 v27, 192, v25
  ds_read_b128 v[92:95], v27 offset:7168
  s_waitcnt vmcnt(0)
  s_waitcnt lgkmcnt(7)
  v_lshlrev_b32 v128, 16, v128
  v_lshlrev_b32 v28, 16, v64
  v_and_b32 v29, 0xffff0000, v64
  v_lshlrev_b32 v30, 16, v96
  v_and_b32 v31, 0xffff0000, v96
  v_add_f32 v28, v28, v128
  v_add_f32 v29, v29, v128
  v_cvt_pk_bf16_f32 v64, v28, v29
  v_lshlrev_b32 v28, 16, v64
  v_and_b32 v29, 0xffff0000, v64
  v_mul_f32 v28, v28, v30
  v_mul_f32 v29, v29, v31
  v_cvt_pk_bf16_f32 v64, v28, v29
  v_lshlrev_b32 v28, 16, v65
  v_and_b32 v29, 0xffff0000, v65
  v_lshlrev_b32 v30, 16, v97
  v_and_b32 v31, 0xffff0000, v97
  v_add_f32 v28, v28, v128
  v_add_f32 v29, v29, v128
  v_cvt_pk_bf16_f32 v65, v28, v29
  v_lshlrev_b32 v28, 16, v65
  v_and_b32 v29, 0xffff0000, v65
  v_mul_f32 v28, v28, v30
  v_mul_f32 v29, v29, v31
  v_cvt_pk_bf16_f32 v65, v28, v29
  v_lshlrev_b32 v28, 16, v66
  v_and_b32 v29, 0xffff0000, v66
  v_lshlrev_b32 v30, 16, v98
  v_and_b32 v31, 0xffff0000, v98
  v_add_f32 v28, v28, v128
  v_add_f32 v29, v29, v128
  v_cvt_pk_bf16_f32 v66, v28, v29
  v_lshlrev_b32 v28, 16, v66
  v_and_b32 v29, 0xffff0000, v66
  v_mul_f32 v28, v28, v30
  v_mul_f32 v29, v29, v31
  v_cvt_pk_bf16_f32 v66, v28, v29
  v_lshlrev_b32 v28, 16, v67
  v_and_b32 v29, 0xffff0000, v67
  v_lshlrev_b32 v30, 16, v99
  v_and_b32 v31, 0xffff0000, v99
  v_add_f32 v28, v28, v128
  v_add_f32 v29, v29, v128
  v_cvt_pk_bf16_f32 v67, v28, v29
  v_lshlrev_b32 v28, 16, v67
  v_and_b32 v29, 0xffff0000, v67
  v_mul_f32 v28, v28, v30
  v_mul_f32 v29, v29, v31
  v_cvt_pk_bf16_f32 v67, v28, v29
  buffer_store_dwordx4 v[64:67], v23, s[4:7], s62 offen sc1
  s_add_u32 s62, s62, s33
  s_waitcnt lgkmcnt(6)
  v_lshlrev_b32 v129, 16, v129
  v_lshlrev_b32 v28, 16, v68
  v_and_b32 v29, 0xffff0000, v68
  v_lshlrev_b32 v30, 16, v100
  v_and_b32 v31, 0xffff0000, v100
  v_add_f32 v28, v28, v129
  v_add_f32 v29, v29, v129
  v_cvt_pk_bf16_f32 v68, v28, v29
  v_lshlrev_b32 v28, 16, v68
  v_and_b32 v29, 0xffff0000, v68
  v_mul_f32 v28, v28, v30
  v_mul_f32 v29, v29, v31
  v_cvt_pk_bf16_f32 v68, v28, v29
  v_lshlrev_b32 v28, 16, v69
  v_and_b32 v29, 0xffff0000, v69
  v_lshlrev_b32 v30, 16, v101
  v_and_b32 v31, 0xffff0000, v101
  v_add_f32 v28, v28, v129
  v_add_f32 v29, v29, v129
  v_cvt_pk_bf16_f32 v69, v28, v29
  v_lshlrev_b32 v28, 16, v69
  v_and_b32 v29, 0xffff0000, v69
  v_mul_f32 v28, v28, v30
  v_mul_f32 v29, v29, v31
  v_cvt_pk_bf16_f32 v69, v28, v29
  v_lshlrev_b32 v28, 16, v70
  v_and_b32 v29, 0xffff0000, v70
  v_lshlrev_b32 v30, 16, v102
  v_and_b32 v31, 0xffff0000, v102
  v_add_f32 v28, v28, v129
  v_add_f32 v29, v29, v129
  v_cvt_pk_bf16_f32 v70, v28, v29
  v_lshlrev_b32 v28, 16, v70
  v_and_b32 v29, 0xffff0000, v70
  v_mul_f32 v28, v28, v30
  v_mul_f32 v29, v29, v31
  v_cvt_pk_bf16_f32 v70, v28, v29
  v_lshlrev_b32 v28, 16, v71
  v_and_b32 v29, 0xffff0000, v71
  v_lshlrev_b32 v30, 16, v103
  v_and_b32 v31, 0xffff0000, v103
  v_add_f32 v28, v28, v129
  v_add_f32 v29, v29, v129
  v_cvt_pk_bf16_f32 v71, v28, v29
  v_lshlrev_b32 v28, 16, v71
  v_and_b32 v29, 0xffff0000, v71
  v_mul_f32 v28, v28, v30
  v_mul_f32 v29, v29, v31
  v_cvt_pk_bf16_f32 v71, v28, v29
  buffer_store_dwordx4 v[68:71], v23, s[4:7], s62 offen sc1
  s_add_u32 s62, s62, s33
  s_waitcnt lgkmcnt(5)
  v_lshlrev_b32 v130, 16, v130
  v_lshlrev_b32 v28, 16, v72
  v_and_b32 v29, 0xffff0000, v72
  v_lshlrev_b32 v30, 16, v104
  v_and_b32 v31, 0xffff0000, v104
  v_add_f32 v28, v28, v130
  v_add_f32 v29, v29, v130
  v_cvt_pk_bf16_f32 v72, v28, v29
  v_lshlrev_b32 v28, 16, v72
  v_and_b32 v29, 0xffff0000, v72
  v_mul_f32 v28, v28, v30
  v_mul_f32 v29, v29, v31
  v_cvt_pk_bf16_f32 v72, v28, v29
  v_lshlrev_b32 v28, 16, v73
  v_and_b32 v29, 0xffff0000, v73
  v_lshlrev_b32 v30, 16, v105
  v_and_b32 v31, 0xffff0000, v105
  v_add_f32 v28, v28, v130
  v_add_f32 v29, v29, v130
  v_cvt_pk_bf16_f32 v73, v28, v29
  v_lshlrev_b32 v28, 16, v73
  v_and_b32 v29, 0xffff0000, v73
  v_mul_f32 v28, v28, v30
  v_mul_f32 v29, v29, v31
  v_cvt_pk_bf16_f32 v73, v28, v29
  v_lshlrev_b32 v28, 16, v74
  v_and_b32 v29, 0xffff0000, v74
  v_lshlrev_b32 v30, 16, v106
  v_and_b32 v31, 0xffff0000, v106
  v_add_f32 v28, v28, v130
  v_add_f32 v29, v29, v130
  v_cvt_pk_bf16_f32 v74, v28, v29
  v_lshlrev_b32 v28, 16, v74
  v_and_b32 v29, 0xffff0000, v74
  v_mul_f32 v28, v28, v30
  v_mul_f32 v29, v29, v31
  v_cvt_pk_bf16_f32 v74, v28, v29
  v_lshlrev_b32 v28, 16, v75
  v_and_b32 v29, 0xffff0000, v75
  v_lshlrev_b32 v30, 16, v107
  v_and_b32 v31, 0xffff0000, v107
  v_add_f32 v28, v28, v130
  v_add_f32 v29, v29, v130
  v_cvt_pk_bf16_f32 v75, v28, v29
  v_lshlrev_b32 v28, 16, v75
  v_and_b32 v29, 0xffff0000, v75
  v_mul_f32 v28, v28, v30
  v_mul_f32 v29, v29, v31
  v_cvt_pk_bf16_f32 v75, v28, v29
  buffer_store_dwordx4 v[72:75], v23, s[4:7], s62 offen sc1
  s_add_u32 s62, s62, s33
  s_waitcnt lgkmcnt(4)
  v_lshlrev_b32 v131, 16, v131
  v_lshlrev_b32 v28, 16, v76
  v_and_b32 v29, 0xffff0000, v76
  v_lshlrev_b32 v30, 16, v108
  v_and_b32 v31, 0xffff0000, v108
  v_add_f32 v28, v28, v131
  v_add_f32 v29, v29, v131
  v_cvt_pk_bf16_f32 v76, v28, v29
  v_lshlrev_b32 v28, 16, v76
  v_and_b32 v29, 0xffff0000, v76
  v_mul_f32 v28, v28, v30
  v_mul_f32 v29, v29, v31
  v_cvt_pk_bf16_f32 v76, v28, v29
  v_lshlrev_b32 v28, 16, v77
  v_and_b32 v29, 0xffff0000, v77
  v_lshlrev_b32 v30, 16, v109
  v_and_b32 v31, 0xffff0000, v109
  v_add_f32 v28, v28, v131
  v_add_f32 v29, v29, v131
  v_cvt_pk_bf16_f32 v77, v28, v29
  v_lshlrev_b32 v28, 16, v77
  v_and_b32 v29, 0xffff0000, v77
  v_mul_f32 v28, v28, v30
  v_mul_f32 v29, v29, v31
  v_cvt_pk_bf16_f32 v77, v28, v29
  v_lshlrev_b32 v28, 16, v78
  v_and_b32 v29, 0xffff0000, v78
  v_lshlrev_b32 v30, 16, v110
  v_and_b32 v31, 0xffff0000, v110
  v_add_f32 v28, v28, v131
  v_add_f32 v29, v29, v131
  v_cvt_pk_bf16_f32 v78, v28, v29
  v_lshlrev_b32 v28, 16, v78
  v_and_b32 v29, 0xffff0000, v78
  v_mul_f32 v28, v28, v30
  v_mul_f32 v29, v29, v31
  v_cvt_pk_bf16_f32 v78, v28, v29
  v_lshlrev_b32 v28, 16, v79
  v_and_b32 v29, 0xffff0000, v79
  v_lshlrev_b32 v30, 16, v111
  v_and_b32 v31, 0xffff0000, v111
  v_add_f32 v28, v28, v131
  v_add_f32 v29, v29, v131
  v_cvt_pk_bf16_f32 v79, v28, v29
  v_lshlrev_b32 v28, 16, v79
  v_and_b32 v29, 0xffff0000, v79
  v_mul_f32 v28, v28, v30
  v_mul_f32 v29, v29, v31
  v_cvt_pk_bf16_f32 v79, v28, v29
  buffer_store_dwordx4 v[76:79], v23, s[4:7], s62 offen sc1
  s_add_u32 s62, s62, s33
  s_waitcnt lgkmcnt(3)
  v_lshlrev_b32 v132, 16, v132
  v_lshlrev_b32 v28, 16, v80
  v_and_b32 v29, 0xffff0000, v80
  v_lshlrev_b32 v30, 16, v112
  v_and_b32 v31, 0xffff0000, v112
  v_add_f32 v28, v28, v132
  v_add_f32 v29, v29, v132
  v_cvt_pk_bf16_f32 v80, v28, v29
  v_lshlrev_b32 v28, 16, v80
  v_and_b32 v29, 0xffff0000, v80
  v_mul_f32 v28, v28, v30
  v_mul_f32 v29, v29, v31
  v_cvt_pk_bf16_f32 v80, v28, v29
  v_lshlrev_b32 v28, 16, v81
  v_and_b32 v29, 0xffff0000, v81
  v_lshlrev_b32 v30, 16, v113
  v_and_b32 v31, 0xffff0000, v113
  v_add_f32 v28, v28, v132
  v_add_f32 v29, v29, v132
  v_cvt_pk_bf16_f32 v81, v28, v29
  v_lshlrev_b32 v28, 16, v81
  v_and_b32 v29, 0xffff0000, v81
  v_mul_f32 v28, v28, v30
  v_mul_f32 v29, v29, v31
  v_cvt_pk_bf16_f32 v81, v28, v29
  v_lshlrev_b32 v28, 16, v82
  v_and_b32 v29, 0xffff0000, v82
  v_lshlrev_b32 v30, 16, v114
  v_and_b32 v31, 0xffff0000, v114
  v_add_f32 v28, v28, v132
  v_add_f32 v29, v29, v132
  v_cvt_pk_bf16_f32 v82, v28, v29
  v_lshlrev_b32 v28, 16, v82
  v_and_b32 v29, 0xffff0000, v82
  v_mul_f32 v28, v28, v30
  v_mul_f32 v29, v29, v31
  v_cvt_pk_bf16_f32 v82, v28, v29
  v_lshlrev_b32 v28, 16, v83
  v_and_b32 v29, 0xffff0000, v83
  v_lshlrev_b32 v30, 16, v115
  v_and_b32 v31, 0xffff0000, v115
  v_add_f32 v28, v28, v132
  v_add_f32 v29, v29, v132
  v_cvt_pk_bf16_f32 v83, v28, v29
  v_lshlrev_b32 v28, 16, v83
  v_and_b32 v29, 0xffff0000, v83
  v_mul_f32 v28, v28, v30
  v_mul_f32 v29, v29, v31
  v_cvt_pk_bf16_f32 v83, v28, v29
  buffer_store_dwordx4 v[80:83], v23, s[4:7], s62 offen sc1
  s_add_u32 s62, s62, s33
  s_waitcnt lgkmcnt(2)
  v_lshlrev_b32 v133, 16, v133
  v_lshlrev_b32 v28, 16, v84
  v_and_b32 v29, 0xffff0000, v84
  v_lshlrev_b32 v30, 16, v116
  v_and_b32 v31, 0xffff0000, v116
  v_add_f32 v28, v28, v133
  v_add_f32 v29, v29, v133
  v_cvt_pk_bf16_f32 v84, v28, v29
  v_lshlrev_b32 v28, 16, v84
  v_and_b32 v29, 0xffff0000, v84
  v_mul_f32 v28, v28, v30
  v_mul_f32 v29, v29, v31
  v_cvt_pk_bf16_f32 v84, v28, v29
  v_lshlrev_b32 v28, 16, v85
  v_and_b32 v29, 0xffff0000, v85
  v_lshlrev_b32 v30, 16, v117
  v_and_b32 v31, 0xffff0000, v117
  v_add_f32 v28, v28, v133
  v_add_f32 v29, v29, v133
  v_cvt_pk_bf16_f32 v85, v28, v29
  v_lshlrev_b32 v28, 16, v85
  v_and_b32 v29, 0xffff0000, v85
  v_mul_f32 v28, v28, v30
  v_mul_f32 v29, v29, v31
  v_cvt_pk_bf16_f32 v85, v28, v29
  v_lshlrev_b32 v28, 16, v86
  v_and_b32 v29, 0xffff0000, v86
  v_lshlrev_b32 v30, 16, v118
  v_and_b32 v31, 0xffff0000, v118
  v_add_f32 v28, v28, v133
  v_add_f32 v29, v29, v133
  v_cvt_pk_bf16_f32 v86, v28, v29
  v_lshlrev_b32 v28, 16, v86
  v_and_b32 v29, 0xffff0000, v86
  v_mul_f32 v28, v28, v30
  v_mul_f32 v29, v29, v31
  v_cvt_pk_bf16_f32 v86, v28, v29
  v_lshlrev_b32 v28, 16, v87
  v_and_b32 v29, 0xffff0000, v87
  v_lshlrev_b32 v30, 16, v119
  v_and_b32 v31, 0xffff0000, v119
  v_add_f32 v28, v28, v133
  v_add_f32 v29, v29, v133
  v_cvt_pk_bf16_f32 v87, v28, v29
  v_lshlrev_b32 v28, 16, v87
  v_and_b32 v29, 0xffff0000, v87
  v_mul_f32 v28, v28, v30
  v_mul_f32 v29, v29, v31
  v_cvt_pk_bf16_f32 v87, v28, v29
  buffer_store_dwordx4 v[84:87], v23, s[4:7], s62 offen sc1
  s_add_u32 s62, s62, s33
  s_waitcnt lgkmcnt(1)
  v_lshlrev_b32 v134, 16, v134
  v_lshlrev_b32 v28, 16, v88
  v_and_b32 v29, 0xffff0000, v88
  v_lshlrev_b32 v30, 16, v120
  v_and_b32 v31, 0xffff0000, v120
  v_add_f32 v28, v28, v134
  v_add_f32 v29, v29, v134
  v_cvt_pk_bf16_f32 v88, v28, v29
  v_lshlrev_b32 v28, 16, v88
  v_and_b32 v29, 0xffff0000, v88
  v_mul_f32 v28, v28, v30
  v_mul_f32 v29, v29, v31
  v_cvt_pk_bf16_f32 v88, v28, v29
  v_lshlrev_b32 v28, 16, v89
  v_and_b32 v29, 0xffff0000, v89
  v_lshlrev_b32 v30, 16, v121
  v_and_b32 v31, 0xffff0000, v121
  v_add_f32 v28, v28, v134
  v_add_f32 v29, v29, v134
  v_cvt_pk_bf16_f32 v89, v28, v29
  v_lshlrev_b32 v28, 16, v89
  v_and_b32 v29, 0xffff0000, v89
  v_mul_f32 v28, v28, v30
  v_mul_f32 v29, v29, v31
  v_cvt_pk_bf16_f32 v89, v28, v29
  v_lshlrev_b32 v28, 16, v90
  v_and_b32 v29, 0xffff0000, v90
  v_lshlrev_b32 v30, 16, v122
  v_and_b32 v31, 0xffff0000, v122
  v_add_f32 v28, v28, v134
  v_add_f32 v29, v29, v134
  v_cvt_pk_bf16_f32 v90, v28, v29
  v_lshlrev_b32 v28, 16, v90
  v_and_b32 v29, 0xffff0000, v90
  v_mul_f32 v28, v28, v30
  v_mul_f32 v29, v29, v31
  v_cvt_pk_bf16_f32 v90, v28, v29
  v_lshlrev_b32 v28, 16, v91
  v_and_b32 v29, 0xffff0000, v91
  v_lshlrev_b32 v30, 16, v123
  v_and_b32 v31, 0xffff0000, v123
  v_add_f32 v28, v28, v134
  v_add_f32 v29, v29, v134
  v_cvt_pk_bf16_f32 v91, v28, v29
  v_lshlrev_b32 v28, 16, v91
  v_and_b32 v29, 0xffff0000, v91
  v_mul_f32 v28, v28, v30
  v_mul_f32 v29, v29, v31
  v_cvt_pk_bf16_f32 v91, v28, v29
  buffer_store_dwordx4 v[88:91], v23, s[4:7], s62 offen sc1
  s_add_u32 s62, s62, s33
  s_waitcnt lgkmcnt(0)
  v_lshlrev_b32 v135, 16, v135
  v_lshlrev_b32 v28, 16, v92
  v_and_b32 v29, 0xffff0000, v92
  v_lshlrev_b32 v30, 16, v124
  v_and_b32 v31, 0xffff0000, v124
  v_add_f32 v28, v28, v135
  v_add_f32 v29, v29, v135
  v_cvt_pk_bf16_f32 v92, v28, v29
  v_lshlrev_b32 v28, 16, v92
  v_and_b32 v29, 0xffff0000, v92
  v_mul_f32 v28, v28, v30
  v_mul_f32 v29, v29, v31
  v_cvt_pk_bf16_f32 v92, v28, v29
  v_lshlrev_b32 v28, 16, v93
  v_and_b32 v29, 0xffff0000, v93
  v_lshlrev_b32 v30, 16, v125
  v_and_b32 v31, 0xffff0000, v125
  v_add_f32 v28, v28, v135
  v_add_f32 v29, v29, v135
  v_cvt_pk_bf16_f32 v93, v28, v29
  v_lshlrev_b32 v28, 16, v93
  v_and_b32 v29, 0xffff0000, v93
  v_mul_f32 v28, v28, v30
  v_mul_f32 v29, v29, v31
  v_cvt_pk_bf16_f32 v93, v28, v29
  v_lshlrev_b32 v28, 16, v94
  v_and_b32 v29, 0xffff0000, v94
  v_lshlrev_b32 v30, 16, v126
  v_and_b32 v31, 0xffff0000, v126
  v_add_f32 v28, v28, v135
  v_add_f32 v29, v29, v135
  v_cvt_pk_bf16_f32 v94, v28, v29
  v_lshlrev_b32 v28, 16, v94
  v_and_b32 v29, 0xffff0000, v94
  v_mul_f32 v28, v28, v30
  v_mul_f32 v29, v29, v31
  v_cvt_pk_bf16_f32 v94, v28, v29
  v_lshlrev_b32 v28, 16, v95
  v_and_b32 v29, 0xffff0000, v95
  v_lshlrev_b32 v30, 16, v127
  v_and_b32 v31, 0xffff0000, v127
  v_add_f32 v28, v28, v135
  v_add_f32 v29, v29, v135
  v_cvt_pk_bf16_f32 v95, v28, v29
  v_lshlrev_b32 v28, 16, v95
  v_and_b32 v29, 0xffff0000, v95
  v_mul_f32 v28, v28, v30
  v_mul_f32 v29, v29, v31
  v_cvt_pk_bf16_f32 v95, v28, v29
  buffer_store_dwordx4 v[92:95], v23, s[4:7], s62 offen sc1
  s_add_u32 s62, s62, s33
  s_waitcnt vmcnt(0)
  s_barrier
  s_cmp_lg_u32 s29, 0
  s_cbranch_scc1 L_sg_68
  v_mov_b32 v21, 1
  s_mov_b64 exec, 1
  buffer_atomic_add v21, v20, s[4:7], s61 offen sc0
  s_waitcnt vmcnt(0)
  v_cmp_eq_u32 vcc, 6, v21
  v_mov_b32 v21, 1
  s_and_b64 exec, exec, vcc
  s_cbranch_execz L_sg_68x
  buffer_store_dword v21, v20, s[4:7], s87 offen sc1
L_sg_68x:
  s_mov_b64 exec, -1
L_sg_68:
  s_branch L_done
L_drain:
  s_waitcnt vmcnt(0)
  s_barrier
  s_cmp_eq_u32 s93, 0
  s_cbranch_scc1 L_ps_69
  s_cmp_eq_u32 s93, 1
  s_cselect_b32 s31, 15, 1
  s_mov_b32 s93, 0
  s_cmp_lg_u32 s29, 0
  s_cbranch_scc1 L_ps_69
  v_mov_b32 v21, 1
  v_lshlrev_b32 v22, 18, v1
  s_mov_b32 exec_lo, s31
  s_mov_b32 exec_hi, 0
  buffer_atomic_add v21, v22, s[4:7], s88 offen
  s_mov_b64 exec, -1
L_ps_69:
  s_branch L_done
L_done:
  s_branch L_claim
L_chk:
  s_mov_b32 s70, 0
  buffer_load_dword v21, v20, s[8:11], 0 offen offset:192 sc1
  s_waitcnt vmcnt(0)
  v_mov_b32 v24, v21
  s_cmp_lg_u32 s29, 0
  v_mov_b32 v21, 0
  s_cbranch_scc1 L_bt_70
  s_mov_b64 exec, 1
  ds_write_b32 v21, v24
  s_mov_b64 exec, -1
  s_waitcnt lgkmcnt(0)
L_bt_70:
  s_barrier
  ds_read_b32 v22, v21
  s_waitcnt lgkmcnt(0)
  v_readfirstlane_b32 s39, v22
  s_barrier
  s_cmp_eq_u32 s39, 0
  s_cbranch_scc1 L_tryrole
  s_cmp_lt_u32 s96, 5
  s_cbranch_scc1 L_claim
  s_branch L_end
L_wdone:
  s_branch L_end
L_chain:
  s_load_dwordx4 s[32:35], s[0:1], 16
  s_load_dwordx4 s[36:39], s[0:1], 32
  v_and_b32 v1, 63, v0
  s_waitcnt lgkmcnt(0)
  s_mov_b32 s12, s32
  s_mov_b32 s13, s33
  s_mov_b32 s14, 0x400000
  s_mov_b32 s15, 0x20000
  s_mov_b32 s16, s34
  s_mov_b32 s17, s35
  s_mov_b32 s18, 0x400000
  s_mov_b32 s19, 0x20000
  s_mov_b32 s20, s36
  s_mov_b32 s21, s37
  s_mov_b32 s22, 0x400000
  s_mov_b32 s23, 0x20000
  s_mov_b32 s24, s38
  s_mov_b32 s25, s39
  s_mov_b32 s26, 0x400000
  s_mov_b32 s27, 0x20000
  v_lshrrev_b32 v20, 4, v1
  v_and_b32 v21, 15, v1
  v_lshlrev_b32 v100, 13, v20
  v_lshl_add_u32 v100, v21, 4, v100
  s_lshl_b32 s31, s30, 8
  s_lshl_b32 s32, s29, 20
  s_add_u32 s31, s31, s32
  v_add_u32 v100, s31, v100
  v_lshlrev_b32 v101, 10, v20
  v_lshl_add_u32 v101, v21, 4, v101
  s_lshl_b32 s31, s30, 17
  s_lshl_b32 s32, s29, 8
  s_add_u32 s31, s31, s32
  v_add_u32 v101, s31, v101
  s_mul_i32 s33, s29, 36864
  s_lshl_b32 s34, s29, 14
  s_add_u32 m0, s34, 0
  s_mov_b32 s40, 0
  buffer_load_dwordx4 v101, s[24:27], s40 offen lds
  s_add_u32 m0, s34, 1024
  s_mov_b32 s40, 4096
  buffer_load_dwordx4 v101, s[24:27], s40 offen lds
  s_add_u32 m0, s34, 2048
  s_mov_b32 s40, 8192
  buffer_load_dwordx4 v101, s[24:27], s40 offen lds
  s_add_u32 m0, s34, 3072
  s_mov_b32 s40, 12288
  buffer_load_dwordx4 v101, s[24:27], s40 offen lds
  s_add_u32 m0, s34, 4096
  s_mov_b32 s40, 16384
  buffer_load_dwordx4 v101, s[24:27], s40 offen lds
  s_add_u32 m0, s34, 5120
  s_mov_b32 s40, 20480
  buffer_load_dwordx4 v101, s[24:27], s40 offen lds
  s_add_u32 m0, s34, 6144
  s_mov_b32 s40, 24576
  buffer_load_dwordx4 v101, s[24:27], s40 offen lds
  s_add_u32 m0, s34, 7168
  s_mov_b32 s40, 28672
  buffer_load_dwordx4 v101, s[24:27], s40 offen lds
  s_add_u32 m0, s34, 8192
  s_mov_b32 s40, 32768
  buffer_load_dwordx4 v101, s[24:27], s40 offen lds
  s_add_u32 m0, s34, 9216
  s_mov_b32 s40, 36864
  buffer_load_dwordx4 v101, s[24:27], s40 offen lds
  s_add_u32 m0, s34, 10240
  s_mov_b32 s40, 40960
  buffer_load_dwordx4 v101, s[24:27], s40 offen lds
  s_add_u32 m0, s34, 11264
  s_mov_b32 s40, 45056
  buffer_load_dwordx4 v101, s[24:27], s40 offen lds
  s_add_u32 m0, s34, 12288
  s_mov_b32 s40, 49152
  buffer_load_dwordx4 v101, s[24:27], s40 offen lds
  s_add_u32 m0, s34, 13312
  s_mov_b32 s40, 53248
  buffer_load_dwordx4 v101, s[24:27], s40 offen lds
  s_add_u32 m0, s34, 14336
  s_mov_b32 s40, 57344
  buffer_load_dwordx4 v101, s[24:27], s40 offen lds
  s_add_u32 m0, s34, 15360
  s_mov_b32 s40, 61440
  buffer_load_dwordx4 v101, s[24:27], s40 offen lds
  s_add_u32 m0, s34, 65536
  s_mov_b32 s40, 65536
  buffer_load_dwordx4 v101, s[24:27], s40 offen lds
  s_add_u32 m0, s34, 66560
  s_mov_b32 s40, 69632
  buffer_load_dwordx4 v101, s[24:27], s40 offen lds
  s_add_u32 m0, s34, 67584
  s_mov_b32 s40, 73728
  buffer_load_dwordx4 v101, s[24:27], s40 offen lds
  s_add_u32 m0, s34, 68608
  s_mov_b32 s40, 77824
  buffer_load_dwordx4 v101, s[24:27], s40 offen lds
  s_add_u32 m0, s34, 69632
  s_mov_b32 s40, 81920
  buffer_load_dwordx4 v101, s[24:27], s40 offen lds
  s_add_u32 m0, s34, 70656
  s_mov_b32 s40, 86016
  buffer_load_dwordx4 v101, s[24:27], s40 offen lds
  s_add_u32 m0, s34, 71680
  s_mov_b32 s40, 90112
  buffer_load_dwordx4 v101, s[24:27], s40 offen lds
  s_add_u32 m0, s34, 72704
  s_mov_b32 s40, 94208
  buffer_load_dwordx4 v101, s[24:27], s40 offen lds
  s_add_u32 m0, s34, 73728
  s_mov_b32 s40, 98304
  buffer_load_dwordx4 v101, s[24:27], s40 offen lds
  s_add_u32 m0, s34, 74752
  s_mov_b32 s40, 102400
  buffer_load_dwordx4 v101, s[24:27], s40 offen lds
  s_add_u32 m0, s34, 75776
  s_mov_b32 s40, 106496
  buffer_load_dwordx4 v101, s[24:27], s40 offen lds
  s_add_u32 m0, s34, 76800
  s_mov_b32 s40, 110592
  buffer_load_dwordx4 v101, s[24:27], s40 offen lds
  s_add_u32 m0, s34, 77824
  s_mov_b32 s40, 114688
  buffer_load_dwordx4 v101, s[24:27], s40 offen lds
  s_add_u32 m0, s34, 78848
  s_mov_b32 s40, 118784
  buffer_load_dwordx4 v101, s[24:27], s40 offen lds
  s_add_u32 m0, s34, 79872
  s_mov_b32 s40, 122880
  buffer_load_dwordx4 v101, s[24:27], s40 offen lds
  s_add_u32 m0, s34, 80896
  s_mov_b32 s40, 126976
  buffer_load_dwordx4 v101, s[24:27], s40 offen lds
  v_lshrrev_b32 v22, 4, v1
  v_and_b32 v23, 15, v1
  v_bfe_u32 v24, v1, 2, 2
  v_and_b32 v25, 3, v1
  v_lshrrev_b32 v26, 1, v22
  v_and_b32 v27, 1, v22
  v_lshrrev_b32 v28, 1, v24
  v_and_b32 v29, 1, v24
  v_lshl_add_u32 v18, v26, 2, v27
  v_lshl_add_u32 v18, v28, 1, v18
  v_lshl_add_u32 v18, v29, 4, v18
  v_lshlrev_b32 v18, 8, v18
  v_lshl_add_u32 v18, v25, 4, v18
  s_lshl_b32 s35, s29, 6
  s_add_u32 s35, s35, s34
  v_add_u32 v102, s35, v18
  v_xor_b32 v103, 0x4000, v102
  v_xor_b32 v104, 0x8000, v102
  v_xor_b32 v105, 0xc000, v102
  v_add_u32 v106, 0x10000, v102
  v_add_u32 v107, 0x10000, v103
  v_add_u32 v108, 0x10000, v104
  v_add_u32 v109, 0x10000, v105
  v_lshl_add_u32 v19, v26, 3, v29
  v_lshl_add_u32 v19, v27, 2, v19
  v_lshlrev_b32 v19, 8, v19
  v_lshl_add_u32 v19, v28, 5, v19
  v_lshl_add_u32 v19, v25, 3, v19
  v_add_u32 v110, s34, v19
  v_lshlrev_b32 v30, 4, v1
  v_add_u32 v2, s33, v30
  v_lshlrev_b32 v31, 2, v1
  s_xor_b32 s35, s29, 0
  s_lshl_b32 s35, s35, 11
  s_add_u32 s36, s35, 147456
  v_add_u32 v3, s36, v30
  s_add_u32 s36, s35, 156672
  v_add_u32 v7, s36, v31
  s_xor_b32 s35, s29, 1
  s_lshl_b32 s35, s35, 11
  s_add_u32 s36, s35, 147456
  v_add_u32 v4, s36, v30
  s_add_u32 s36, s35, 156672
  v_add_u32 v8, s36, v31
  s_xor_b32 s35, s29, 2
  s_lshl_b32 s35, s35, 11
  s_add_u32 s36, s35, 147456
  v_add_u32 v5, s36, v30
  s_add_u32 s36, s35, 156672
  v_add_u32 v9, s36, v31
  s_xor_b32 s35, s29, 3
  s_lshl_b32 s35, s35, 11
  s_add_u32 s36, s35, 147456
  v_add_u32 v6, s36, v30
  s_add_u32 s36, s35, 156672
  v_add_u32 v10, s36, v31
  s_lshl_b32 s35, s29, 11
  s_add_u32 s35, s35, 155648
  v_lshlrev_b32 v11, 7, v22
  v_lshl_add_u32 v11, v23, 2, v11
  v_add_u32 v11, s35, v11
  v_and_b32 v32, 7, v23
  v_lshrrev_b32 v33, 3, v23
  v_lshlrev_b32 v12, 6, v32
  v_lshl_add_u32 v12, v27, 4, v12
  v_mov_b32 v34, 1280
  v_cmp_eq_u32 vcc, v26, v33
  s_nop 1
  v_cndmask_b32 v12, v34, v12, vcc
  v_add_u32 v12, s35, v12
  v_lshl_add_u32 v35, v24, 1, v26
  v_lshlrev_b32 v13, 6, v35
  v_lshl_add_u32 v13, v27, 4, v13
  v_add_u32 v13, s35, v13
  v_add_u32 v13, 512, v13
  v_and_b32 v36, 1, v1
  v_lshl_add_u32 v13, v36, 5, v13
  v_lshlrev_b32 v111, 8, v35
  v_lshl_add_u32 v111, v27, 4, v111
  v_lshl_add_u32 v111, v36, 5, v111
  s_lshl_b32 s36, s29, 6
  v_add_u32 v111, s36, v111
  v_cmp_eq_u32 s[52:53], 0, v33
  v_cmp_eq_u32 s[54:55], 1, v33
  v_lshlrev_b32 v14, 7, v22
  v_lshl_add_u32 v14, v32, 4, v14
  s_lshl_b32 s36, s29, 9
  s_add_u32 s36, s36, 147456
  v_add_u32 v14, s36, v14
  v_lshlrev_b32 v36, 4, v32
  v_lshl_add_u32 v36, v22, 7, v36
  v_add_u32 v36, s35, v36
  v_add_u32 v36, 1536, v36
  v_cndmask_b32 v14, v14, v36, s[54:55]
  v_add_u32 v15, 147456, v30
  v_bfe_u32 v38, v1, 1, 1
  v_mov_b32 v96, 0x4444
  v_mov_b32 v39, 0xeeee
  v_cmp_eq_u32 vcc, 1, v38
  s_nop 1
  v_cndmask_b32 v96, v96, v39, vcc
  s_lshl_b32 s36, s29, 3
  v_add_u32 v97, s36, v22
  v_lshlrev_b32 v97, 14, v97
  v_lshl_add_u32 v97, v24, 11, v97
  v_lshl_add_u32 v97, v25, 4, v97
  s_lshl_b32 s36, s30, 6
  v_add_u32 v97, s36, v97
  s_lshl_b32 s36, s30, 14
  s_lshl_b32 s37, s29, 11
  s_add_u32 s36, s36, s37
  s_add_u32 s47, s36, 376832
  v_lshlrev_b32 v99, 7, v26
  v_lshl_add_u32 v99, v25, 3, v99
  v_lshl_add_u32 v99, v27, 2, v99
  s_lshl_b32 s36, s30, 8
  s_lshl_b32 s37, s29, 5
  s_add_u32 s36, s36, s37
  v_add_u32 v99, s36, v99
  s_mov_b32 s56, 0x000f000f
  s_mov_b32 s57, 0x000f000f
  v_and_b32 v40, 1, v1
  v_lshlrev_b32 v98, 8, v24
  v_lshl_add_u32 v98, v40, 7, v98
  v_lshl_add_u32 v98, v22, 5, v98
  v_lshl_add_u32 v98, v38, 4, v98
  s_lshl_b32 s36, s29, 11
  v_add_u32 v98, s36, v98
  s_mov_b32 s50, 0x3e0293ee
  v_mov_b32 v44, -1
  v_mov_b32 v45, -1
  v_mov_b32 v46, -1
  v_mov_b32 v47, -1
  buffer_store_dwordx4 v[44:47], v15, s[4:7], s47 offen sc1
  buffer_store_dwordx4 v[44:47], v15, s[4:7], s47 offen offset:1024 sc1
  s_load_dwordx2 s[36:37], s[0:1], 8
  s_mov_b64 exec, s[56:57]
  s_mov_b32 s38, 1056768
  buffer_store_dword v44, v99, s[4:7], s38 offen sc1
  s_mov_b32 s38, 1064960
  buffer_store_dword v44, v99, s[4:7], s38 offen sc1
  s_mov_b32 s38, 1073152
  buffer_store_dword v44, v99, s[4:7], s38 offen sc1
  s_mov_b64 exec, -1
  s_and_b32 s38, s30, 3
  s_lshl_b32 s38, s38, 11
  s_lshr_b32 s39, s30, 2
  s_lshl_b32 s39, s39, 7
  s_add_u32 s38, s38, s39
  s_lshl_b32 s39, s29, 3
  s_add_u32 s38, s38, s39
  v_lshlrev_b32 v41, 10, v26
  v_lshl_add_u32 v41, v25, 1, v41
  v_lshl_add_u32 v41, v27, 6, v41
  v_add_u32 v41, s38, v41
  s_waitcnt lgkmcnt(0)
  global_load_ushort v48, v41, s[36:37]
  global_load_ushort v49, v41, s[36:37] offset:32
  s_waitcnt vmcnt(16)
  ds_read_b64_tr_b16 a[128:129], v110 offset:0
  ds_read_b64_tr_b16 a[130:131], v110 offset:512
  ds_read_b64_tr_b16 a[132:133], v110 offset:4096
  ds_read_b64_tr_b16 a[134:135], v110 offset:4608
  ds_read_b64_tr_b16 a[136:137], v110 offset:8192
  ds_read_b64_tr_b16 a[138:139], v110 offset:8704
  ds_read_b64_tr_b16 a[140:141], v110 offset:12288
  ds_read_b64_tr_b16 a[142:143], v110 offset:12800
  ds_read_b64_tr_b16 a[160:161], v110 offset:64
  ds_read_b64_tr_b16 a[162:163], v110 offset:576
  ds_read_b64_tr_b16 a[164:165], v110 offset:4160
  ds_read_b64_tr_b16 a[166:167], v110 offset:4672
  ds_read_b64_tr_b16 a[168:169], v110 offset:8256
  ds_read_b64_tr_b16 a[170:171], v110 offset:8768
  ds_read_b64_tr_b16 a[172:173], v110 offset:12352
  ds_read_b64_tr_b16 a[174:175], v110 offset:12864
  ds_read_b64_tr_b16 a[192:193], v110 offset:128
  ds_read_b64_tr_b16 a[194:195], v110 offset:640
  ds_read_b64_tr_b16 a[196:197], v110 offset:4224
  ds_read_b64_tr_b16 a[198:199], v110 offset:4736
  ds_read_b64_tr_b16 a[200:201], v110 offset:8320
  ds_read_b64_tr_b16 a[202:203], v110 offset:8832
  ds_read_b64_tr_b16 a[204:205], v110 offset:12416
  ds_read_b64_tr_b16 a[206:207], v110 offset:12928
  ds_read_b64_tr_b16 v[16:17], v110 offset:192
  ds_read_b64_tr_b16 v[18:19], v110 offset:704
  ds_read_b64_tr_b16 v[20:21], v110 offset:4288
  ds_read_b64_tr_b16 v[22:23], v110 offset:4800
  ds_read_b64_tr_b16 v[24:25], v110 offset:8384
  ds_read_b64_tr_b16 v[26:27], v110 offset:8896
  ds_read_b64_tr_b16 v[28:29], v110 offset:12480
  ds_read_b64_tr_b16 v[30:31], v110 offset:12992
  s_waitcnt lgkmcnt(0)
  v_add_u32 v32, 4294950912, v3
  ds_write_b128 v32, v[16:19]
  v_add_u32 v32, 4294951936, v3
  ds_write_b128 v32, v[20:23]
  v_add_u32 v32, 4294959104, v3
  ds_write_b128 v32, v[24:27]
  v_add_u32 v32, 4294960128, v3
  ds_write_b128 v32, v[28:31]
  s_waitcnt lgkmcnt(0)
  s_barrier
  s_add_u32 m0, s34, 0
  s_mov_b32 s40, 0
  buffer_load_dwordx4 v100, s[20:23], s40 offen lds
  s_add_u32 m0, s34, 1024
  s_mov_b32 s40, 32768
  buffer_load_dwordx4 v100, s[20:23], s40 offen lds
  s_add_u32 m0, s34, 2048
  s_mov_b32 s40, 65536
  buffer_load_dwordx4 v100, s[20:23], s40 offen lds
  s_add_u32 m0, s34, 3072
  s_mov_b32 s40, 98304
  buffer_load_dwordx4 v100, s[20:23], s40 offen lds
  s_add_u32 m0, s34, 4096
  s_mov_b32 s40, 131072
  buffer_load_dwordx4 v100, s[20:23], s40 offen lds
  s_add_u32 m0, s34, 5120
  s_mov_b32 s40, 163840
  buffer_load_dwordx4 v100, s[20:23], s40 offen lds
  s_add_u32 m0, s34, 6144
  s_mov_b32 s40, 196608
  buffer_load_dwordx4 v100, s[20:23], s40 offen lds
  s_add_u32 m0, s34, 7168
  s_mov_b32 s40, 229376
  buffer_load_dwordx4 v100, s[20:23], s40 offen lds
  s_add_u32 m0, s34, 8192
  s_mov_b32 s40, 262144
  buffer_load_dwordx4 v100, s[20:23], s40 offen lds
  s_add_u32 m0, s34, 9216
  s_mov_b32 s40, 294912
  buffer_load_dwordx4 v100, s[20:23], s40 offen lds
  s_add_u32 m0, s34, 10240
  s_mov_b32 s40, 327680
  buffer_load_dwordx4 v100, s[20:23], s40 offen lds
  s_add_u32 m0, s34, 11264
  s_mov_b32 s40, 360448
  buffer_load_dwordx4 v100, s[20:23], s40 offen lds
  s_add_u32 m0, s34, 12288
  s_mov_b32 s40, 393216
  buffer_load_dwordx4 v100, s[20:23], s40 offen lds
  s_add_u32 m0, s34, 13312
  s_mov_b32 s40, 425984
  buffer_load_dwordx4 v100, s[20:23], s40 offen lds
  s_add_u32 m0, s34, 14336
  s_mov_b32 s40, 458752
  buffer_load_dwordx4 v100, s[20:23], s40 offen lds
  s_add_u32 m0, s34, 15360
  s_mov_b32 s40, 491520
  buffer_load_dwordx4 v100, s[20:23], s40 offen lds
  s_waitcnt vmcnt(16)
  v_add_u32 v110, 0x10000, v110
  ds_read_b64_tr_b16 a[144:145], v110 offset:0
  ds_read_b64_tr_b16 a[146:147], v110 offset:512
  ds_read_b64_tr_b16 a[148:149], v110 offset:4096
  ds_read_b64_tr_b16 a[150:151], v110 offset:4608
  ds_read_b64_tr_b16 a[152:153], v110 offset:8192
  ds_read_b64_tr_b16 a[154:155], v110 offset:8704
  ds_read_b64_tr_b16 a[156:157], v110 offset:12288
  ds_read_b64_tr_b16 a[158:159], v110 offset:12800
  ds_read_b64_tr_b16 a[176:177], v110 offset:64
  ds_read_b64_tr_b16 a[178:179], v110 offset:576
  ds_read_b64_tr_b16 a[180:181], v110 offset:4160
  ds_read_b64_tr_b16 a[182:183], v110 offset:4672
  ds_read_b64_tr_b16 a[184:185], v110 offset:8256
  ds_read_b64_tr_b16 a[186:187], v110 offset:8768
  ds_read_b64_tr_b16 a[188:189], v110 offset:12352
  ds_read_b64_tr_b16 a[190:191], v110 offset:12864
  ds_read_b64_tr_b16 a[208:209], v110 offset:128
  ds_read_b64_tr_b16 a[210:211], v110 offset:640
  ds_read_b64_tr_b16 a[212:213], v110 offset:4224
  ds_read_b64_tr_b16 a[214:215], v110 offset:4736
  ds_read_b64_tr_b16 a[216:217], v110 offset:8320
  ds_read_b64_tr_b16 a[218:219], v110 offset:8832
  ds_read_b64_tr_b16 a[220:221], v110 offset:12416
  ds_read_b64_tr_b16 a[222:223], v110 offset:12928
  ds_read_b64_tr_b16 v[16:17], v110 offset:192
  ds_read_b64_tr_b16 v[18:19], v110 offset:704
  ds_read_b64_tr_b16 v[20:21], v110 offset:4288
  ds_read_b64_tr_b16 v[22:23], v110 offset:4800
  ds_read_b64_tr_b16 v[24:25], v110 offset:8384
  ds_read_b64_tr_b16 v[26:27], v110 offset:8896
  ds_read_b64_tr_b16 v[28:29], v110 offset:12480
  ds_read_b64_tr_b16 v[30:31], v110 offset:12992
  v_subrev_u32 v110, 0x10000, v110
  s_waitcnt lgkmcnt(0)
  v_add_u32 v32, 0, v3
  ds_write_b128 v32, v[16:19]
  v_add_u32 v32, 1024, v3
  ds_write_b128 v32, v[20:23]
  v_add_u32 v32, 8192, v3
  ds_write_b128 v32, v[24:27]
  v_add_u32 v32, 9216, v3
  ds_write_b128 v32, v[28:31]
  s_waitcnt lgkmcnt(0)
  s_barrier
  s_add_u32 m0, s34, 65536
  s_mov_b32 s40, 524288
  buffer_load_dwordx4 v100, s[20:23], s40 offen lds
  s_add_u32 m0, s34, 66560
  s_mov_b32 s40, 557056
  buffer_load_dwordx4 v100, s[20:23], s40 offen lds
  s_add_u32 m0, s34, 67584
  s_mov_b32 s40, 589824
  buffer_load_dwordx4 v100, s[20:23], s40 offen lds
  s_add_u32 m0, s34, 68608
  s_mov_b32 s40, 622592
  buffer_load_dwordx4 v100, s[20:23], s40 offen lds
  s_add_u32 m0, s34, 69632
  s_mov_b32 s40, 655360
  buffer_load_dwordx4 v100, s[20:23], s40 offen lds
  s_add_u32 m0, s34, 70656
  s_mov_b32 s40, 688128
  buffer_load_dwordx4 v100, s[20:23], s40 offen lds
  s_add_u32 m0, s34, 71680
  s_mov_b32 s40, 720896
  buffer_load_dwordx4 v100, s[20:23], s40 offen lds
  s_add_u32 m0, s34, 72704
  s_mov_b32 s40, 753664
  buffer_load_dwordx4 v100, s[20:23], s40 offen lds
  s_add_u32 m0, s34, 73728
  s_mov_b32 s40, 786432
  buffer_load_dwordx4 v100, s[20:23], s40 offen lds
  s_add_u32 m0, s34, 74752
  s_mov_b32 s40, 819200
  buffer_load_dwordx4 v100, s[20:23], s40 offen lds
  s_add_u32 m0, s34, 75776
  s_mov_b32 s40, 851968
  buffer_load_dwordx4 v100, s[20:23], s40 offen lds
  s_add_u32 m0, s34, 76800
  s_mov_b32 s40, 884736
  buffer_load_dwordx4 v100, s[20:23], s40 offen lds
  s_add_u32 m0, s34, 77824
  s_mov_b32 s40, 917504
  buffer_load_dwordx4 v100, s[20:23], s40 offen lds
  s_add_u32 m0, s34, 78848
  s_mov_b32 s40, 950272
  buffer_load_dwordx4 v100, s[20:23], s40 offen lds
  s_add_u32 m0, s34, 79872
  s_mov_b32 s40, 983040
  buffer_load_dwordx4 v100, s[20:23], s40 offen lds
  s_add_u32 m0, s34, 80896
  s_mov_b32 s40, 1015808
  buffer_load_dwordx4 v100, s[20:23], s40 offen lds
  s_waitcnt vmcnt(16)
  v_lshl_or_b32 v48, v49, 16, v48
  v_min_u32 v48, -2, v48
  s_mov_b32 s38, 1048576
  s_mov_b64 exec, s[56:57]
  buffer_store_dword v48, v99, s[4:7], s38 offen sc1
  s_mov_b64 exec, -1
  s_barrier
  ds_read_b64_tr_b16 a[0:1], v102 offset:0
  ds_read_b64_tr_b16 a[2:3], v102 offset:8192
  ds_read_b64_tr_b16 a[4:5], v102 offset:2048
  ds_read_b64_tr_b16 a[6:7], v102 offset:10240
  ds_read_b64_tr_b16 a[8:9], v102 offset:8
  ds_read_b64_tr_b16 a[10:11], v102 offset:8200
  ds_read_b64_tr_b16 a[12:13], v102 offset:2056
  ds_read_b64_tr_b16 a[14:15], v102 offset:10248
  ds_read_b64_tr_b16 a[32:33], v103 offset:0
  ds_read_b64_tr_b16 a[34:35], v103 offset:8192
  ds_read_b64_tr_b16 a[36:37], v103 offset:2048
  ds_read_b64_tr_b16 a[38:39], v103 offset:10240
  ds_read_b64_tr_b16 a[40:41], v103 offset:8
  ds_read_b64_tr_b16 a[42:43], v103 offset:8200
  ds_read_b64_tr_b16 a[44:45], v103 offset:2056
  ds_read_b64_tr_b16 a[46:47], v103 offset:10248
  ds_read_b64_tr_b16 a[64:65], v104 offset:0
  ds_read_b64_tr_b16 a[66:67], v104 offset:8192
  ds_read_b64_tr_b16 a[68:69], v104 offset:2048
  ds_read_b64_tr_b16 a[70:71], v104 offset:10240
  ds_read_b64_tr_b16 a[72:73], v104 offset:8
  ds_read_b64_tr_b16 a[74:75], v104 offset:8200
  ds_read_b64_tr_b16 a[76:77], v104 offset:2056
  ds_read_b64_tr_b16 a[78:79], v104 offset:10248
  ds_read_b64_tr_b16 a[96:97], v105 offset:0
  ds_read_b64_tr_b16 a[98:99], v105 offset:8192
  ds_read_b64_tr_b16 a[100:101], v105 offset:2048
  ds_read_b64_tr_b16 a[102:103], v105 offset:10240
  ds_read_b64_tr_b16 a[104:105], v105 offset:8
  ds_read_b64_tr_b16 a[106:107], v105 offset:8200
  ds_read_b64_tr_b16 a[108:109], v105 offset:2056
  ds_read_b64_tr_b16 a[110:111], v105 offset:10248
  s_waitcnt lgkmcnt(0)
  s_barrier
  s_add_u32 m0, s34, 0
  s_mov_b32 s40, 0
  buffer_load_dwordx4 v100, s[16:19], s40 offen lds
  s_add_u32 m0, s34, 1024
  s_mov_b32 s40, 32768
  buffer_load_dwordx4 v100, s[16:19], s40 offen lds
  s_add_u32 m0, s34, 2048
  s_mov_b32 s40, 65536
  buffer_load_dwordx4 v100, s[16:19], s40 offen lds
  s_add_u32 m0, s34, 3072
  s_mov_b32 s40, 98304
  buffer_load_dwordx4 v100, s[16:19], s40 offen lds
  s_add_u32 m0, s34, 4096
  s_mov_b32 s40, 131072
  buffer_load_dwordx4 v100, s[16:19], s40 offen lds
  s_add_u32 m0, s34, 5120
  s_mov_b32 s40, 163840
  buffer_load_dwordx4 v100, s[16:19], s40 offen lds
  s_add_u32 m0, s34, 6144
  s_mov_b32 s40, 196608
  buffer_load_dwordx4 v100, s[16:19], s40 offen lds
  s_add_u32 m0, s34, 7168
  s_mov_b32 s40, 229376
  buffer_load_dwordx4 v100, s[16:19], s40 offen lds
  s_add_u32 m0, s34, 8192
  s_mov_b32 s40, 262144
  buffer_load_dwordx4 v100, s[16:19], s40 offen lds
  s_add_u32 m0, s34, 9216
  s_mov_b32 s40, 294912
  buffer_load_dwordx4 v100, s[16:19], s40 offen lds
  s_add_u32 m0, s34, 10240
  s_mov_b32 s40, 327680
  buffer_load_dwordx4 v100, s[16:19], s40 offen lds
  s_add_u32 m0, s34, 11264
  s_mov_b32 s40, 360448
  buffer_load_dwordx4 v100, s[16:19], s40 offen lds
  s_add_u32 m0, s34, 12288
  s_mov_b32 s40, 393216
  buffer_load_dwordx4 v100, s[16:19], s40 offen lds
  s_add_u32 m0, s34, 13312
  s_mov_b32 s40, 425984
  buffer_load_dwordx4 v100, s[16:19], s40 offen lds
  s_add_u32 m0, s34, 14336
  s_mov_b32 s40, 458752
  buffer_load_dwordx4 v100, s[16:19], s40 offen lds
  s_add_u32 m0, s34, 15360
  s_mov_b32 s40, 491520
  buffer_load_dwordx4 v100, s[16:19], s40 offen lds
  s_waitcnt vmcnt(16)
  s_barrier
  ds_read_b64_tr_b16 a[16:17], v106 offset:0
  ds_read_b64_tr_b16 a[18:19], v106 offset:8192
  ds_read_b64_tr_b16 a[20:21], v106 offset:2048
  ds_read_b64_tr_b16 a[22:23], v106 offset:10240
  ds_read_b64_tr_b16 a[24:25], v106 offset:8
  ds_read_b64_tr_b16 a[26:27], v106 offset:8200
  ds_read_b64_tr_b16 a[28:29], v106 offset:2056
  ds_read_b64_tr_b16 a[30:31], v106 offset:10248
  ds_read_b64_tr_b16 a[48:49], v107 offset:0
  ds_read_b64_tr_b16 a[50:51], v107 offset:8192
  ds_read_b64_tr_b16 a[52:53], v107 offset:2048
  ds_read_b64_tr_b16 a[54:55], v107 offset:10240
  ds_read_b64_tr_b16 a[56:57], v107 offset:8
  ds_read_b64_tr_b16 a[58:59], v107 offset:8200
  ds_read_b64_tr_b16 a[60:61], v107 offset:2056
  ds_read_b64_tr_b16 a[62:63], v107 offset:10248
  ds_read_b64_tr_b16 a[80:81], v108 offset:0
  ds_read_b64_tr_b16 a[82:83], v108 offset:8192
  ds_read_b64_tr_b16 a[84:85], v108 offset:2048
  ds_read_b64_tr_b16 a[86:87], v108 offset:10240
  ds_read_b64_tr_b16 a[88:89], v108 offset:8
  ds_read_b64_tr_b16 a[90:91], v108 offset:8200
  ds_read_b64_tr_b16 a[92:93], v108 offset:2056
  ds_read_b64_tr_b16 a[94:95], v108 offset:10248
  ds_read_b64_tr_b16 a[112:113], v109 offset:0
  ds_read_b64_tr_b16 a[114:115], v109 offset:8192
  ds_read_b64_tr_b16 a[116:117], v109 offset:2048
  ds_read_b64_tr_b16 a[118:119], v109 offset:10240
  ds_read_b64_tr_b16 a[120:121], v109 offset:8
  ds_read_b64_tr_b16 a[122:123], v109 offset:8200
  ds_read_b64_tr_b16 a[124:125], v109 offset:2056
  ds_read_b64_tr_b16 a[126:127], v109 offset:10248
  s_waitcnt lgkmcnt(0)
  s_barrier
  s_add_u32 m0, s34, 65536
  s_mov_b32 s40, 524288
  buffer_load_dwordx4 v100, s[16:19], s40 offen lds
  s_add_u32 m0, s34, 66560
  s_mov_b32 s40, 557056
  buffer_load_dwordx4 v100, s[16:19], s40 offen lds
  s_add_u32 m0, s34, 67584
  s_mov_b32 s40, 589824
  buffer_load_dwordx4 v100, s[16:19], s40 offen lds
  s_add_u32 m0, s34, 68608
  s_mov_b32 s40, 622592
  buffer_load_dwordx4 v100, s[16:19], s40 offen lds
  s_add_u32 m0, s34, 69632
  s_mov_b32 s40, 655360
  buffer_load_dwordx4 v100, s[16:19], s40 offen lds
  s_add_u32 m0, s34, 70656
  s_mov_b32 s40, 688128
  buffer_load_dwordx4 v100, s[16:19], s40 offen lds
  s_add_u32 m0, s34, 71680
  s_mov_b32 s40, 720896
  buffer_load_dwordx4 v100, s[16:19], s40 offen lds
  s_add_u32 m0, s34, 72704
  s_mov_b32 s40, 753664
  buffer_load_dwordx4 v100, s[16:19], s40 offen lds
  s_add_u32 m0, s34, 73728
  s_mov_b32 s40, 786432
  buffer_load_dwordx4 v100, s[16:19], s40 offen lds
  s_add_u32 m0, s34, 74752
  s_mov_b32 s40, 819200
  buffer_load_dwordx4 v100, s[16:19], s40 offen lds
  s_add_u32 m0, s34, 75776
  s_mov_b32 s40, 851968
  buffer_load_dwordx4 v100, s[16:19], s40 offen lds
  s_add_u32 m0, s34, 76800
  s_mov_b32 s40, 884736
  buffer_load_dwordx4 v100, s[16:19], s40 offen lds
  s_add_u32 m0, s34, 77824
  s_mov_b32 s40, 917504
  buffer_load_dwordx4 v100, s[16:19], s40 offen lds
  s_add_u32 m0, s34, 78848
  s_mov_b32 s40, 950272
  buffer_load_dwordx4 v100, s[16:19], s40 offen lds
  s_add_u32 m0, s34, 79872
  s_mov_b32 s40, 983040
  buffer_load_dwordx4 v100, s[16:19], s40 offen lds
  s_add_u32 m0, s34, 80896
  s_mov_b32 s40, 1015808
  buffer_load_dwordx4 v100, s[16:19], s40 offen lds
  s_waitcnt vmcnt(16)
  s_barrier
  s_cmp_eq_u32 s28, 3
  s_cselect_b32 s59, 1, 0x10001
  s_cmp_lg_u32 s29, 0
  s_cbranch_scc1 L_h4
  v_mov_b32 v0, s59
  v_mov_b32 v96, 4
  s_mov_b64 exec, 1
  buffer_atomic_add v0, v96, s[8:11], 0 offen sc0
  s_mov_b64 exec, -1
L_h4:
  ds_read_b64_tr_b16 v[16:17], v102 offset:0
  ds_read_b64_tr_b16 v[18:19], v102 offset:8192
  ds_read_b64_tr_b16 v[20:21], v102 offset:2048
  ds_read_b64_tr_b16 v[22:23], v102 offset:10240
  ds_read_b64_tr_b16 v[24:25], v102 offset:8
  ds_read_b64_tr_b16 v[26:27], v102 offset:8200
  ds_read_b64_tr_b16 v[28:29], v102 offset:2056
  ds_read_b64_tr_b16 v[30:31], v102 offset:10248
  ds_read_b64_tr_b16 a[224:225], v103 offset:0
  ds_read_b64_tr_b16 a[226:227], v103 offset:8192
  ds_read_b64_tr_b16 a[228:229], v103 offset:2048
  ds_read_b64_tr_b16 a[230:231], v103 offset:10240
  ds_read_b64_tr_b16 a[232:233], v103 offset:8
  ds_read_b64_tr_b16 a[234:235], v103 offset:8200
  ds_read_b64_tr_b16 a[236:237], v103 offset:2056
  ds_read_b64_tr_b16 a[238:239], v103 offset:10248
  ds_read_b64_tr_b16 v[144:145], v104 offset:0
  ds_read_b64_tr_b16 v[146:147], v104 offset:8192
  ds_read_b64_tr_b16 v[148:149], v104 offset:2048
  ds_read_b64_tr_b16 v[150:151], v104 offset:10240
  ds_read_b64_tr_b16 v[152:153], v104 offset:8
  ds_read_b64_tr_b16 v[154:155], v104 offset:8200
  ds_read_b64_tr_b16 v[156:157], v104 offset:2056
  ds_read_b64_tr_b16 v[158:159], v104 offset:10248
  ds_read_b64_tr_b16 v[32:33], v105 offset:0
  ds_read_b64_tr_b16 v[34:35], v105 offset:8192
  ds_read_b64_tr_b16 v[36:37], v105 offset:2048
  ds_read_b64_tr_b16 v[38:39], v105 offset:10240
  ds_read_b64_tr_b16 v[40:41], v105 offset:8
  ds_read_b64_tr_b16 v[42:43], v105 offset:8200
  ds_read_b64_tr_b16 v[44:45], v105 offset:2056
  ds_read_b64_tr_b16 v[46:47], v105 offset:10248
  s_waitcnt lgkmcnt(0)
  s_barrier
  s_add_u32 m0, s34, 0
  s_mov_b32 s40, 0
  buffer_load_dwordx4 v100, s[12:15], s40 offen lds
  s_add_u32 m0, s34, 1024
  s_mov_b32 s40, 32768
  buffer_load_dwordx4 v100, s[12:15], s40 offen lds
  s_add_u32 m0, s34, 2048
  s_mov_b32 s40, 65536
  buffer_load_dwordx4 v100, s[12:15], s40 offen lds
  s_add_u32 m0, s34, 3072
  s_mov_b32 s40, 98304
  buffer_load_dwordx4 v100, s[12:15], s40 offen lds
  s_add_u32 m0, s34, 4096
  s_mov_b32 s40, 131072
  buffer_load_dwordx4 v100, s[12:15], s40 offen lds
  s_add_u32 m0, s34, 5120
  s_mov_b32 s40, 163840
  buffer_load_dwordx4 v100, s[12:15], s40 offen lds
  s_add_u32 m0, s34, 6144
  s_mov_b32 s40, 196608
  buffer_load_dwordx4 v100, s[12:15], s40 offen lds
  s_add_u32 m0, s34, 7168
  s_mov_b32 s40, 229376
  buffer_load_dwordx4 v100, s[12:15], s40 offen lds
  s_add_u32 m0, s34, 8192
  s_mov_b32 s40, 262144
  buffer_load_dwordx4 v100, s[12:15], s40 offen lds
  s_add_u32 m0, s34, 9216
  s_mov_b32 s40, 294912
  buffer_load_dwordx4 v100, s[12:15], s40 offen lds
  s_add_u32 m0, s34, 10240
  s_mov_b32 s40, 327680
  buffer_load_dwordx4 v100, s[12:15], s40 offen lds
  s_add_u32 m0, s34, 11264
  s_mov_b32 s40, 360448
  buffer_load_dwordx4 v100, s[12:15], s40 offen lds
  s_add_u32 m0, s34, 12288
  s_mov_b32 s40, 393216
  buffer_load_dwordx4 v100, s[12:15], s40 offen lds
  s_add_u32 m0, s34, 13312
  s_mov_b32 s40, 425984
  buffer_load_dwordx4 v100, s[12:15], s40 offen lds
  s_add_u32 m0, s34, 14336
  s_mov_b32 s40, 458752
  buffer_load_dwordx4 v100, s[12:15], s40 offen lds
  s_add_u32 m0, s34, 15360
  s_mov_b32 s40, 491520
  buffer_load_dwordx4 v100, s[12:15], s40 offen lds
  s_waitcnt vmcnt(16)
  s_barrier
  ds_read_b64_tr_b16 v[48:49], v106 offset:0
  ds_read_b64_tr_b16 v[50:51], v106 offset:8192
  ds_read_b64_tr_b16 v[52:53], v106 offset:2048
  ds_read_b64_tr_b16 v[54:55], v106 offset:10240
  ds_read_b64_tr_b16 v[56:57], v106 offset:8
  ds_read_b64_tr_b16 v[58:59], v106 offset:8200
  ds_read_b64_tr_b16 v[60:61], v106 offset:2056
  ds_read_b64_tr_b16 v[62:63], v106 offset:10248
  ds_read_b64_tr_b16 a[240:241], v107 offset:0
  ds_read_b64_tr_b16 a[242:243], v107 offset:8192
  ds_read_b64_tr_b16 a[244:245], v107 offset:2048
  ds_read_b64_tr_b16 a[246:247], v107 offset:10240
  ds_read_b64_tr_b16 a[248:249], v107 offset:8
  ds_read_b64_tr_b16 a[250:251], v107 offset:8200
  ds_read_b64_tr_b16 a[252:253], v107 offset:2056
  ds_read_b64_tr_b16 a[254:255], v107 offset:10248
  ds_read_b64_tr_b16 v[160:161], v108 offset:0
  ds_read_b64_tr_b16 v[162:163], v108 offset:8192
  ds_read_b64_tr_b16 v[164:165], v108 offset:2048
  ds_read_b64_tr_b16 v[166:167], v108 offset:10240
  ds_read_b64_tr_b16 v[168:169], v108 offset:8
  ds_read_b64_tr_b16 v[170:171], v108 offset:8200
  ds_read_b64_tr_b16 v[172:173], v108 offset:2056
  ds_read_b64_tr_b16 v[174:175], v108 offset:10248
  ds_read_b64_tr_b16 v[64:65], v109 offset:0
  ds_read_b64_tr_b16 v[66:67], v109 offset:8192
  ds_read_b64_tr_b16 v[68:69], v109 offset:2048
  ds_read_b64_tr_b16 v[70:71], v109 offset:10240
  ds_read_b64_tr_b16 v[72:73], v109 offset:8
  ds_read_b64_tr_b16 v[74:75], v109 offset:8200
  ds_read_b64_tr_b16 v[76:77], v109 offset:2056
  ds_read_b64_tr_b16 v[78:79], v109 offset:10248
  s_waitcnt lgkmcnt(0)
  s_barrier
  s_add_u32 m0, s34, 65536
  s_mov_b32 s40, 524288
  buffer_load_dwordx4 v100, s[12:15], s40 offen lds
  s_add_u32 m0, s34, 66560
  s_mov_b32 s40, 557056
  buffer_load_dwordx4 v100, s[12:15], s40 offen lds
  s_add_u32 m0, s34, 67584
  s_mov_b32 s40, 589824
  buffer_load_dwordx4 v100, s[12:15], s40 offen lds
  s_add_u32 m0, s34, 68608
  s_mov_b32 s40, 622592
  buffer_load_dwordx4 v100, s[12:15], s40 offen lds
  s_add_u32 m0, s34, 69632
  s_mov_b32 s40, 655360
  buffer_load_dwordx4 v100, s[12:15], s40 offen lds
  s_add_u32 m0, s34, 70656
  s_mov_b32 s40, 688128
  buffer_load_dwordx4 v100, s[12:15], s40 offen lds
  s_add_u32 m0, s34, 71680
  s_mov_b32 s40, 720896
  buffer_load_dwordx4 v100, s[12:15], s40 offen lds
  s_add_u32 m0, s34, 72704
  s_mov_b32 s40, 753664
  buffer_load_dwordx4 v100, s[12:15], s40 offen lds
  s_add_u32 m0, s34, 73728
  s_mov_b32 s40, 786432
  buffer_load_dwordx4 v100, s[12:15], s40 offen lds
  s_add_u32 m0, s34, 74752
  s_mov_b32 s40, 819200
  buffer_load_dwordx4 v100, s[12:15], s40 offen lds
  s_add_u32 m0, s34, 75776
  s_mov_b32 s40, 851968
  buffer_load_dwordx4 v100, s[12:15], s40 offen lds
  s_add_u32 m0, s34, 76800
  s_mov_b32 s40, 884736
  buffer_load_dwordx4 v100, s[12:15], s40 offen lds
  s_add_u32 m0, s34, 77824
  s_mov_b32 s40, 917504
  buffer_load_dwordx4 v100, s[12:15], s40 offen lds
  s_add_u32 m0, s34, 78848
  s_mov_b32 s40, 950272
  buffer_load_dwordx4 v100, s[12:15], s40 offen lds
  s_add_u32 m0, s34, 79872
  s_mov_b32 s40, 983040
  buffer_load_dwordx4 v100, s[12:15], s40 offen lds
  s_add_u32 m0, s34, 80896
  s_mov_b32 s40, 1015808
  buffer_load_dwordx4 v100, s[12:15], s40 offen lds
  s_waitcnt vmcnt(16)
  s_barrier
  s_cmp_lg_u32 s29, 0
  s_cbranch_scc1 L_h6
  s_mov_b64 exec, 1
  v_add_u32 v0, s59, v0
  v_and_b32 v96, 0xffff, v0
  v_cmp_eq_u32 vcc, 32, v96
  v_mov_b32 v96, 192
  s_and_b64 exec, exec, vcc
  s_cbranch_execz L_h6x
  buffer_store_dword v0, v96, s[8:11], 0 offen sc1
L_h6x:
  s_mov_b64 exec, -1
L_h6:
  ds_read_b64_tr_b16 v[80:81], v102 offset:0
  ds_read_b64_tr_b16 v[82:83], v102 offset:8192
  ds_read_b64_tr_b16 v[84:85], v102 offset:2048
  ds_read_b64_tr_b16 v[86:87], v102 offset:10240
  ds_read_b64_tr_b16 v[88:89], v102 offset:8
  ds_read_b64_tr_b16 v[90:91], v102 offset:8200
  ds_read_b64_tr_b16 v[92:93], v102 offset:2056
  ds_read_b64_tr_b16 v[94:95], v102 offset:10248
  ds_read_b64_tr_b16 v[176:177], v103 offset:0
  ds_read_b64_tr_b16 v[178:179], v103 offset:8192
  ds_read_b64_tr_b16 v[180:181], v103 offset:2048
  ds_read_b64_tr_b16 v[182:183], v103 offset:10240
  ds_read_b64_tr_b16 v[184:185], v103 offset:8
  ds_read_b64_tr_b16 v[186:187], v103 offset:8200
  ds_read_b64_tr_b16 v[188:189], v103 offset:2056
  ds_read_b64_tr_b16 v[190:191], v103 offset:10248
  ds_read_b64_tr_b16 v[208:209], v104 offset:0
  ds_read_b64_tr_b16 v[210:211], v104 offset:8192
  ds_read_b64_tr_b16 v[212:213], v104 offset:2048
  ds_read_b64_tr_b16 v[214:215], v104 offset:10240
  ds_read_b64_tr_b16 v[216:217], v104 offset:8
  ds_read_b64_tr_b16 v[218:219], v104 offset:8200
  ds_read_b64_tr_b16 v[220:221], v104 offset:2056
  ds_read_b64_tr_b16 v[222:223], v104 offset:10248
  ds_read_b64_tr_b16 v[240:241], v105 offset:0
  ds_read_b64_tr_b16 v[242:243], v105 offset:8192
  ds_read_b64_tr_b16 v[244:245], v105 offset:2048
  ds_read_b64_tr_b16 v[246:247], v105 offset:10240
  ds_read_b64_tr_b16 v[248:249], v105 offset:8
  ds_read_b64_tr_b16 v[250:251], v105 offset:8200
  ds_read_b64_tr_b16 v[252:253], v105 offset:2056
  ds_read_b64_tr_b16 v[254:255], v105 offset:10248
  s_waitcnt lgkmcnt(0)
  s_barrier
  s_waitcnt vmcnt(0)
  s_barrier
  ds_read_b64_tr_b16 v[112:113], v106 offset:0
  ds_read_b64_tr_b16 v[114:115], v106 offset:8192
  ds_read_b64_tr_b16 v[116:117], v106 offset:2048
  ds_read_b64_tr_b16 v[118:119], v106 offset:10240
  ds_read_b64_tr_b16 v[120:121], v106 offset:8
  ds_read_b64_tr_b16 v[122:123], v106 offset:8200
  ds_read_b64_tr_b16 v[124:125], v106 offset:2056
  ds_read_b64_tr_b16 v[126:127], v106 offset:10248
  ds_read_b64_tr_b16 v[192:193], v107 offset:0
  ds_read_b64_tr_b16 v[194:195], v107 offset:8192
  ds_read_b64_tr_b16 v[196:197], v107 offset:2048
  ds_read_b64_tr_b16 v[198:199], v107 offset:10240
  ds_read_b64_tr_b16 v[200:201], v107 offset:8
  ds_read_b64_tr_b16 v[202:203], v107 offset:8200
  ds_read_b64_tr_b16 v[204:205], v107 offset:2056
  ds_read_b64_tr_b16 v[206:207], v107 offset:10248
  ds_read_b64_tr_b16 v[224:225], v108 offset:0
  ds_read_b64_tr_b16 v[226:227], v108 offset:8192
  ds_read_b64_tr_b16 v[228:229], v108 offset:2048
  ds_read_b64_tr_b16 v[230:231], v108 offset:10240
  ds_read_b64_tr_b16 v[232:233], v108 offset:8
  ds_read_b64_tr_b16 v[234:235], v108 offset:8200
  ds_read_b64_tr_b16 v[236:237], v108 offset:2056
  ds_read_b64_tr_b16 v[238:239], v108 offset:10248
  ds_read_b64_tr_b16 v[128:129], v109 offset:0
  ds_read_b64_tr_b16 v[130:131], v109 offset:8192
  ds_read_b64_tr_b16 v[132:133], v109 offset:2048
  ds_read_b64_tr_b16 v[134:135], v109 offset:10240
  ds_read_b64_tr_b16 v[136:137], v109 offset:8
  ds_read_b64_tr_b16 v[138:139], v109 offset:8200
  ds_read_b64_tr_b16 v[140:141], v109 offset:2056
  ds_read_b64_tr_b16 v[142:143], v109 offset:10248
  s_waitcnt lgkmcnt(0)
  s_barrier
  ds_write_b128 v2, v[16:19] offset:4096
  ds_write_b128 v2, v[20:23] offset:5120
  ds_write_b128 v2, v[24:27] offset:6144
  ds_write_b128 v2, v[28:31] offset:7168
  ds_write_b128 v2, v[32:35] offset:16384
  ds_write_b128 v2, v[36:39] offset:17408
  ds_write_b128 v2, v[40:43] offset:18432
  ds_write_b128 v2, v[44:47] offset:19456
  s_waitcnt lgkmcnt(0)
  v_add_u32 v110, 4294950912, v3
  ds_read_b128 v[16:19], v110
  v_add_u32 v110, 4294951936, v3
  ds_read_b128 v[20:23], v110
  v_add_u32 v110, 4294959104, v3
  ds_read_b128 v[24:27], v110
  v_add_u32 v110, 4294960128, v3
  ds_read_b128 v[28:31], v110
  v_add_u32 v110, 0, v3
  ds_read_b128 v[32:35], v110
  v_add_u32 v110, 1024, v3
  ds_read_b128 v[36:39], v110
  v_add_u32 v110, 8192, v3
  ds_read_b128 v[40:43], v110
  v_add_u32 v110, 9216, v3
  ds_read_b128 v[44:47], v110
  s_waitcnt lgkmcnt(0)
  s_barrier
  ds_write_b128 v2, v[48:51] offset:12288
  ds_write_b128 v2, v[52:55] offset:13312
  ds_write_b128 v2, v[56:59] offset:14336
  ds_write_b128 v2, v[60:63] offset:15360
  ds_write_b128 v2, v[64:67] offset:20480
  ds_write_b128 v2, v[68:71] offset:21504
  ds_write_b128 v2, v[72:75] offset:22528
  ds_write_b128 v2, v[76:79] offset:23552
  ds_write_b128 v2, v[80:83] offset:0
  ds_write_b128 v2, v[84:87] offset:1024
  ds_write_b128 v2, v[88:91] offset:2048
  ds_write_b128 v2, v[92:95] offset:3072
  ds_write_b128 v2, v[112:115] offset:8192
  ds_write_b128 v2, v[116:119] offset:9216
  ds_write_b128 v2, v[120:123] offset:10240
  ds_write_b128 v2, v[124:127] offset:11264
  ds_write_b128 v2, v[128:131] offset:32768
  ds_write_b128 v2, v[132:135] offset:33792
  ds_write_b128 v2, v[136:139] offset:34816
  ds_write_b128 v2, v[140:143] offset:35840
  ds_write_b128 v2, v[16:19] offset:24576
  ds_write_b128 v2, v[20:23] offset:25600
  ds_write_b128 v2, v[24:27] offset:26624
  ds_write_b128 v2, v[28:31] offset:27648
  ds_write_b128 v2, v[32:35] offset:28672
  ds_write_b128 v2, v[36:39] offset:29696
  ds_write_b128 v2, v[40:43] offset:30720
  ds_write_b128 v2, v[44:47] offset:31744
  s_waitcnt lgkmcnt(0)
  v_lshrrev_b32 v22, 4, v1
  v_and_b32 v23, 15, v1
  v_bfe_u32 v24, v1, 2, 2
  v_and_b32 v25, 3, v1
  v_and_b32 v27, 1, v22
  v_lshrrev_b32 v28, 1, v24
  v_and_b32 v29, 1, v24
  v_mov_b32 v39, 0x3f80
  v_mov_b32 v40, 0x3f800000
  v_cmp_eq_u32 vcc, 1, v28
  s_nop 1
  v_cndmask_b32 v39, v39, v40, vcc
  v_cmp_gt_u32 vcc, 2, v25
  s_nop 1
  v_cndmask_b32 v39, 0, v39, vcc
  v_lshl_add_u32 v40, v29, 1, v25
  v_cmp_eq_u32 vcc, 0, v40
  s_nop 1
  v_cndmask_b32 v100, 0, v39, vcc
  v_cmp_eq_u32 vcc, 1, v40
  s_nop 1
  v_cndmask_b32 v101, 0, v39, vcc
  v_cmp_eq_u32 vcc, 2, v40
  s_nop 1
  v_cndmask_b32 v102, 0, v39, vcc
  v_cmp_eq_u32 vcc, 3, v40
  s_nop 1
  v_cndmask_b32 v103, 0, v39, vcc
  v_lshlrev_b32 v108, 7, v23
  v_lshl_add_u32 v108, v27, 24, v108
  v_add_u32 v108, 409600, v108
  s_lshl_b32 s36, s29, 11
  s_sub_u32 s37, 118118400, s36
  v_mov_b32 v40, s37
  v_cmp_lt_u32 vcc, 31, v1
  s_nop 1
  v_cndmask_b32 v108, v108, v40, vcc
  v_mov_b32 v42, 0
  ds_write_b32 v7, v42 offset:256
  v_and_b32 v40, 1, v1
  v_lshl_add_u32 v40, v24, 1, v40
  v_lshlrev_b32 v120, 7, v22
  v_lshl_add_u32 v120, v40, 4, v120
  v_add_u32 v120, 147456, v120
  s_waitcnt vmcnt(0) lgkmcnt(0)
  v_bfe_u32 v16, v1, 1, 1
  v_mov_b32 v96, 0x4444
  v_mov_b32 v17, 0xeeee
  v_cmp_eq_u32 vcc, 1, v16
  v_mov_b32 v18, 192
  s_mov_b32 s34, 0
  v_cndmask_b32 v96, v96, v17, vcc
L_cspin:
  s_add_u32 s34, s34, 1
  s_cmp_gt_u32 s34, 0x100000
  s_cbranch_scc1 L_end
  buffer_load_dword v16, v18, s[8:11], 0 offen sc1
  s_waitcnt vmcnt(0)
  v_readfirstlane_b32 s31, v16
  s_nop 3
  s_cmp_eq_u32 s31, 0
  s_cbranch_scc1 L_cspin
  s_mov_b32 s59, s31
  v_mov_b32 v0, 0
  v_mov_b32 v1, 0
  v_mov_b32 v104, 0
  v_mov_b32 v105, 0
  v_mov_b32 v106, 0
  v_mov_b32 v107, 0
  s_lshl_b32 s98, s30, 6
  s_add_u32 s31, s98, 8192
  s_lshl_b32 s98, s98, 3
  s_lshl_b32 s32, s29, 7
  s_add_u32 s98, s98, s32
  s_add_u32 s98, s98, 131072
  s_cmp_eq_u32 s29, 0
  s_cselect_b32 s98, s31, s98
  buffer_load_dwordx4 v[16:19], v15, s[4:7], s47 offen sc1
  buffer_load_dwordx4 v[20:23], v15, s[4:7], s47 offen offset:1024 sc1
  s_mov_b32 s31, 1056768
  buffer_load_dwordx4 v[16:19], v98, s[4:7], s31 offen sc1
  buffer_load_dwordx4 v[20:23], v98, s[4:7], s31 offen offset:1024 sc1
  s_mov_b32 s31, 1064960
  buffer_load_dwordx4 v[16:19], v98, s[4:7], s31 offen sc1
  buffer_load_dwordx4 v[20:23], v98, s[4:7], s31 offen offset:1024 sc1
  s_mov_b32 s31, 1073152
  buffer_load_dwordx4 v[16:19], v98, s[4:7], s31 offen sc1
  buffer_load_dwordx4 v[20:23], v98, s[4:7], s31 offen offset:1024 sc1
  s_waitcnt vmcnt(0)
  s_cmp_gt_u32 s59, 0xffff
  s_cbranch_scc1 L_slow
  s_mov_b32 s40, 0
  s_mov_b32 s41, 1048576
  s_mov_b32 s42, 1056768
  s_mov_b32 s43, 524288
  s_lshl_b32 s31, s30, 13
  s_lshl_b32 s32, s29, 11
  s_add_u32 s48, s31, 134217728
  s_add_u32 s31, s31, s32
  s_add_u32 s44, s31, 16629760
  s_add_u32 s45, s31, 33406976
  s_add_u32 s46, s44, 16252928
  s_lshl_b32 s32, s29, 10
  s_add_u32 s51, s48, s32
  s_add_u32 s51, s51, -407552
  s_mov_b32 s49, 0
  s_mov_b32 s58, 0
  s_lshl_b32 s31, s30, 13
  s_add_u32 s31, s31, 134223872
  s_mov_b32 s32, 128
  s_mov_b32 s34, 0
L_kw_71:
  s_add_u32 s34, s34, 1
  s_cmp_gt_u32 s34, 0x40000
  s_cbranch_scc1 L_end
  buffer_load_dword v16, v1, s[8:11], s32 offen sc1
  s_waitcnt vmcnt(0)
  buffer_load_dword v17, v1, s[4:7], s31 offen sc1
  s_waitcnt vmcnt(0)
  v_lshlrev_b32 v16, 1, v16
  v_min_u32 v16, v16, v17
  s_nop 0
  v_readfirstlane_b32 s33, v16
  s_nop 3
  s_cmp_lg_u32 s33, 2
  s_cbranch_scc1 L_kw_71
  v_mov_b32 v110, 2
  ds_read_b128 v[64:67], v2 offset:6144
  ds_read_b128 v[68:71], v2 offset:7168
  ds_read_b128 v[72:75], v2 offset:8192
  ds_read_b128 v[76:79], v2 offset:9216
  ds_read_b128 v[80:83], v2 offset:10240
  ds_read_b128 v[84:87], v2 offset:11264
  ds_read_b128 v[88:91], v2 offset:12288
  ds_read_b128 v[92:95], v2 offset:13312
  ds_read_b128 v[24:27], v2 offset:0
  ds_read_b128 v[28:31], v2 offset:1024
  ds_read_b128 v[32:35], v2 offset:2048
  ds_read_b128 v[36:39], v2 offset:3072
  ds_read_b128 v[40:43], v2 offset:4096
  ds_read_b128 v[44:47], v2 offset:5120
  v_mov_b32 v48, 0
  v_mov_b32 v49, 0
  v_mov_b32 v50, 0
  v_mov_b32 v51, 0
  v_mov_b32 v52, 0
  v_mov_b32 v53, 0
  v_mov_b32 v54, 0
  v_mov_b32 v55, 0
  v_mov_b32 v56, 0
  v_mov_b32 v57, 0
  v_mov_b32 v58, 0
  v_mov_b32 v59, 0
  v_mov_b32 v60, 0
  v_mov_b32 v61, 0
  v_mov_b32 v62, 0
  v_mov_b32 v63, 0
  v_mov_b32 v112, 0
  v_mov_b32 v113, 0
  v_mov_b32 v114, 0
  v_mov_b32 v115, 0
  v_mov_b32 v116, 0
  v_mov_b32 v117, 0
  v_mov_b32 v118, 0
  v_mov_b32 v119, 0
  buffer_load_dwordx4 v[16:19], v98, s[4:7], s41 offen sc1
  buffer_load_dwordx4 v[20:23], v98, s[4:7], s41 offen offset:1024 sc1
L_step_f:
  s_waitcnt vmcnt(1)
  ds_write_b128 v3, v[16:19]
  v_max3_u32 v109, v16, v17, v18
  s_waitcnt vmcnt(0)
  ds_write_b128 v3, v[20:23] offset:1024
  v_max3_u32 v109, v109, v19, v20
  v_max3_u32 v109, v109, v21, v22
  v_max_u32 v109, v109, v23
  v_cmp_eq_u32 vcc, -1, v109
  s_cbranch_vccnz L_p2_f
L_p2_fx:
  s_waitcnt lgkmcnt(2)
  v_smfmac_f32_16x16x64_bf16 v[48:51], v[16:19], v[24:31], v96
  buffer_load_dwordx4 v[128:131], v15, s[4:7], s44 offen sc1
  v_smfmac_f32_16x16x64_bf16 v[52:55], v[16:19], v[32:39], v96
  buffer_load_dwordx4 v[132:135], v15, s[4:7], s44 offen offset:1024 sc1
  v_smfmac_f32_16x16x64_bf16 v[56:59], v[16:19], v[40:47], v96
  buffer_load_dwordx4 v[136:139], v15, s[4:7], s45 offen sc1
  v_smfmac_f32_16x16x64_bf16 v[60:63], v[16:19], v[64:71], v96
  buffer_load_dwordx4 v[140:143], v15, s[4:7], s45 offen offset:1024 sc1
  s_waitcnt lgkmcnt(0)
  s_barrier
  ds_read_b128 v[24:27], v4
  ds_read_b128 v[28:31], v4 offset:1024
  v_readlane_b32 s31, v110, 32
  s_cmp_ge_u32 s40, 63
  s_cselect_b32 s31, 2, s31
  s_cmp_lg_u32 s31, 2
  s_cbranch_scc1 L_kw_72e
L_kwx_73:
  s_min_u32 s33, s44, s46
  buffer_load_dword v110, v108, s[4:7], s33 offen sc1
  v_smfmac_f32_16x16x64_bf16 v[48:51], v[20:23], v[72:79], v96
  ds_read_b128 v[32:35], v5
  ds_read_b128 v[36:39], v5 offset:1024
  v_smfmac_f32_16x16x64_bf16 v[52:55], v[20:23], v[80:87], v96
  ds_read_b128 v[40:43], v6
  ds_read_b128 v[44:47], v6 offset:1024
  v_smfmac_f32_16x16x64_bf16 v[56:59], v[20:23], v[88:95], v96
  s_max_u32 s31, s40, 1
  s_sub_u32 s31, s31, 1
  v_mov_b32 v109, s31
  s_mov_b64 exec, 1
  buffer_store_dword v109, v1, s[4:7], s98 offen sc1
  s_mov_b64 exec, -1
  s_add_u32 s44, s44, 262144
  s_add_u32 s45, s45, 262144
  v_smfmac_f32_16x16x64_bf16 v[112:115], v[16:19], a[0:7], v96
  v_smfmac_f32_16x16x64_bf16 v[116:119], v[16:19], a[8:15], v96
  s_waitcnt lgkmcnt(5)
  v_smfmac_f32_16x16x64_bf16 v[48:51], v[24:27], v[176:183], v96
  ds_read_b128 v[64:67], v2 offset:32768
  v_smfmac_f32_16x16x64_bf16 v[52:55], v[24:27], v[184:191], v96
  ds_read_b128 v[68:71], v2 offset:33792
  s_waitcnt lgkmcnt(6)
  v_smfmac_f32_16x16x64_bf16 v[48:51], v[28:31], v[192:199], v96
  ds_read_b128 v[72:75], v2 offset:34816
  v_smfmac_f32_16x16x64_bf16 v[52:55], v[28:31], v[200:207], v96
  ds_read_b128 v[76:79], v2 offset:35840
  s_waitcnt lgkmcnt(7)
  v_smfmac_f32_16x16x64_bf16 v[48:51], v[32:35], v[208:215], v96
  ds_read_b128 v[80:83], v2 offset:14336
  v_smfmac_f32_16x16x64_bf16 v[52:55], v[32:35], v[216:223], v96
  ds_read_b128 v[84:87], v2 offset:15360
  s_waitcnt lgkmcnt(8)
  v_smfmac_f32_16x16x64_bf16 v[48:51], v[36:39], v[224:231], v96
  ds_read_b128 v[88:91], v2 offset:16384
  v_smfmac_f32_16x16x64_bf16 v[52:55], v[36:39], v[232:239], v96
  ds_read_b128 v[92:95], v2 offset:17408
  s_waitcnt lgkmcnt(9)
  v_smfmac_f32_16x16x64_bf16 v[48:51], v[40:43], v[240:247], v96
  v_smfmac_f32_16x16x64_bf16 v[52:55], v[40:43], v[248:255], v96
  buffer_store_dwordx4 v[104:107], v15, s[4:7], s51 offen sc1
  s_add_u32 s51, s51, 262144
  s_waitcnt lgkmcnt(2)
  v_smfmac_f32_16x16x64_bf16 v[48:51], v[44:47], v[64:71], v96
  v_smfmac_f32_16x16x64_bf16 v[52:55], v[44:47], v[72:79], v96
  v_smfmac_f32_16x16x64_bf16 v[60:63], v[20:23], v[80:87], v96
  ds_read_b128 v[64:67], v2 offset:18432
  v_smfmac_f32_16x16x64_bf16 v[56:59], v[24:27], a[224:231], v96
  ds_read_b128 v[68:71], v2 offset:19456
  v_smfmac_f32_16x16x64_bf16 v[60:63], v[24:27], a[232:239], v96
  ds_read_b128 v[72:75], v2 offset:20480
  v_smfmac_f32_16x16x64_bf16 v[56:59], v[28:31], a[240:247], v96
  ds_read_b128 v[76:79], v2 offset:21504
  v_add_f32 v48, v48, v50
  v_add_f32 v49, v49, v51
  v_smfmac_f32_16x16x64_bf16 v[60:63], v[28:31], a[248:255], v96
  ds_read_b128 v[80:83], v2 offset:22528
  v_add_f32 v52, v52, v54
  v_add_f32 v53, v53, v55
  v_smfmac_f32_16x16x64_bf16 v[56:59], v[32:35], v[144:151], v96
  ds_read_b128 v[84:87], v2 offset:23552
  v_cvt_pk_bf16_f32 v109, v48, v52
  v_cvt_pk_bf16_f32 v0, v49, v53
  v_smfmac_f32_16x16x64_bf16 v[60:63], v[32:35], v[152:159], v96
  ds_write2_b32 v11, v109, v0 offset0:0 offset1:16
  v_smfmac_f32_16x16x64_bf16 v[56:59], v[36:39], v[160:167], v96
  v_mov_b32 v48, 0
  v_mov_b32 v49, 0
  v_smfmac_f32_16x16x64_bf16 v[60:63], v[36:39], v[168:175], v96
  v_mov_b32 v50, 0
  v_mov_b32 v51, 0
  s_waitcnt lgkmcnt(1)
  v_smfmac_f32_16x16x64_bf16 v[56:59], v[40:43], v[88:95], v96
  v_mov_b32 v52, 0
  v_mov_b32 v53, 0
  v_smfmac_f32_16x16x64_bf16 v[60:63], v[40:43], v[64:71], v96
  v_mov_b32 v54, 0
  v_mov_b32 v55, 0
  v_smfmac_f32_16x16x64_bf16 v[56:59], v[44:47], v[72:79], v96
  ds_read_b128 v[88:91], v12
  v_smfmac_f32_16x16x64_bf16 v[60:63], v[44:47], v[80:87], v96
  ds_read_b128 v[92:95], v12 offset:32
  v_smfmac_f32_16x16x64_bf16 v[112:115], v[20:23], a[16:23], v96
  v_smfmac_f32_16x16x64_bf16 v[116:119], v[20:23], a[24:31], v96
  s_nop 0
  v_add_f32 v56, v56, v58
  v_add_f32 v57, v57, v59
  v_add_f32 v60, v60, v62
  v_add_f32 v61, v61, v63
  v_cvt_pk_bf16_f32 v109, v56, v60
  v_cvt_pk_bf16_f32 v0, v57, v61
  ds_write2_b32 v11, v109, v0 offset0:128 offset1:144
  ds_read_b128 v[64:67], v13
  ds_read_b128 v[68:71], v13 offset:32
  s_waitcnt lgkmcnt(3) vmcnt(3)
  v_mfma_f32_16x16x32_bf16 v[72:75], v[128:131], v[88:91], 0
  v_mfma_f32_16x16x32_bf16 v[72:75], v[132:135], v[92:95], v[72:75]
  v_smfmac_f32_16x16x64_bf16 v[112:115], v[24:27], a[32:39], v96
  v_mov_b32 v56, 0
  v_mov_b32 v57, 0
  v_smfmac_f32_16x16x64_bf16 v[116:119], v[24:27], a[40:47], v96
  v_mov_b32 v58, 0
  v_mov_b32 v59, 0
  v_smfmac_f32_16x16x64_bf16 v[112:115], v[28:31], a[48:55], v96
  v_mov_b32 v60, 0
  v_mov_b32 v61, 0
  s_waitcnt lgkmcnt(0)
  v_mfma_f32_16x16x32_bf16 v[76:79], v[64:67], v[88:91], 0
  v_mfma_f32_16x16x32_bf16 v[76:79], v[68:71], v[92:95], v[76:79]
  ds_write_b128 v3, v[72:75] offset:8192
  v_smfmac_f32_16x16x64_bf16 v[116:119], v[28:31], a[56:63], v96
  v_mov_b32 v62, 0
  v_mov_b32 v63, 0
  v_smfmac_f32_16x16x64_bf16 v[112:115], v[32:35], a[64:71], v96
  s_nop 0
  ds_write_b32 v7, v76
  v_smfmac_f32_16x16x64_bf16 v[116:119], v[32:35], a[72:79], v96
  buffer_store_dwordx4 v[64:67], v111, s[4:7], s48 offen sc1
  v_smfmac_f32_16x16x64_bf16 v[112:115], v[36:39], a[80:87], v96
  v_smfmac_f32_16x16x64_bf16 v[116:119], v[36:39], a[88:95], v96
  s_waitcnt lgkmcnt(0)
  s_barrier
  ds_read_b128 v[88:91], v4 offset:8192
  ds_read_b32 v84, v8
  v_smfmac_f32_16x16x64_bf16 v[112:115], v[40:43], a[96:103], v96
  ds_read_b128 v[92:95], v5 offset:8192
  ds_read_b32 v85, v9
  v_smfmac_f32_16x16x64_bf16 v[116:119], v[40:43], a[104:111], v96
  ds_read_b128 v[80:83], v6 offset:8192
  ds_read_b32 v86, v10
  v_smfmac_f32_16x16x64_bf16 v[112:115], v[44:47], a[112:119], v96
  v_smfmac_f32_16x16x64_bf16 v[116:119], v[44:47], a[120:127], v96
  s_cmp_eq_u32 s40, 63
  s_cbranch_scc1 L_fin_f
  s_waitcnt lgkmcnt(4)
  v_pk_add_f32 v[72:73], v[72:73], v[88:89]
  v_pk_add_f32 v[74:75], v[74:75], v[90:91]
  v_add_f32 v76, v76, v84
  s_waitcnt lgkmcnt(2)
  v_pk_add_f32 v[72:73], v[72:73], v[92:93]
  v_pk_add_f32 v[74:75], v[74:75], v[94:95]
  v_add_f32 v76, v76, v85
  s_waitcnt lgkmcnt(0)
  v_pk_add_f32 v[72:73], v[72:73], v[80:81]
  v_pk_add_f32 v[74:75], v[74:75], v[82:83]
  v_add_f32 v76, v76, v86
  v_max3_f32 v80, v72, v73, v74
  v_max3_f32 v80, v80, v75, v76
  v_add_f32 v112, v112, v114
  v_add_f32 v113, v113, v115
  v_max_f32_dpp v80, v80, v80 row_ror:8 row_mask:0xf bank_mask:0xf
  v_mov_b32 v81, v80
  v_add_f32 v116, v116, v118
  v_add_f32 v117, v117, v119
  v_permlane16_swap_b32 v80, v81
  v_max_f32 v80, v80, v81
  v_mov_b32 v81, v80
  v_cvt_pk_bf16_f32 v104, v112, v113
  v_cvt_pk_bf16_f32 v106, v116, v117
  v_permlane32_swap_b32 v80, v81
  v_max_f32 v80, v80, v81
  v_mul_f32 v80, s50, v80
  v_fma_f32 v82, v72, s50, -v80
  v_fma_f32 v83, v73, s50, -v80
  v_exp_f32 v82, v82
  v_fma_f32 v84, v74, s50, -v80
  v_exp_f32 v83, v83
  v_fma_f32 v85, v75, s50, -v80
  v_exp_f32 v84, v84
  v_fma_f32 v86, v76, s50, -v80
  v_exp_f32 v85, v85
  v_cvt_pk_bf16_f32 v88, v82, v83
  v_exp_f32 v86, v86
  v_cvt_pk_bf16_f32 v89, v84, v85
  v_mov_b32_dpp v90, v88 row_ror:8 row_mask:0xf bank_mask:0xf
  v_add_f32 v80, v82, v83
  v_mov_b32_dpp v91, v89 row_ror:8 row_mask:0xf bank_mask:0xf
  v_mov_b32_dpp v81, v86 row_ror:8 row_mask:0xf bank_mask:0xf
  s_nop 0
  v_mfma_f32_16x16x32_bf16 v[112:115], v[136:139], v[88:91], 0
  v_cvt_pk_bf16_f32 v0, v86, v81
  v_add_f32 v87, v84, v85
  v_mfma_f32_16x16x32_bf16 v[116:119], v[140:143], v[88:91], 0
  v_add_f32 v80, v80, v87
  v_add_f32 v80, v80, v86
  v_mfma_f32_16x16x16_bf16 v[112:115], v[104:105], v[0:1], v[112:115]
  ds_read_b128 v[16:19], v2 offset:24576
  v_add_f32_dpp v80, v80, v80 row_ror:8 row_mask:0xf bank_mask:0xf
  v_mfma_f32_16x16x16_bf16 v[116:119], v[106:107], v[0:1], v[116:119]
  v_mov_b32 v81, v80
  ds_read_b128 v[20:23], v2 offset:25600
  ds_read_b128 v[24:27], v2 offset:28672
  v_permlane16_swap_b32 v80, v81
  v_add_f32 v80, v80, v81
  v_mov_b32 v81, v80
  ds_read_b128 v[28:31], v2 offset:29696
  s_nop 0
  v_permlane32_swap_b32 v80, v81
  v_add_f32 v80, v80, v81
  v_rcp_f32 v80, v80
  s_nop 0
  v_pk_mul_f32 v[112:113], v[112:113], v[80:81] op_sel_hi:[1,0]
  v_pk_mul_f32 v[114:115], v[114:115], v[80:81] op_sel_hi:[1,0]
  v_cvt_pk_bf16_f32 v88, v112, v113
  v_cvt_pk_bf16_f32 v89, v114, v115
  v_pk_mul_f32 v[116:117], v[116:117], v[80:81] op_sel_hi:[1,0]
  v_pk_mul_f32 v[118:119], v[118:119], v[80:81] op_sel_hi:[1,0]
  v_cvt_pk_bf16_f32 v90, v116, v117
  v_cvt_pk_bf16_f32 v91, v118, v119
  ds_write_b128 v14, v[88:91]
  s_waitcnt lgkmcnt(0)
  s_barrier
  ds_read_b128 v[64:67], v120 offset:0
  ds_read_b128 v[68:71], v120 offset:512
  ds_read_b128 v[72:75], v120 offset:1024
  ds_read_b128 v[76:79], v120 offset:1536
  s_waitcnt lgkmcnt(3)
  v_smfmac_f32_16x16x64_bf16 v[48:51], v[64:67], a[128:135], v96
  v_smfmac_f32_16x16x64_bf16 v[52:55], v[64:67], a[160:167], v96
  s_waitcnt lgkmcnt(2)
  v_smfmac_f32_16x16x64_bf16 v[48:51], v[68:71], a[136:143], v96
  v_smfmac_f32_16x16x64_bf16 v[52:55], v[68:71], a[168:175], v96
  s_waitcnt lgkmcnt(1)
  v_smfmac_f32_16x16x64_bf16 v[48:51], v[72:75], a[144:151], v96
  v_smfmac_f32_16x16x64_bf16 v[52:55], v[72:75], a[176:183], v96
  s_waitcnt lgkmcnt(0)
  v_smfmac_f32_16x16x64_bf16 v[48:51], v[76:79], a[152:159], v96
  v_smfmac_f32_16x16x64_bf16 v[52:55], v[76:79], a[184:191], v96
  v_smfmac_f32_16x16x64_bf16 v[56:59], v[64:67], a[192:199], v96
  ds_read_b128 v[32:35], v2 offset:26624
  ds_read_b128 v[36:39], v2 offset:27648
  v_smfmac_f32_16x16x64_bf16 v[56:59], v[68:71], a[200:207], v96
  ds_read_b128 v[40:43], v2 offset:30720
  ds_read_b128 v[44:47], v2 offset:31744
  v_smfmac_f32_16x16x64_bf16 v[56:59], v[72:75], a[208:215], v96
  v_cvt_pk_bf16_f32 v80, v48, v49
  v_cvt_pk_bf16_f32 v81, v50, v51
  v_bfi_b32 v80, 1, s58, v80
  v_smfmac_f32_16x16x64_bf16 v[56:59], v[76:79], a[216:223], v96
  v_bfi_b32 v81, 1, s58, v81
  v_cvt_pk_bf16_f32 v82, v52, v53
  v_cvt_pk_bf16_f32 v83, v54, v55
  v_smfmac_f32_16x16x64_bf16 v[60:63], v[64:67], v[16:23], v96
  v_bfi_b32 v82, 1, s58, v82
  v_bfi_b32 v83, 1, s58, v83
  buffer_store_dwordx4 v[80:83], v97, s[4:7], s43 offen
  v_smfmac_f32_16x16x64_bf16 v[60:63], v[72:75], v[24:31], v96
  s_waitcnt lgkmcnt(0)
  v_smfmac_f32_16x16x64_bf16 v[60:63], v[68:71], v[32:39], v96
  v_cvt_pk_bf16_f32 v84, v56, v57
  v_cvt_pk_bf16_f32 v85, v58, v59
  v_smfmac_f32_16x16x64_bf16 v[60:63], v[76:79], v[40:47], v96
  s_add_u32 s31, s43, 65536
  v_bfi_b32 v84, 1, s58, v84
  v_bfi_b32 v85, 1, s58, v85
  s_nop 4
  v_cvt_pk_bf16_f32 v86, v60, v61
  v_cvt_pk_bf16_f32 v87, v62, v63
  v_bfi_b32 v86, 1, s58, v86
  v_bfi_b32 v87, 1, s58, v87
  buffer_store_dwordx4 v[84:87], v97, s[4:7], s31 offen
  ds_read_b128 v[64:67], v2 offset:6144
  ds_read_b128 v[68:71], v2 offset:7168
  ds_read_b128 v[72:75], v2 offset:8192
  ds_read_b128 v[76:79], v2 offset:9216
  ds_read_b128 v[80:83], v2 offset:10240
  ds_read_b128 v[84:87], v2 offset:11264
  ds_read_b128 v[88:91], v2 offset:12288
  ds_read_b128 v[92:95], v2 offset:13312
  v_mov_b32 v36, -1
  v_mov_b32 v37, -1
  v_mov_b32 v48, 0
  v_mov_b32 v49, 0
  v_mov_b32 v50, 0
  v_mov_b32 v51, 0
  v_mov_b32 v52, 0
  v_mov_b32 v53, 0
  v_mov_b32 v54, 0
  v_mov_b32 v55, 0
  v_mov_b32 v112, 0
  v_mov_b32 v113, 0
  v_mov_b32 v114, 0
  v_mov_b32 v115, 0
  v_mov_b32 v116, 0
  v_mov_b32 v117, 0
  v_mov_b32 v118, 0
  v_mov_b32 v119, 0
  v_mov_b32 v56, 0
  v_mov_b32 v57, 0
  v_mov_b32 v58, 0
  v_mov_b32 v59, 0
  v_mov_b32 v60, 0
  v_mov_b32 v61, 0
  v_mov_b32 v62, 0
  v_mov_b32 v63, 0
  s_nop 7
  s_bitcmp0_b32 s30, 2
  s_cbranch_scc1 L_d1_74
  s_nop 7
  s_nop 7
  s_nop 7
  s_nop 7
L_d1_74:
  buffer_load_dwordx4 v[16:19], v15, s[4:7], s47 offen sc1
  buffer_load_dwordx4 v[20:23], v15, s[4:7], s47 offen offset:1024 sc1
L_p1_fc:
  s_waitcnt vmcnt(1)
  v_mfma_f32_16x16x32_bf16 v[32:35], v[100:103], v[16:19], 0
  v_bitop3_b32 v109, v16, v17, s58 bitop3:0x7e
  v_bitop3_b32 v38, v18, v19, s58 bitop3:0x7e
  s_waitcnt vmcnt(0)
  v_mfma_f32_16x16x32_bf16 v[32:35], v[100:103], v[20:23], v[32:35]
  v_bitop3_b32 v39, v20, v21, s58 bitop3:0x7e
  v_or3_b32 v109, v109, v38, v39
  v_bitop3_b32 v38, v22, v23, s58 bitop3:0x7e
  v_bitop3_b32 v109, v109, v38, 1 bitop3:0xa8
  v_cmp_ne_u32 vcc, 0, v109
  s_nop 0
  s_cbranch_vccnz L_p1_f
L_p1_fx:
  s_nop 0
  v_add_f32_dpp v32, v32, v32 row_ror:8 row_mask:0xf bank_mask:0xf
  v_add_f32_dpp v33, v33, v33 row_ror:8 row_mask:0xf bank_mask:0xf
  s_nop 0
  v_add_f32_dpp v32, v32, v32 row_ror:4 row_mask:0xf bank_mask:0xf
  v_add_f32_dpp v33, v33, v33 row_ror:4 row_mask:0xf bank_mask:0xf
  s_mov_b64 exec, s[56:57]
  v_cvt_pk_bf16_f32 v109, v32, v33
  buffer_store_dword v109, v99, s[4:7], s42 offen
  buffer_store_dword v36, v99, s[4:7], s41 offen
  s_mov_b64 exec, -1
  s_add_u32 s40, s40, 1
  s_mov_b32 s41, s42
  s_add_u32 s31, s40, 1
  s_and_b32 s31, s31, 3
  s_lshl_b32 s31, s31, 13
  s_add_u32 s42, s31, 1048576
  s_xor_b32 s58, s58, 1
  s_add_u32 s48, s48, 262144
  ds_read_b128 v[24:27], v2 offset:0
  ds_read_b128 v[28:31], v2 offset:1024
  ds_read_b128 v[32:35], v2 offset:2048
  ds_read_b128 v[36:39], v2 offset:3072
  ds_read_b128 v[40:43], v2 offset:4096
  ds_read_b128 v[44:47], v2 offset:5120
  s_nop 7
  s_nop 7
  s_nop 7
  s_nop 7
  s_nop 7
  s_nop 7
  s_bitcmp1_b32 s30, 2
  s_cbranch_scc1 L_d2_75
  s_nop 7
  s_nop 7
  s_nop 7
  s_nop 7
L_d2_75:
  buffer_load_dwordx4 v[16:19], v98, s[4:7], s41 offen sc1
  buffer_load_dwordx4 v[20:23], v98, s[4:7], s41 offen offset:1024 sc1
  s_branch L_step_f
L_p2_f:
  s_mov_b64 exec, vcc
  buffer_load_dwordx4 v[16:19], v98, s[4:7], s41 offen sc1
  buffer_load_dwordx4 v[20:23], v98, s[4:7], s41 offen offset:1024 sc1
  s_mov_b64 exec, -1
  s_add_u32 s49, s49, 1
  s_cmp_gt_u32 s49, 0x100000
  s_cbranch_scc0 L_step_f
  s_waitcnt vmcnt(0)
  s_branch L_p2_fx
L_p1_f:
  s_mov_b64 exec, vcc
  buffer_load_dwordx4 v[16:19], v15, s[4:7], s47 offen sc1
  buffer_load_dwordx4 v[20:23], v15, s[4:7], s47 offen offset:1024 sc1
  s_mov_b64 exec, -1
  s_add_u32 s49, s49, 1
  s_cmp_gt_u32 s49, 0x100000
  s_cbranch_scc0 L_p1_fc
  s_waitcnt vmcnt(0)
  s_branch L_p1_fx
L_kw_72e:
  s_sub_u32 s32, s44, 262144
  s_mov_b32 exec_lo, 0
L_kw_72:
  s_add_u32 s49, s49, 16
  s_cmp_gt_u32 s49, 0x400000
  s_cbranch_scc1 L_end
  buffer_load_dword v110, v108, s[4:7], s32 offen sc1
  s_waitcnt vmcnt(0)
  v_readlane_b32 s31, v110, 32
  s_sleep 2
  s_cmp_lg_u32 s31, 2
  s_cbranch_scc1 L_kw_72
  s_mov_b64 exec, -1
  s_branch L_kwx_73
L_fin_f:
  s_nop 7
  v_add_f32 v112, v112, v114
  v_add_f32 v113, v113, v115
  v_add_f32 v116, v116, v118
  v_add_f32 v117, v117, v119
  v_cvt_pk_bf16_f32 v104, v112, v113
  v_cvt_pk_bf16_f32 v106, v116, v117
  buffer_store_dwordx4 v[104:107], v15, s[4:7], s51 offen sc1
  s_waitcnt vmcnt(0) lgkmcnt(0)
  s_barrier
  s_mov_b32 s31, 64
  v_mov_b32 v109, s31
  s_mov_b64 exec, 1
  buffer_store_dword v109, v1, s[4:7], s98 offen sc1
  s_mov_b64 exec, -1
  s_branch L_end
L_slow:
  s_mov_b32 s40, 0
  s_mov_b32 s41, 1048576
  s_mov_b32 s42, 1056768
  s_mov_b32 s43, 524288
  s_lshl_b32 s31, s30, 13
  s_lshl_b32 s32, s29, 11
  s_add_u32 s48, s31, 134217728
  s_add_u32 s31, s31, s32
  s_add_u32 s44, s31, 16629760
  s_add_u32 s45, s31, 33406976
  s_add_u32 s46, s44, 16252928
  s_lshl_b32 s32, s29, 10
  s_add_u32 s51, s48, s32
  s_add_u32 s51, s51, -407552
  s_mov_b32 s49, 0
  s_mov_b32 s58, 0
  s_lshl_b32 s31, s30, 13
  s_add_u32 s31, s31, 134223872
  s_mov_b32 s32, 128
  s_mov_b32 s34, 0
L_kw_76:
  s_add_u32 s34, s34, 1
  s_cmp_gt_u32 s34, 0x40000
  s_cbranch_scc1 L_end
  buffer_load_dword v16, v1, s[8:11], s32 offen sc1
  s_waitcnt vmcnt(0)
  buffer_load_dword v17, v1, s[4:7], s31 offen sc1
  s_waitcnt vmcnt(0)
  v_lshlrev_b32 v16, 1, v16
  v_min_u32 v16, v16, v17
  s_nop 0
  v_readfirstlane_b32 s33, v16
  s_nop 3
  s_cmp_lg_u32 s33, 2
  s_cbranch_scc1 L_kw_76
  v_mov_b32 v110, 2
  ds_read_b128 v[64:67], v2 offset:6144
  ds_read_b128 v[68:71], v2 offset:7168
  ds_read_b128 v[72:75], v2 offset:8192
  ds_read_b128 v[76:79], v2 offset:9216
  ds_read_b128 v[80:83], v2 offset:10240
  ds_read_b128 v[84:87], v2 offset:11264
  ds_read_b128 v[88:91], v2 offset:12288
  ds_read_b128 v[92:95], v2 offset:13312
  ds_read_b128 v[24:27], v2 offset:0
  ds_read_b128 v[28:31], v2 offset:1024
  ds_read_b128 v[32:35], v2 offset:2048
  ds_read_b128 v[36:39], v2 offset:3072
  ds_read_b128 v[40:43], v2 offset:4096
  ds_read_b128 v[44:47], v2 offset:5120
  v_mov_b32 v48, 0
  v_mov_b32 v49, 0
  v_mov_b32 v50, 0
  v_mov_b32 v51, 0
  v_mov_b32 v52, 0
  v_mov_b32 v53, 0
  v_mov_b32 v54, 0
  v_mov_b32 v55, 0
  v_mov_b32 v56, 0
  v_mov_b32 v57, 0
  v_mov_b32 v58, 0
  v_mov_b32 v59, 0
  v_mov_b32 v60, 0
  v_mov_b32 v61, 0
  v_mov_b32 v62, 0
  v_mov_b32 v63, 0
  v_mov_b32 v112, 0
  v_mov_b32 v113, 0
  v_mov_b32 v114, 0
  v_mov_b32 v115, 0
  v_mov_b32 v116, 0
  v_mov_b32 v117, 0
  v_mov_b32 v118, 0
  v_mov_b32 v119, 0
  buffer_load_dwordx4 v[16:19], v98, s[4:7], s41 offen sc1
  buffer_load_dwordx4 v[20:23], v98, s[4:7], s41 offen offset:1024 sc1
L_step_s:
  s_waitcnt vmcnt(1)
  ds_write_b128 v3, v[16:19]
  v_max3_u32 v109, v16, v17, v18
  s_waitcnt vmcnt(0)
  ds_write_b128 v3, v[20:23] offset:1024
  v_max3_u32 v109, v109, v19, v20
  v_max3_u32 v109, v109, v21, v22
  v_max_u32 v109, v109, v23
  v_cmp_eq_u32 vcc, -1, v109
  s_cbranch_vccnz L_p2_s
L_p2_sx:
  s_waitcnt lgkmcnt(2)
  v_smfmac_f32_16x16x64_bf16 v[48:51], v[16:19], v[24:31], v96
  buffer_load_dwordx4 v[128:131], v15, s[4:7], s44 offen sc1
  v_smfmac_f32_16x16x64_bf16 v[52:55], v[16:19], v[32:39], v96
  buffer_load_dwordx4 v[132:135], v15, s[4:7], s44 offen offset:1024 sc1
  v_smfmac_f32_16x16x64_bf16 v[56:59], v[16:19], v[40:47], v96
  buffer_load_dwordx4 v[136:139], v15, s[4:7], s45 offen sc1
  v_smfmac_f32_16x16x64_bf16 v[60:63], v[16:19], v[64:71], v96
  buffer_load_dwordx4 v[140:143], v15, s[4:7], s45 offen offset:1024 sc1
  s_waitcnt lgkmcnt(0)
  s_barrier
  ds_read_b128 v[24:27], v4
  ds_read_b128 v[28:31], v4 offset:1024
  v_readlane_b32 s31, v110, 32
  s_cmp_ge_u32 s40, 63
  s_cselect_b32 s31, 2, s31
  s_cmp_lg_u32 s31, 2
  s_cbranch_scc1 L_kw_77e
L_kwx_78:
  s_min_u32 s33, s44, s46
  buffer_load_dword v110, v108, s[4:7], s33 offen sc1
  v_smfmac_f32_16x16x64_bf16 v[48:51], v[20:23], v[72:79], v96
  ds_read_b128 v[32:35], v5
  ds_read_b128 v[36:39], v5 offset:1024
  v_smfmac_f32_16x16x64_bf16 v[52:55], v[20:23], v[80:87], v96
  ds_read_b128 v[40:43], v6
  ds_read_b128 v[44:47], v6 offset:1024
  v_smfmac_f32_16x16x64_bf16 v[56:59], v[20:23], v[88:95], v96
  s_max_u32 s31, s40, 1
  s_sub_u32 s31, s31, 1
  v_mov_b32 v109, s31
  s_mov_b64 exec, 1
  buffer_store_dword v109, v1, s[4:7], s98 offen sc1
  s_mov_b64 exec, -1
  s_add_u32 s44, s44, 262144
  s_add_u32 s45, s45, 262144
  v_smfmac_f32_16x16x64_bf16 v[112:115], v[16:19], a[0:7], v96
  v_smfmac_f32_16x16x64_bf16 v[116:119], v[16:19], a[8:15], v96
  s_waitcnt lgkmcnt(5)
  v_smfmac_f32_16x16x64_bf16 v[48:51], v[24:27], v[176:183], v96
  ds_read_b128 v[64:67], v2 offset:32768
  v_smfmac_f32_16x16x64_bf16 v[52:55], v[24:27], v[184:191], v96
  ds_read_b128 v[68:71], v2 offset:33792
  s_waitcnt lgkmcnt(6)
  v_smfmac_f32_16x16x64_bf16 v[48:51], v[28:31], v[192:199], v96
  ds_read_b128 v[72:75], v2 offset:34816
  v_smfmac_f32_16x16x64_bf16 v[52:55], v[28:31], v[200:207], v96
  ds_read_b128 v[76:79], v2 offset:35840
  s_waitcnt lgkmcnt(7)
  v_smfmac_f32_16x16x64_bf16 v[48:51], v[32:35], v[208:215], v96
  ds_read_b128 v[80:83], v2 offset:14336
  v_smfmac_f32_16x16x64_bf16 v[52:55], v[32:35], v[216:223], v96
  ds_read_b128 v[84:87], v2 offset:15360
  s_waitcnt lgkmcnt(8)
  v_smfmac_f32_16x16x64_bf16 v[48:51], v[36:39], v[224:231], v96
  ds_read_b128 v[88:91], v2 offset:16384
  v_smfmac_f32_16x16x64_bf16 v[52:55], v[36:39], v[232:239], v96
  ds_read_b128 v[92:95], v2 offset:17408
  s_waitcnt lgkmcnt(9)
  v_smfmac_f32_16x16x64_bf16 v[48:51], v[40:43], v[240:247], v96
  v_smfmac_f32_16x16x64_bf16 v[52:55], v[40:43], v[248:255], v96
  buffer_store_dwordx4 v[104:107], v15, s[4:7], s51 offen sc1
  s_add_u32 s51, s51, 262144
  s_waitcnt lgkmcnt(2)
  v_smfmac_f32_16x16x64_bf16 v[48:51], v[44:47], v[64:71], v96
  v_smfmac_f32_16x16x64_bf16 v[52:55], v[44:47], v[72:79], v96
  v_smfmac_f32_16x16x64_bf16 v[60:63], v[20:23], v[80:87], v96
  ds_read_b128 v[64:67], v2 offset:18432
  v_smfmac_f32_16x16x64_bf16 v[56:59], v[24:27], a[224:231], v96
  ds_read_b128 v[68:71], v2 offset:19456
  v_smfmac_f32_16x16x64_bf16 v[60:63], v[24:27], a[232:239], v96
  ds_read_b128 v[72:75], v2 offset:20480
  v_smfmac_f32_16x16x64_bf16 v[56:59], v[28:31], a[240:247], v96
  ds_read_b128 v[76:79], v2 offset:21504
  v_add_f32 v48, v48, v50
  v_add_f32 v49, v49, v51
  v_smfmac_f32_16x16x64_bf16 v[60:63], v[28:31], a[248:255], v96
  ds_read_b128 v[80:83], v2 offset:22528
  v_add_f32 v52, v52, v54
  v_add_f32 v53, v53, v55
  v_smfmac_f32_16x16x64_bf16 v[56:59], v[32:35], v[144:151], v96
  ds_read_b128 v[84:87], v2 offset:23552
  v_cvt_pk_bf16_f32 v109, v48, v52
  v_cvt_pk_bf16_f32 v0, v49, v53
  v_smfmac_f32_16x16x64_bf16 v[60:63], v[32:35], v[152:159], v96
  ds_write2_b32 v11, v109, v0 offset0:0 offset1:16
  v_smfmac_f32_16x16x64_bf16 v[56:59], v[36:39], v[160:167], v96
  v_mov_b32 v48, 0
  v_mov_b32 v49, 0
  v_smfmac_f32_16x16x64_bf16 v[60:63], v[36:39], v[168:175], v96
  v_mov_b32 v50, 0
  v_mov_b32 v51, 0
  s_waitcnt lgkmcnt(1)
  v_smfmac_f32_16x16x64_bf16 v[56:59], v[40:43], v[88:95], v96
  v_mov_b32 v52, 0
  v_mov_b32 v53, 0
  v_smfmac_f32_16x16x64_bf16 v[60:63], v[40:43], v[64:71], v96
  v_mov_b32 v54, 0
  v_mov_b32 v55, 0
  v_smfmac_f32_16x16x64_bf16 v[56:59], v[44:47], v[72:79], v96
  ds_read_b128 v[88:91], v12
  v_smfmac_f32_16x16x64_bf16 v[60:63], v[44:47], v[80:87], v96
  ds_read_b128 v[92:95], v12 offset:32
  v_smfmac_f32_16x16x64_bf16 v[112:115], v[20:23], a[16:23], v96
  v_smfmac_f32_16x16x64_bf16 v[116:119], v[20:23], a[24:31], v96
  s_nop 0
  v_add_f32 v56, v56, v58
  v_add_f32 v57, v57, v59
  v_add_f32 v60, v60, v62
  v_add_f32 v61, v61, v63
  v_cvt_pk_bf16_f32 v109, v56, v60
  v_cvt_pk_bf16_f32 v0, v57, v61
  ds_write2_b32 v11, v109, v0 offset0:128 offset1:144
  ds_read_b128 v[64:67], v13
  ds_read_b128 v[68:71], v13 offset:32
  s_waitcnt lgkmcnt(3) vmcnt(3)
  v_mfma_f32_16x16x32_bf16 v[72:75], v[128:131], v[88:91], 0
  v_mfma_f32_16x16x32_bf16 v[72:75], v[132:135], v[92:95], v[72:75]
  v_smfmac_f32_16x16x64_bf16 v[112:115], v[24:27], a[32:39], v96
  v_mov_b32 v56, 0
  v_mov_b32 v57, 0
  v_smfmac_f32_16x16x64_bf16 v[116:119], v[24:27], a[40:47], v96
  v_mov_b32 v58, 0
  v_mov_b32 v59, 0
  v_smfmac_f32_16x16x64_bf16 v[112:115], v[28:31], a[48:55], v96
  v_mov_b32 v60, 0
  v_mov_b32 v61, 0
  s_waitcnt lgkmcnt(0)
  v_mfma_f32_16x16x32_bf16 v[76:79], v[64:67], v[88:91], 0
  v_mfma_f32_16x16x32_bf16 v[76:79], v[68:71], v[92:95], v[76:79]
  ds_write_b128 v3, v[72:75] offset:8192
  v_smfmac_f32_16x16x64_bf16 v[116:119], v[28:31], a[56:63], v96
  v_mov_b32 v62, 0
  v_mov_b32 v63, 0
  v_smfmac_f32_16x16x64_bf16 v[112:115], v[32:35], a[64:71], v96
  s_nop 0
  ds_write_b32 v7, v76
  v_smfmac_f32_16x16x64_bf16 v[116:119], v[32:35], a[72:79], v96
  buffer_store_dwordx4 v[64:67], v111, s[4:7], s48 offen sc1
  v_smfmac_f32_16x16x64_bf16 v[112:115], v[36:39], a[80:87], v96
  v_smfmac_f32_16x16x64_bf16 v[116:119], v[36:39], a[88:95], v96
  s_waitcnt lgkmcnt(0)
  s_barrier
  ds_read_b128 v[88:91], v4 offset:8192
  ds_read_b32 v84, v8
  v_smfmac_f32_16x16x64_bf16 v[112:115], v[40:43], a[96:103], v96
  ds_read_b128 v[92:95], v5 offset:8192
  ds_read_b32 v85, v9
  v_smfmac_f32_16x16x64_bf16 v[116:119], v[40:43], a[104:111], v96
  ds_read_b128 v[80:83], v6 offset:8192
  ds_read_b32 v86, v10
  v_smfmac_f32_16x16x64_bf16 v[112:115], v[44:47], a[112:119], v96
  v_smfmac_f32_16x16x64_bf16 v[116:119], v[44:47], a[120:127], v96
  s_cmp_eq_u32 s40, 63
  s_cbranch_scc1 L_fin_s
  s_waitcnt lgkmcnt(4)
  v_pk_add_f32 v[72:73], v[72:73], v[88:89]
  v_pk_add_f32 v[74:75], v[74:75], v[90:91]
  v_add_f32 v76, v76, v84
  s_waitcnt lgkmcnt(2)
  v_pk_add_f32 v[72:73], v[72:73], v[92:93]
  v_pk_add_f32 v[74:75], v[74:75], v[94:95]
  v_add_f32 v76, v76, v85
  s_waitcnt lgkmcnt(0)
  v_pk_add_f32 v[72:73], v[72:73], v[80:81]
  v_pk_add_f32 v[74:75], v[74:75], v[82:83]
  v_add_f32 v76, v76, v86
  v_max3_f32 v80, v72, v73, v74
  v_max3_f32 v80, v80, v75, v76
  v_add_f32 v112, v112, v114
  v_add_f32 v113, v113, v115
  v_max_f32_dpp v80, v80, v80 row_ror:8 row_mask:0xf bank_mask:0xf
  v_mov_b32 v81, v80
  v_add_f32 v116, v116, v118
  v_add_f32 v117, v117, v119
  v_permlane16_swap_b32 v80, v81
  v_max_f32 v80, v80, v81
  v_mov_b32 v81, v80
  v_cvt_pk_bf16_f32 v104, v112, v113
  v_cvt_pk_bf16_f32 v106, v116, v117
  v_permlane32_swap_b32 v80, v81
  v_max_f32 v80, v80, v81
  v_mul_f32 v80, s50, v80
  v_fma_f32 v82, v72, s50, -v80
  v_fma_f32 v83, v73, s50, -v80
  v_exp_f32 v82, v82
  v_fma_f32 v84, v74, s50, -v80
  v_exp_f32 v83, v83
  v_fma_f32 v85, v75, s50, -v80
  v_exp_f32 v84, v84
  v_fma_f32 v86, v76, s50, -v80
  v_exp_f32 v85, v85
  v_cvt_pk_bf16_f32 v88, v82, v83
  v_exp_f32 v86, v86
  v_cvt_pk_bf16_f32 v89, v84, v85
  v_mov_b32_dpp v90, v88 row_ror:8 row_mask:0xf bank_mask:0xf
  v_add_f32 v80, v82, v83
  v_mov_b32_dpp v91, v89 row_ror:8 row_mask:0xf bank_mask:0xf
  v_mov_b32_dpp v81, v86 row_ror:8 row_mask:0xf bank_mask:0xf
  s_nop 0
  v_mfma_f32_16x16x32_bf16 v[112:115], v[136:139], v[88:91], 0
  v_cvt_pk_bf16_f32 v0, v86, v81
  v_add_f32 v87, v84, v85
  v_mfma_f32_16x16x32_bf16 v[116:119], v[140:143], v[88:91], 0
  v_add_f32 v80, v80, v87
  v_add_f32 v80, v80, v86
  v_mfma_f32_16x16x16_bf16 v[112:115], v[104:105], v[0:1], v[112:115]
  ds_read_b128 v[16:19], v2 offset:24576
  v_add_f32_dpp v80, v80, v80 row_ror:8 row_mask:0xf bank_mask:0xf
  v_mfma_f32_16x16x16_bf16 v[116:119], v[106:107], v[0:1], v[116:119]
  v_mov_b32 v81, v80
  ds_read_b128 v[20:23], v2 offset:25600
  ds_read_b128 v[24:27], v2 offset:28672
  v_permlane16_swap_b32 v80, v81
  v_add_f32 v80, v80, v81
  v_mov_b32 v81, v80
  ds_read_b128 v[28:31], v2 offset:29696
  s_nop 0
  v_permlane32_swap_b32 v80, v81
  v_add_f32 v80, v80, v81
  v_rcp_f32 v80, v80
  s_nop 0
  v_pk_mul_f32 v[112:113], v[112:113], v[80:81] op_sel_hi:[1,0]
  v_pk_mul_f32 v[114:115], v[114:115], v[80:81] op_sel_hi:[1,0]
  v_cvt_pk_bf16_f32 v88, v112, v113
  v_cvt_pk_bf16_f32 v89, v114, v115
  v_pk_mul_f32 v[116:117], v[116:117], v[80:81] op_sel_hi:[1,0]
  v_pk_mul_f32 v[118:119], v[118:119], v[80:81] op_sel_hi:[1,0]
  v_cvt_pk_bf16_f32 v90, v116, v117
  v_cvt_pk_bf16_f32 v91, v118, v119
  ds_write_b128 v14, v[88:91]
  s_waitcnt lgkmcnt(0)
  s_barrier
  ds_read_b128 v[64:67], v120 offset:0
  ds_read_b128 v[68:71], v120 offset:512
  ds_read_b128 v[72:75], v120 offset:1024
  ds_read_b128 v[76:79], v120 offset:1536
  s_waitcnt lgkmcnt(3)
  v_smfmac_f32_16x16x64_bf16 v[48:51], v[64:67], a[128:135], v96
  v_smfmac_f32_16x16x64_bf16 v[52:55], v[64:67], a[160:167], v96
  s_waitcnt lgkmcnt(2)
  v_smfmac_f32_16x16x64_bf16 v[48:51], v[68:71], a[136:143], v96
  v_smfmac_f32_16x16x64_bf16 v[52:55], v[68:71], a[168:175], v96
  s_waitcnt lgkmcnt(1)
  v_smfmac_f32_16x16x64_bf16 v[48:51], v[72:75], a[144:151], v96
  v_smfmac_f32_16x16x64_bf16 v[52:55], v[72:75], a[176:183], v96
  s_waitcnt lgkmcnt(0)
  v_smfmac_f32_16x16x64_bf16 v[48:51], v[76:79], a[152:159], v96
  v_smfmac_f32_16x16x64_bf16 v[52:55], v[76:79], a[184:191], v96
  v_smfmac_f32_16x16x64_bf16 v[56:59], v[64:67], a[192:199], v96
  ds_read_b128 v[32:35], v2 offset:26624
  ds_read_b128 v[36:39], v2 offset:27648
  v_smfmac_f32_16x16x64_bf16 v[56:59], v[68:71], a[200:207], v96
  ds_read_b128 v[40:43], v2 offset:30720
  ds_read_b128 v[44:47], v2 offset:31744
  v_smfmac_f32_16x16x64_bf16 v[56:59], v[72:75], a[208:215], v96
  v_cvt_pk_bf16_f32 v80, v48, v49
  v_cvt_pk_bf16_f32 v81, v50, v51
  v_bfi_b32 v80, 1, s58, v80
  v_smfmac_f32_16x16x64_bf16 v[56:59], v[76:79], a[216:223], v96
  v_bfi_b32 v81, 1, s58, v81
  v_cvt_pk_bf16_f32 v82, v52, v53
  v_cvt_pk_bf16_f32 v83, v54, v55
  v_smfmac_f32_16x16x64_bf16 v[60:63], v[64:67], v[16:23], v96
  v_bfi_b32 v82, 1, s58, v82
  v_bfi_b32 v83, 1, s58, v83
  buffer_store_dwordx4 v[80:83], v97, s[4:7], s43 offen sc1
  v_smfmac_f32_16x16x64_bf16 v[60:63], v[72:75], v[24:31], v96
  s_waitcnt lgkmcnt(0)
  v_smfmac_f32_16x16x64_bf16 v[60:63], v[68:71], v[32:39], v96
  v_cvt_pk_bf16_f32 v84, v56, v57
  v_cvt_pk_bf16_f32 v85, v58, v59
  v_smfmac_f32_16x16x64_bf16 v[60:63], v[76:79], v[40:47], v96
  s_add_u32 s31, s43, 65536
  v_bfi_b32 v84, 1, s58, v84
  v_bfi_b32 v85, 1, s58, v85
  s_nop 4
  v_cvt_pk_bf16_f32 v86, v60, v61
  v_cvt_pk_bf16_f32 v87, v62, v63
  v_bfi_b32 v86, 1, s58, v86
  v_bfi_b32 v87, 1, s58, v87
  buffer_store_dwordx4 v[84:87], v97, s[4:7], s31 offen sc1
  ds_read_b128 v[64:67], v2 offset:6144
  ds_read_b128 v[68:71], v2 offset:7168
  ds_read_b128 v[72:75], v2 offset:8192
  ds_read_b128 v[76:79], v2 offset:9216
  ds_read_b128 v[80:83], v2 offset:10240
  ds_read_b128 v[84:87], v2 offset:11264
  ds_read_b128 v[88:91], v2 offset:12288
  ds_read_b128 v[92:95], v2 offset:13312
  v_mov_b32 v36, -1
  v_mov_b32 v37, -1
  v_mov_b32 v48, 0
  v_mov_b32 v49, 0
  v_mov_b32 v50, 0
  v_mov_b32 v51, 0
  v_mov_b32 v52, 0
  v_mov_b32 v53, 0
  v_mov_b32 v54, 0
  v_mov_b32 v55, 0
  v_mov_b32 v112, 0
  v_mov_b32 v113, 0
  v_mov_b32 v114, 0
  v_mov_b32 v115, 0
  v_mov_b32 v116, 0
  v_mov_b32 v117, 0
  v_mov_b32 v118, 0
  v_mov_b32 v119, 0
  v_mov_b32 v56, 0
  v_mov_b32 v57, 0
  v_mov_b32 v58, 0
  v_mov_b32 v59, 0
  v_mov_b32 v60, 0
  v_mov_b32 v61, 0
  v_mov_b32 v62, 0
  v_mov_b32 v63, 0
  s_nop 7
  s_bitcmp0_b32 s30, 2
  s_cbranch_scc1 L_d1_79
  s_nop 7
  s_nop 7
  s_nop 7
  s_nop 7
L_d1_79:
  buffer_load_dwordx4 v[16:19], v15, s[4:7], s47 offen sc1
  buffer_load_dwordx4 v[20:23], v15, s[4:7], s47 offen offset:1024 sc1
L_p1_sc:
  s_waitcnt vmcnt(1)
  v_mfma_f32_16x16x32_bf16 v[32:35], v[100:103], v[16:19], 0
  v_bitop3_b32 v109, v16, v17, s58 bitop3:0x7e
  v_bitop3_b32 v38, v18, v19, s58 bitop3:0x7e
  s_waitcnt vmcnt(0)
  v_mfma_f32_16x16x32_bf16 v[32:35], v[100:103], v[20:23], v[32:35]
  v_bitop3_b32 v39, v20, v21, s58 bitop3:0x7e
  v_or3_b32 v109, v109, v38, v39
  v_bitop3_b32 v38, v22, v23, s58 bitop3:0x7e
  v_bitop3_b32 v109, v109, v38, 1 bitop3:0xa8
  v_cmp_ne_u32 vcc, 0, v109
  s_nop 0
  s_cbranch_vccnz L_p1_s
L_p1_sx:
  s_nop 0
  v_add_f32_dpp v32, v32, v32 row_ror:8 row_mask:0xf bank_mask:0xf
  v_add_f32_dpp v33, v33, v33 row_ror:8 row_mask:0xf bank_mask:0xf
  s_nop 0
  v_add_f32_dpp v32, v32, v32 row_ror:4 row_mask:0xf bank_mask:0xf
  v_add_f32_dpp v33, v33, v33 row_ror:4 row_mask:0xf bank_mask:0xf
  s_mov_b64 exec, s[56:57]
  v_cvt_pk_bf16_f32 v109, v32, v33
  buffer_store_dword v109, v99, s[4:7], s42 offen sc1
  buffer_store_dword v36, v99, s[4:7], s41 offen sc1
  s_mov_b64 exec, -1
  s_add_u32 s40, s40, 1
  s_mov_b32 s41, s42
  s_add_u32 s31, s40, 1
  s_and_b32 s31, s31, 3
  s_lshl_b32 s31, s31, 13
  s_add_u32 s42, s31, 1048576
  s_xor_b32 s58, s58, 1
  s_add_u32 s48, s48, 262144
  ds_read_b128 v[24:27], v2 offset:0
  ds_read_b128 v[28:31], v2 offset:1024
  ds_read_b128 v[32:35], v2 offset:2048
  ds_read_b128 v[36:39], v2 offset:3072
  ds_read_b128 v[40:43], v2 offset:4096
  ds_read_b128 v[44:47], v2 offset:5120
  s_nop 7
  s_nop 7
  s_nop 7
  s_nop 7
  s_nop 7
  s_nop 7
  s_bitcmp1_b32 s30, 2
  s_cbranch_scc1 L_d2_80
  s_nop 7
  s_nop 7
  s_nop 7
  s_nop 7
L_d2_80:
  buffer_load_dwordx4 v[16:19], v98, s[4:7], s41 offen sc1
  buffer_load_dwordx4 v[20:23], v98, s[4:7], s41 offen offset:1024 sc1
  s_branch L_step_s
L_p2_s:
  s_mov_b64 exec, vcc
  buffer_load_dwordx4 v[16:19], v98, s[4:7], s41 offen sc1
  buffer_load_dwordx4 v[20:23], v98, s[4:7], s41 offen offset:1024 sc1
  s_mov_b64 exec, -1
  s_add_u32 s49, s49, 1
  s_cmp_gt_u32 s49, 0x100000
  s_cbranch_scc0 L_step_s
  s_waitcnt vmcnt(0)
  s_branch L_p2_sx
L_p1_s:
  s_mov_b64 exec, vcc
  buffer_load_dwordx4 v[16:19], v15, s[4:7], s47 offen sc1
  buffer_load_dwordx4 v[20:23], v15, s[4:7], s47 offen offset:1024 sc1
  s_mov_b64 exec, -1
  s_add_u32 s49, s49, 1
  s_cmp_gt_u32 s49, 0x100000
  s_cbranch_scc0 L_p1_sc
  s_waitcnt vmcnt(0)
  s_branch L_p1_sx
L_kw_77e:
  s_sub_u32 s32, s44, 262144
  s_mov_b32 exec_lo, 0
L_kw_77:
  s_add_u32 s49, s49, 16
  s_cmp_gt_u32 s49, 0x400000
  s_cbranch_scc1 L_end
  buffer_load_dword v110, v108, s[4:7], s32 offen sc1
  s_waitcnt vmcnt(0)
  v_readlane_b32 s31, v110, 32
  s_sleep 2
  s_cmp_lg_u32 s31, 2
  s_cbranch_scc1 L_kw_77
  s_mov_b64 exec, -1
  s_branch L_kwx_78
L_fin_s:
  s_nop 7
  v_add_f32 v112, v112, v114
  v_add_f32 v113, v113, v115
  v_add_f32 v116, v116, v118
  v_add_f32 v117, v117, v119
  v_cvt_pk_bf16_f32 v104, v112, v113
  v_cvt_pk_bf16_f32 v106, v116, v117
  buffer_store_dwordx4 v[104:107], v15, s[4:7], s51 offen sc1
  s_waitcnt vmcnt(0) lgkmcnt(0)
  s_barrier
  s_mov_b32 s31, 64
  v_mov_b32 v109, s31
  s_mov_b64 exec, 1
  buffer_store_dword v109, v1, s[4:7], s98 offen sc1
  s_mov_b64 exec, -1
L_end:
  s_endpgm
  .p2align 4
  .type task_table,@object
task_table:
  .long 0x1, 0x80, 0x14, 0x10, 0x7, 0x2e, 0x94, 0x20
  .long 0x1, 0xc0, 0x1d6, 0x9880, 0x7, 0x10, 0x296, 0x9900
  .long 0x1, 0x1b0, 0x306, 0x9c80, 0x100007, 0x100017, 0x100027, 0x100037
  .long 0x100047, 0x100057, 0x100067, 0x100077, 0x100087, 0x100097, 0x1000a7, 0x1000b7
  .long 0x1000c7, 0x1000d7, 0x1000e7, 0x1000f7, 0x100107, 0x100117, 0x100127, 0x100137
  .long 0x100147, 0x100157, 0x100167, 0x100177, 0x100187, 0x100197, 0x1001a7, 0x1001b7
  .long 0x1001c7, 0x1001d7, 0x1001e7, 0x1001f7, 0x100207, 0x100217, 0x100227, 0x100237
  .long 0x100247, 0x100257, 0x100267, 0x100277, 0x100287, 0x100297, 0x1002a7, 0x1002b7
  .long 0x1002c7, 0x1002d7, 0x1002e7, 0x1002f7, 0x100307, 0x100317, 0x100327, 0x100337
  .long 0x100347, 0x100357, 0x100367, 0x100377, 0x100387, 0x100397, 0x1003a7, 0x1003b7
  .long 0x1003c7, 0x1003d7, 0x1003e7, 0x1003f7, 0x100407, 0x100417, 0x100427, 0x100437
  .long 0x100447, 0x100457, 0x100467, 0x100477, 0x100487, 0x100497, 0x1004a7, 0x1004b7
  .long 0x1004c7, 0x1004d7, 0x1004e7, 0x1004f7, 0x100507, 0x100517, 0x100527, 0x100537
  .long 0x100547, 0x100557, 0x100567, 0x100577, 0x100587, 0x100597, 0x1005a7, 0x1005b7
  .long 0x1005c7, 0x1005d7, 0x1005e7, 0x1005f7, 0x100607, 0x100617, 0x100627, 0x100637
  .long 0x100647, 0x100657, 0x100667, 0x100677, 0x100687, 0x100697, 0x1006a7, 0x1006b7
  .long 0x1006c7, 0x1006d7, 0x1006e7, 0x1006f7, 0x100707, 0x100717, 0x100727, 0x100737
  .long 0x100747, 0x100757, 0x100767, 0x100777, 0x100787, 0x100797, 0x1007a7, 0x1007b7
  .long 0x1007c7, 0x1007d7, 0x1007e7, 0x1007f7, 0xb, 0x10000b, 0x20000b, 0x30000b
  .long 0x40000b, 0x50000b, 0x60000b, 0x70000b, 0x80000b, 0x90000b, 0xa0001b, 0xb0001b
  .long 0xc0001b, 0xd0001b, 0xe0001b, 0xf0002b, 0x100002b, 0x110002b, 0x140003b, 0x150003b
  .long 0x160003b, 0x190004b, 0x1a0004b, 0x1b0004b, 0x1e0005b, 0x1f0005b, 0x200005b, 0x230006b
  .long 0x240006b, 0x250006b, 0x280007b, 0x290007b, 0x120002b, 0x130002b, 0x170003b, 0x180003b
  .long 0x1c0004b, 0x1d0004b, 0x210005b, 0x220005b, 0x260006b, 0x270006b, 0x2a0007b, 0x2b0007b
  .long 0x2c0007b, 0x2d0007b, 0x2e0000b, 0x2f0000b, 0x300000b, 0x310000b, 0x320000b, 0x330000b
  .long 0x340000b, 0x350000b, 0x360000b, 0x370000b, 0x380001b, 0x390001b, 0x3a0001b, 0x3b0001b
  .long 0x3c0001b, 0x3d0002b, 0x3e0002b, 0x3f0002b, 0x420003b, 0x430003b, 0x440003b, 0x470004b
  .long 0x480004b, 0x490004b, 0x4c0005b, 0x4d0005b, 0x4e0005b, 0x510006b, 0x520006b, 0x530006b
  .long 0x560007b, 0x570007b, 0x400002b, 0x410002b, 0x450003b, 0x460003b, 0x4a0004b, 0x4b0004b
  .long 0x4f0005b, 0x500005b, 0x540006b, 0x550006b, 0x580007b, 0x590007b, 0x5a0007b, 0x5b0007b
  .long 0x5c0000b, 0x5d0000b, 0x5e0000b, 0x5f0000b, 0x600000b, 0x610000b, 0x620000b, 0x630000b
  .long 0x640000b, 0x650000b, 0x660001b, 0x670001b, 0x680001b, 0x690001b, 0x6a0001b, 0x6b0002b
  .long 0x6c0002b, 0x6d0002b, 0x700003b, 0x710003b, 0x720003b, 0x750004b, 0x760004b, 0x770004b
  .long 0x7a0005b, 0x7b0005b, 0x7c0005b, 0x7f0006b, 0x800006b, 0x810006b, 0x840007b, 0x850007b
  .long 0x6e0002b, 0x6f0002b, 0x730003b, 0x740003b, 0x780004b, 0x790004b, 0x7d0005b, 0x7e0005b
  .long 0x820006b, 0x830006b, 0x860007b, 0x870007b, 0x880007b, 0x890007b, 0x8a0000b, 0x8b0000b
  .long 0x8c0000b, 0x8d0000b, 0x8e0000b, 0x8f0000b, 0x900000b, 0x910000b, 0x920000b, 0x930000b
  .long 0x940001b, 0x950001b, 0x960001b, 0x970001b, 0x980001b, 0x990002b, 0x9a0002b, 0x9b0002b
  .long 0x9e0003b, 0x9f0003b, 0xa00003b, 0xa30004b, 0xa40004b, 0xa50004b, 0xa80005b, 0xa90005b
  .long 0xaa0005b, 0xad0006b, 0xae0006b, 0xaf0006b, 0xb20007b, 0xb30007b, 0x9c0002b, 0x9d0002b
  .long 0xa10003b, 0xa20003b, 0xa60004b, 0xa70004b, 0xab0005b, 0xac0005b, 0xb00006b, 0xb10006b
  .long 0xb40007b, 0xb50007b, 0xb60007b, 0xb70007b, 0xb80000b, 0xb90000b, 0xba0000b, 0xbb0000b
  .long 0xbc0000b, 0xbd0000b, 0xbe0000b, 0xbf0000b, 0xc00001b, 0xc10001b, 0xc20001b, 0xc30001b
  .long 0xc40002b, 0xc50002b, 0xc60002b, 0xc70002b, 0xc80003b, 0xc90003b, 0xca0003b, 0xcb0003b
  .long 0xcc0004b, 0xcd0004b, 0xce0004b, 0xd00005b, 0xd10005b, 0xd20005b, 0xd50006b, 0xd60006b
  .long 0xd70006b, 0xda0007b, 0xdb0007b, 0xdc0007b, 0xcf0004b, 0xd30005b, 0xd40005b, 0xd80006b
  .long 0xd90006b, 0xdd0007b, 0xde0007b, 0x10000a, 0x10000a, 0x10000a, 0x10000a, 0x10000a
  .long 0x10000a, 0x10000a, 0xdf0000b, 0xe00000b, 0xe10000b, 0xe20000b, 0xe30000b, 0xe40000b
  .long 0xe50000b, 0xe60000b, 0xe70001b, 0xe80001b, 0xe90001b, 0xea0001b, 0xeb0002b, 0xec0002b
  .long 0xed0002b, 0xee0002b, 0xef0003b, 0xf00003b, 0xf10003b, 0xf20003b, 0xf30004b, 0xf40004b
  .long 0xf50004b, 0xf70005b, 0xf80005b, 0xf90005b, 0xfc0006b, 0xfd0006b, 0xfe0006b, 0x1010007b
  .long 0x1020007b, 0x1030007b, 0xf60004b, 0xfa0005b, 0xfb0005b, 0xff0006b, 0x1000006b, 0x1040007b
  .long 0x1050007b, 0x10000a, 0x10000a, 0x10000a, 0x10000a, 0x10000a, 0x10000a, 0x10000a
  .long 0x1060000b, 0x1070000b, 0x1080000b, 0x1090000b, 0x10a0000b, 0x10b0000b, 0x10c0000b, 0x10d0000b
  .long 0x10e0001b, 0x10f0001b, 0x1100001b, 0x1110001b, 0x1120002b, 0x1130002b, 0x1140002b, 0x1150002b
  .long 0x1160003b, 0x1170003b, 0x1180003b, 0x1190003b, 0x11a0004b, 0x11b0004b, 0x11c0004b, 0x11f0005b
  .long 0x1200005b, 0x1210005b, 0x1240006b, 0x1250006b, 0x1260006b, 0x1290007b, 0x12a0007b, 0x12b0007b
  .long 0x11d0004b, 0x11e0004b, 0x1220005b, 0x1230005b, 0x1270006b, 0x1280006b, 0x12c0007b, 0x12d0007b
  .long 0x10000a, 0x10000a, 0x10000a, 0x10000a, 0x10000a, 0x10000a, 0x100008, 0x100018
  .long 0x100028, 0x100038, 0x100048, 0x100058, 0x100068, 0x100078, 0x100088, 0x100098
  .long 0x1000a8, 0x1000b8, 0x1000c8, 0x1000d8, 0x1000e8, 0x1000f8, 0x100108, 0x100118
  .long 0x100128, 0x100138, 0x100148, 0x100158, 0x100168, 0x100178, 0x100188, 0x100198
  .long 0x1001a8, 0x1001b8, 0x1001c8, 0x1001d8, 0x1001e8, 0x1001f8, 0x100208, 0x100218
  .long 0x100228, 0x100238, 0x100248, 0x100258, 0x100268, 0x100278, 0x100288, 0x100298
  .long 0x1002a8, 0x1002b8, 0x1002c8, 0x1002d8, 0x1002e8, 0x1002f8, 0x100308, 0x100318
  .long 0x100328, 0x100338, 0x100348, 0x100358, 0x100368, 0x100378, 0x100388, 0x100398
  .long 0x1003a8, 0x1003b8, 0x1003c8, 0x1003d8, 0x1003e8, 0x1003f8, 0x100408, 0x100418
  .long 0x100428, 0x100438, 0x100448, 0x100458, 0x100468, 0x100478, 0x100488, 0x100498
  .long 0x1004a8, 0x1004b8, 0x1004c8, 0x1004d8, 0x1004e8, 0x1004f8, 0x100508, 0x100518
  .long 0x100528, 0x100538, 0x100548, 0x100558, 0x100568, 0x100578, 0x100588, 0x100598
  .long 0x1005a8, 0x1005b8, 0x1005c8, 0x1005d8, 0x1005e8, 0x1005f8, 0x100608, 0x100618
  .long 0x100628, 0x100638, 0x100648, 0x100658, 0x100668, 0x100678, 0x100688, 0x100698
  .long 0x1006a8, 0x1006b8, 0x1006c8, 0x1006d8, 0x1006e8, 0x1006f8, 0x100708, 0x100718
  .long 0x100728, 0x100738, 0x100748, 0x100758, 0x100768, 0x100778, 0x100788, 0x100798
  .long 0x1007a8, 0x1007b8, 0x1007c8, 0x1007d8, 0x1007e8, 0x1007f8, 0x100009, 0x101009
  .long 0x102009, 0x103009, 0x104009, 0x105009, 0x106009, 0x107009, 0x108009, 0x109009
  .long 0x10a009, 0x10b009, 0x10c009, 0x10d009, 0x10e009, 0x10f009, 0x110009, 0x111009
  .long 0x112009, 0x113009, 0x114009, 0x115009, 0x116009, 0x117009, 0x118009, 0x119009
  .long 0x11a009, 0x11b009, 0x11c009, 0x11d009, 0x11e009, 0x11f009, 0x100019, 0x101019
  .long 0x102019, 0x103019, 0x104019, 0x105019, 0x106019, 0x107019, 0x108019, 0x109019
  .long 0x10a019, 0x10b019, 0x10c019, 0x10d019, 0x10e019, 0x10f019, 0x110019, 0x111019
  .long 0x112019, 0x113019, 0x114019, 0x115019, 0x116019, 0x117019, 0x118019, 0x119019
  .long 0x11a019, 0x11b019, 0x11c019, 0x11d019, 0x11e019, 0x11f019, 0x100003, 0x100013
  .long 0x100023, 0x100033, 0x100043, 0x100053, 0x100063, 0x100073, 0x100083, 0x100093
  .long 0x1000a3, 0x1000b3, 0x1000c3, 0x1000d3, 0x1000e3, 0x1000f3, 0x101003, 0x101013
  .long 0x101023, 0x101033, 0x101043, 0x101053, 0x101063, 0x101073, 0x101083, 0x101093
  .long 0x1010a3, 0x1010b3, 0x1010c3, 0x1010d3, 0x1010e3, 0x1010f3, 0x102003, 0x102013
  .long 0x102023, 0x102033, 0x102043, 0x102053, 0x102063, 0x102073, 0x102083, 0x102093
  .long 0x1020a3, 0x1020b3, 0x1020c3, 0x1020d3, 0x1020e3, 0x1020f3, 0x103003, 0x103013
  .long 0x103023, 0x103033, 0x103043, 0x103053, 0x103063, 0x103073, 0x103083, 0x103093
  .long 0x1030a3, 0x1030b3, 0x1030c3, 0x1030d3, 0x1030e3, 0x1030f3, 0x104003, 0x104013
  .long 0x104023, 0x104033, 0x104043, 0x104053, 0x104063, 0x104073, 0x104083, 0x104093
  .long 0x1040a3, 0x1040b3, 0x1040c3, 0x1040d3, 0x1040e3, 0x1040f3, 0x105003, 0x105013
  .long 0x105023, 0x105033, 0x105043, 0x105053, 0x105063, 0x105073, 0x105083, 0x105093
  .long 0x1050a3, 0x1050b3, 0x1050c3, 0x1050d3, 0x1050e3, 0x1050f3, 0x106003, 0x106013
  .long 0x106023, 0x106033, 0x106043, 0x106053, 0x106063, 0x106073, 0x106083, 0x106093
  .long 0x1060a3, 0x1060b3, 0x1060c3, 0x1060d3, 0x1060e3, 0x1060f3, 0x100029, 0x101029
  .long 0x102029, 0x103029, 0x104029, 0x105029, 0x106029, 0x107029, 0x108029, 0x109029
  .long 0x10a029, 0x10b029, 0x10c029, 0x10d029, 0x10e029, 0x10f029, 0x110029, 0x111029
  .long 0x112029, 0x113029, 0x114029, 0x115029, 0x116029, 0x117029, 0x118029, 0x119029
  .long 0x11a029, 0x11b029, 0x11c029, 0x11d029, 0x11e029, 0x11f029, 0x100039, 0x101039
  .long 0x102039, 0x103039, 0x104039, 0x105039, 0x106039, 0x107039, 0x108039, 0x109039
  .long 0x10a039, 0x10b039, 0x10c039, 0x10d039, 0x10e039, 0x10f039, 0x110039, 0x111039
  .long 0x112039, 0x113039, 0x114039, 0x115039, 0x116039, 0x117039, 0x118039, 0x119039
  .long 0x11a039, 0x11b039, 0x11c039, 0x11d039, 0x11e039, 0x11f039, 0x100004, 0x101004
  .long 0x102004, 0x103004, 0x100014, 0x101014, 0x102014, 0x103014, 0x100024, 0x101024
  .long 0x102024, 0x103024, 0x100034, 0x101034, 0x102034, 0x103034, 0x100044, 0x101044
  .long 0x102044, 0x103044, 0x100054, 0x101054, 0x102054, 0x103054, 0x100064, 0x101064
  .long 0x102064, 0x103064, 0x100074, 0x101074, 0x102074, 0x103074, 0x100084, 0x101084
  .long 0x102084, 0x103084, 0x100094, 0x101094, 0x102094, 0x103094, 0x1000a4, 0x1010a4
  .long 0x1020a4, 0x1030a4, 0x1000b4, 0x1010b4, 0x1020b4, 0x1030b4, 0x1000c4, 0x1010c4
  .long 0x1020c4, 0x1030c4, 0x1000d4, 0x1010d4, 0x1020d4, 0x1030d4, 0x1000e4, 0x1010e4
  .long 0x1020e4, 0x1030e4, 0x1000f4, 0x1010f4, 0x1020f4, 0x1030f4, 0x200005, 0x202005
  .long 0x204005, 0x206005, 0x200015, 0x202015, 0x204015, 0x206015, 0x200025, 0x202025
  .long 0x204025, 0x206025, 0x200035, 0x202035, 0x204035, 0x206035, 0x200045, 0x202045
  .long 0x204045, 0x206045, 0x200055, 0x202055, 0x204055, 0x206055, 0x200065, 0x202065
  .long 0x204065, 0x206065, 0x200075, 0x202075, 0x204075, 0x206075, 0x200085, 0x202085
  .long 0x204085, 0x206085, 0x200095, 0x202095, 0x204095, 0x206095, 0x2000a5, 0x2020a5
  .long 0x2040a5, 0x2060a5, 0x2000b5, 0x2020b5, 0x2040b5, 0x2060b5, 0x2000c5, 0x2020c5
  .long 0x2040c5, 0x2060c5, 0x2000d5, 0x2020d5, 0x2040d5, 0x2060d5, 0x2000e5, 0x2020e5
  .long 0x2040e5, 0x2060e5, 0x2000f5, 0x2020f5, 0x2040f5, 0x2060f5, 0x200105, 0x202105
  .long 0x204105, 0x206105, 0x200115, 0x202115, 0x204115, 0x206115, 0x200125, 0x202125
  .long 0x204125, 0x206125, 0x200135, 0x202135, 0x204135, 0x206135, 0x200145, 0x202145
  .long 0x204145, 0x206145, 0x200155, 0x202155, 0x204155, 0x206155, 0x200165, 0x202165
  .long 0x204165, 0x206165, 0x200175, 0x202175, 0x204175, 0x206175, 0x200185, 0x202185
  .long 0x204185, 0x206185, 0x200195, 0x202195, 0x204195, 0x206195, 0x2001a5, 0x2021a5
  .long 0x2041a5, 0x2061a5, 0x2001b5, 0x2021b5, 0x2041b5, 0x2061b5, 0x2001c5, 0x2021c5
  .long 0x2041c5, 0x2061c5, 0x2001d5, 0x2021d5, 0x2041d5, 0x2061d5, 0x2001e5, 0x2021e5
  .long 0x2041e5, 0x2061e5, 0x2001f5, 0x2021f5, 0x2041f5, 0x2061f5, 0x200205, 0x202205
  .long 0x204205, 0x206205, 0x200215, 0x202215, 0x204215, 0x206215, 0x200225, 0x202225
  .long 0x204225, 0x206225, 0x200235, 0x202235, 0x204235, 0x206235, 0x200245, 0x202245
  .long 0x204245, 0x206245, 0x200255, 0x202255, 0x204255, 0x206255, 0x200265, 0x202265
  .long 0x204265, 0x206265, 0x200275, 0x202275, 0x204275, 0x206275, 0x200285, 0x202285
  .long 0x204285, 0x206285, 0x200295, 0x202295, 0x204295, 0x206295, 0x2002a5, 0x2022a5
  .long 0x2042a5, 0x2062a5, 0x2002b5, 0x2022b5, 0x2042b5, 0x2062b5, 0x2002c5, 0x2022c5
  .long 0x2042c5, 0x2062c5, 0x2002d5, 0x2022d5, 0x2042d5, 0x2062d5, 0x2002e5, 0x2022e5
  .long 0x2042e5, 0x2062e5, 0x2002f5, 0x2022f5, 0x2042f5, 0x2062f5, 0x200305, 0x202305
  .long 0x204305, 0x206305, 0x200315, 0x202315, 0x204315, 0x206315, 0x200325, 0x202325
  .long 0x204325, 0x206325, 0x200335, 0x202335, 0x204335, 0x206335, 0x100345, 0x101345
  .long 0x102345, 0x103345, 0x104345, 0x105345, 0x106345, 0x107345, 0x100355, 0x101355
  .long 0x102355, 0x103355, 0x104355, 0x105355, 0x106355, 0x107355, 0x100365, 0x101365
  .long 0x102365, 0x103365, 0x104365, 0x105365, 0x106365, 0x107365, 0x100375, 0x101375
  .long 0x102375, 0x103375, 0x104375, 0x105375, 0x106375, 0x107375, 0x100385, 0x101385
  .long 0x102385, 0x103385, 0x104385, 0x105385, 0x106385, 0x107385, 0x100395, 0x101395
  .long 0x102395, 0x103395, 0x104395, 0x105395, 0x106395, 0x107395, 0x1003a5, 0x1013a5
  .long 0x1023a5, 0x1033a5, 0x1043a5, 0x1053a5, 0x1063a5, 0x1073a5, 0x1003b5, 0x1013b5
  .long 0x1023b5, 0x1033b5, 0x1043b5, 0x1053b5, 0x1063b5, 0x1073b5, 0x1003c5, 0x1013c5
  .long 0x1023c5, 0x1033c5, 0x1043c5, 0x1053c5, 0x1063c5, 0x1073c5, 0x1003d5, 0x1013d5
  .long 0x1023d5, 0x1033d5, 0x1043d5, 0x1053d5, 0x1063d5, 0x1073d5, 0x1003e5, 0x1013e5
  .long 0x1023e5, 0x1033e5, 0x1043e5, 0x1053e5, 0x1063e5, 0x1073e5, 0x1003f5, 0x1013f5
  .long 0x1023f5, 0x1033f5, 0x1043f5, 0x1053f5, 0x1063f5, 0x1073f5, 0x0, 0x0
  .long 0x100000, 0x107002, 0x10000a, 0x10000a, 0x100006, 0x100002, 0x10000a, 0x10000a
  .long 0x101000, 0x100001, 0x10000a, 0x10000a, 0x101006, 0x101001, 0x10000a, 0x10000a
  .long 0x102000, 0x102001, 0x10000a, 0x10000a, 0x102006, 0x103001, 0x10000a, 0x10000a
  .long 0x103000, 0x10000a, 0x10000a, 0x10000a, 0x103006, 0x10000a, 0x10000a, 0x10000a
  .long 0x104000, 0x10000a, 0x10000a, 0x10000a, 0x104006, 0x10000a, 0x10000a, 0x10000a
  .long 0x100000, 0x102006, 0x107002, 0x103001, 0x100006, 0x103000, 0x100002, 0x10000a
  .long 0x101000, 0x103006, 0x100001, 0x10000a, 0x101006, 0x104000, 0x101001, 0x10000a
  .long 0x102000, 0x104006, 0x102001, 0x10000a, 0x107002, 0x100006, 0x102000, 0x103006
  .long 0x100002, 0x101000, 0x102006, 0x104000, 0x100000, 0x101006, 0x103000, 0x104006
  .long 0x100001, 0x101001, 0x102001, 0x10000a, 0x103001, 0x10000a, 0x10000a, 0x10000a
  .long 0x107002, 0x100006, 0x102000, 0x103006, 0x100002, 0x101000, 0x102006, 0x104000
  .long 0x100000, 0x101006, 0x103000, 0x104006, 0x100001, 0x101001, 0x102001, 0x10000a
  .long 0x103001, 0x10000a, 0x10000a, 0x10000a, 0x107002, 0x100006, 0x102000, 0x103006
  .long 0x100002, 0x101000, 0x102006, 0x104000, 0x100000, 0x101006, 0x103000, 0x104006
  .long 0x100001, 0x101001, 0x10000a, 0x10000a, 0x102001, 0x103001, 0x10000a, 0x10000a
  .long 0x107002, 0x100006, 0x102000, 0x103006, 0x100002, 0x101000, 0x102006, 0x104000
  .long 0x100000, 0x101006, 0x103000, 0x104006, 0x100001, 0x101001, 0x10000a, 0x10000a
  .long 0x102001, 0x103001, 0x10000a, 0x10000a, 0x107002, 0x100006, 0x102000, 0x103006
  .long 0x100002, 0x101000, 0x102006, 0x104000, 0x100000, 0x101006, 0x103000, 0x104006
  .long 0x100001, 0x101001, 0x10000a, 0x10000a, 0x102001, 0x103001, 0x10000a, 0x10000a
  .long 0x107002, 0x100000, 0x101000, 0x102000, 0x100002, 0x100006, 0x101006, 0x102006
  .long 0x103000, 0x103006, 0x10000a, 0x10000a, 0x104000, 0x104006, 0x10000a, 0x10000a
  .long 0x100001, 0x101001, 0x10000a, 0x10000a, 0x102001, 0x103001, 0x10000a, 0x10000a
  .long 0x105000, 0x108002, 0x10000a, 0x10000a, 0x105006, 0x101002, 0x10000a, 0x10000a
  .long 0x106000, 0x104001, 0x10000a, 0x10000a, 0x106006, 0x105001, 0x10000a, 0x10000a
  .long 0x107000, 0x106001, 0x10000a, 0x10000a, 0x107006, 0x107001, 0x10000a, 0x10000a
  .long 0x108000, 0x10000a, 0x10000a, 0x10000a, 0x108006, 0x10000a, 0x10000a, 0x10000a
  .long 0x109000, 0x10000a, 0x10000a, 0x10000a, 0x109006, 0x10000a, 0x10000a, 0x10000a
  .long 0x105000, 0x107006, 0x108002, 0x107001, 0x105006, 0x108000, 0x101002, 0x10000a
  .long 0x106000, 0x108006, 0x104001, 0x10000a, 0x106006, 0x109000, 0x105001, 0x10000a
  .long 0x107000, 0x109006, 0x106001, 0x10000a, 0x108002, 0x105006, 0x107000, 0x108006
  .long 0x101002, 0x106000, 0x107006, 0x109000, 0x105000, 0x106006, 0x108000, 0x109006
  .long 0x104001, 0x105001, 0x106001, 0x10000a, 0x107001, 0x10000a, 0x10000a, 0x10000a
  .long 0x108002, 0x105006, 0x107000, 0x108006, 0x101002, 0x106000, 0x107006, 0x109000
  .long 0x105000, 0x106006, 0x108000, 0x109006, 0x104001, 0x105001, 0x106001, 0x10000a
  .long 0x107001, 0x10000a, 0x10000a, 0x10000a, 0x108002, 0x105006, 0x107000, 0x108006
  .long 0x101002, 0x106000, 0x107006, 0x109000, 0x105000, 0x106006, 0x108000, 0x109006
  .long 0x104001, 0x105001, 0x10000a, 0x10000a, 0x106001, 0x107001, 0x10000a, 0x10000a
  .long 0x108002, 0x105006, 0x107000, 0x108006, 0x101002, 0x106000, 0x107006, 0x109000
  .long 0x105000, 0x106006, 0x108000, 0x109006, 0x104001, 0x105001, 0x10000a, 0x10000a
  .long 0x106001, 0x107001, 0x10000a, 0x10000a, 0x108002, 0x105006, 0x107000, 0x108006
  .long 0x101002, 0x106000, 0x107006, 0x109000, 0x105000, 0x106006, 0x108000, 0x109006
  .long 0x104001, 0x105001, 0x10000a, 0x10000a, 0x106001, 0x107001, 0x10000a, 0x10000a
  .long 0x108002, 0x105000, 0x106000, 0x107000, 0x101002, 0x105006, 0x106006, 0x107006
  .long 0x108000, 0x108006, 0x10000a, 0x10000a, 0x109000, 0x109006, 0x10000a, 0x10000a
  .long 0x104001, 0x105001, 0x10000a, 0x10000a, 0x106001, 0x107001, 0x10000a, 0x10000a
  .long 0x10a000, 0x109002, 0x10000a, 0x10000a, 0x10a006, 0x102002, 0x10000a, 0x10000a
  .long 0x10b000, 0x108001, 0x10000a, 0x10000a, 0x10b006, 0x109001, 0x10000a, 0x10000a
  .long 0x10c000, 0x10a001, 0x10000a, 0x10000a, 0x10c006, 0x10b001, 0x10000a, 0x10000a
  .long 0x10d000, 0x10000a, 0x10000a, 0x10000a, 0x10d006, 0x10000a, 0x10000a, 0x10000a
  .long 0x10e000, 0x10000a, 0x10000a, 0x10000a, 0x10e006, 0x10000a, 0x10000a, 0x10000a
  .long 0x10a000, 0x10c006, 0x109002, 0x10b001, 0x10a006, 0x10d000, 0x102002, 0x10000a
  .long 0x10b000, 0x10d006, 0x108001, 0x10000a, 0x10b006, 0x10e000, 0x109001, 0x10000a
  .long 0x10c000, 0x10e006, 0x10a001, 0x10000a, 0x109002, 0x10a006, 0x10c000, 0x10d006
  .long 0x102002, 0x10b000, 0x10c006, 0x10e000, 0x10a000, 0x10b006, 0x10d000, 0x10e006
  .long 0x108001, 0x109001, 0x10a001, 0x10000a, 0x10b001, 0x10000a, 0x10000a, 0x10000a
  .long 0x109002, 0x10a006, 0x10c000, 0x10d006, 0x102002, 0x10b000, 0x10c006, 0x10e000
  .long 0x10a000, 0x10b006, 0x10d000, 0x10e006, 0x108001, 0x109001, 0x10a001, 0x10000a
  .long 0x10b001, 0x10000a, 0x10000a, 0x10000a, 0x109002, 0x10a006, 0x10c000, 0x10d006
  .long 0x102002, 0x10b000, 0x10c006, 0x10e000, 0x10a000, 0x10b006, 0x10d000, 0x10e006
  .long 0x108001, 0x109001, 0x10000a, 0x10000a, 0x10a001, 0x10b001, 0x10000a, 0x10000a
  .long 0x109002, 0x10a006, 0x10c000, 0x10d006, 0x102002, 0x10b000, 0x10c006, 0x10e000
  .long 0x10a000, 0x10b006, 0x10d000, 0x10e006, 0x108001, 0x109001, 0x10000a, 0x10000a
  .long 0x10a001, 0x10b001, 0x10000a, 0x10000a, 0x109002, 0x10a006, 0x10c000, 0x10d006
  .long 0x102002, 0x10b000, 0x10c006, 0x10e000, 0x10a000, 0x10b006, 0x10d000, 0x10e006
  .long 0x108001, 0x109001, 0x10000a, 0x10000a, 0x10a001, 0x10b001, 0x10000a, 0x10000a
  .long 0x109002, 0x10a000, 0x10b000, 0x10c000, 0x102002, 0x10a006, 0x10b006, 0x10c006
  .long 0x10d000, 0x10d006, 0x10000a, 0x10000a, 0x10e000, 0x10e006, 0x10000a, 0x10000a
  .long 0x108001, 0x109001, 0x10000a, 0x10000a, 0x10a001, 0x10b001, 0x10000a, 0x10000a
  .long 0x10f000, 0x10a002, 0x10000a, 0x10000a, 0x10f006, 0x103002, 0x10000a, 0x10000a
  .long 0x110000, 0x10c001, 0x10000a, 0x10000a, 0x110006, 0x10d001, 0x10000a, 0x10000a
  .long 0x111000, 0x10e001, 0x10000a, 0x10000a, 0x111006, 0x10f001, 0x10000a, 0x10000a
  .long 0x112000, 0x10000a, 0x10000a, 0x10000a, 0x112006, 0x10000a, 0x10000a, 0x10000a
  .long 0x113000, 0x10000a, 0x10000a, 0x10000a, 0x113006, 0x10000a, 0x10000a, 0x10000a
  .long 0x10f000, 0x111006, 0x10a002, 0x10f001, 0x10f006, 0x112000, 0x103002, 0x10000a
  .long 0x110000, 0x112006, 0x10c001, 0x10000a, 0x110006, 0x113000, 0x10d001, 0x10000a
  .long 0x111000, 0x113006, 0x10e001, 0x10000a, 0x10a002, 0x10f006, 0x111000, 0x112006
  .long 0x103002, 0x110000, 0x111006, 0x113000, 0x10f000, 0x110006, 0x112000, 0x113006
  .long 0x10c001, 0x10d001, 0x10e001, 0x10000a, 0x10f001, 0x10000a, 0x10000a, 0x10000a
  .long 0x10a002, 0x10f006, 0x111000, 0x112006, 0x103002, 0x110000, 0x111006, 0x113000
  .long 0x10f000, 0x110006, 0x112000, 0x113006, 0x10c001, 0x10d001, 0x10e001, 0x10000a
  .long 0x10f001, 0x10000a, 0x10000a, 0x10000a, 0x10a002, 0x10f006, 0x111000, 0x112006
  .long 0x103002, 0x110000, 0x111006, 0x113000, 0x10f000, 0x110006, 0x112000, 0x113006
  .long 0x10c001, 0x10d001, 0x10000a, 0x10000a, 0x10e001, 0x10f001, 0x10000a, 0x10000a
  .long 0x10a002, 0x10f006, 0x111000, 0x112006, 0x103002, 0x110000, 0x111006, 0x113000
  .long 0x10f000, 0x110006, 0x112000, 0x113006, 0x10c001, 0x10d001, 0x10000a, 0x10000a
  .long 0x10e001, 0x10f001, 0x10000a, 0x10000a, 0x10a002, 0x10f006, 0x111000, 0x112006
  .long 0x103002, 0x110000, 0x111006, 0x113000, 0x10f000, 0x110006, 0x112000, 0x113006
  .long 0x10c001, 0x10d001, 0x10000a, 0x10000a, 0x10e001, 0x10f001, 0x10000a, 0x10000a
  .long 0x10a002, 0x10f000, 0x110000, 0x111000, 0x103002, 0x10f006, 0x110006, 0x111006
  .long 0x112000, 0x112006, 0x10000a, 0x10000a, 0x113000, 0x113006, 0x10000a, 0x10000a
  .long 0x10c001, 0x10d001, 0x10000a, 0x10000a, 0x10e001, 0x10f001, 0x10000a, 0x10000a
  .long 0x114000, 0x10b002, 0x10000a, 0x10000a, 0x114006, 0x104002, 0x10000a, 0x10000a
  .long 0x115000, 0x110001, 0x10000a, 0x10000a, 0x115006, 0x111001, 0x10000a, 0x10000a
  .long 0x116000, 0x112001, 0x10000a, 0x10000a, 0x116006, 0x113001, 0x10000a, 0x10000a
  .long 0x117000, 0x114001, 0x10000a, 0x10000a, 0x117006, 0x10000a, 0x10000a, 0x10000a
  .long 0x114000, 0x116000, 0x10b002, 0x112001, 0x114006, 0x116006, 0x104002, 0x113001
  .long 0x115000, 0x117000, 0x110001, 0x114001, 0x115006, 0x117006, 0x111001, 0x10000a
  .long 0x10b002, 0x115000, 0x117000, 0x112001, 0x104002, 0x115006, 0x117006, 0x113001
  .long 0x114000, 0x116000, 0x110001, 0x114001, 0x114006, 0x116006, 0x111001, 0x10000a
  .long 0x10b002, 0x115000, 0x117000, 0x112001, 0x104002, 0x115006, 0x117006, 0x113001
  .long 0x114000, 0x116000, 0x110001, 0x114001, 0x114006, 0x116006, 0x111001, 0x10000a
  .long 0x10b002, 0x114006, 0x116000, 0x117006, 0x104002, 0x115000, 0x116006, 0x110001
  .long 0x114000, 0x115006, 0x117000, 0x111001, 0x112001, 0x113001, 0x114001, 0x10000a
  .long 0x10b002, 0x114006, 0x116000, 0x117006, 0x104002, 0x115000, 0x116006, 0x110001
  .long 0x114000, 0x115006, 0x117000, 0x111001, 0x112001, 0x113001, 0x10000a, 0x10000a
  .long 0x114001, 0x10000a, 0x10000a, 0x10000a, 0x10b002, 0x114006, 0x116000, 0x117006
  .long 0x104002, 0x115000, 0x116006, 0x110001, 0x114000, 0x115006, 0x117000, 0x111001
  .long 0x112001, 0x113001, 0x10000a, 0x10000a, 0x114001, 0x10000a, 0x10000a, 0x10000a
  .long 0x10b002, 0x114006, 0x116000, 0x117006, 0x104002, 0x115000, 0x116006, 0x110001
  .long 0x114000, 0x115006, 0x117000, 0x111001, 0x112001, 0x113001, 0x10000a, 0x10000a
  .long 0x114001, 0x10000a, 0x10000a, 0x10000a, 0x118000, 0x10c002, 0x10000a, 0x10000a
  .long 0x118006, 0x105002, 0x10000a, 0x10000a, 0x119000, 0x115001, 0x10000a, 0x10000a
  .long 0x119006, 0x116001, 0x10000a, 0x10000a, 0x11a000, 0x117001, 0x10000a, 0x10000a
  .long 0x11a006, 0x118001, 0x10000a, 0x10000a, 0x11b000, 0x119001, 0x10000a, 0x10000a
  .long 0x11b006, 0x10000a, 0x10000a, 0x10000a, 0x118000, 0x11a000, 0x10c002, 0x117001
  .long 0x118006, 0x11a006, 0x105002, 0x118001, 0x119000, 0x11b000, 0x115001, 0x119001
  .long 0x119006, 0x11b006, 0x116001, 0x10000a, 0x10c002, 0x119000, 0x11b000, 0x117001
  .long 0x105002, 0x119006, 0x11b006, 0x118001, 0x118000, 0x11a000, 0x115001, 0x119001
  .long 0x118006, 0x11a006, 0x116001, 0x10000a, 0x10c002, 0x119000, 0x11b000, 0x117001
  .long 0x105002, 0x119006, 0x11b006, 0x118001, 0x118000, 0x11a000, 0x115001, 0x119001
  .long 0x118006, 0x11a006, 0x116001, 0x10000a, 0x10c002, 0x118006, 0x11a000, 0x11b006
  .long 0x105002, 0x119000, 0x11a006, 0x115001, 0x118000, 0x119006, 0x11b000, 0x116001
  .long 0x117001, 0x118001, 0x119001, 0x10000a, 0x10c002, 0x118006, 0x11a000, 0x11b006
  .long 0x105002, 0x119000, 0x11a006, 0x115001, 0x118000, 0x119006, 0x11b000, 0x116001
  .long 0x117001, 0x118001, 0x10000a, 0x10000a, 0x119001, 0x10000a, 0x10000a, 0x10000a
  .long 0x10c002, 0x118006, 0x11a000, 0x11b006, 0x105002, 0x119000, 0x11a006, 0x115001
  .long 0x118000, 0x119006, 0x11b000, 0x116001, 0x117001, 0x118001, 0x10000a, 0x10000a
  .long 0x119001, 0x10000a, 0x10000a, 0x10000a, 0x10c002, 0x118006, 0x11a000, 0x11b006
  .long 0x105002, 0x119000, 0x11a006, 0x115001, 0x118000, 0x119006, 0x11b000, 0x116001
  .long 0x117001, 0x118001, 0x10000a, 0x10000a, 0x119001, 0x10000a, 0x10000a, 0x10000a
  .long 0x11c000, 0x10d002, 0x10000a, 0x10000a, 0x11c006, 0x106002, 0x10000a, 0x10000a
  .long 0x11d000, 0x11a001, 0x10000a, 0x10000a, 0x11d006, 0x11b001, 0x10000a, 0x10000a
  .long 0x11e000, 0x11c001, 0x10000a, 0x10000a, 0x11e006, 0x11d001, 0x10000a, 0x10000a
  .long 0x11f000, 0x11e001, 0x10000a, 0x10000a, 0x11f006, 0x11f001, 0x10000a, 0x10000a
  .long 0x11c000, 0x11e000, 0x10d002, 0x11c001, 0x11c006, 0x11e006, 0x106002, 0x11d001
  .long 0x11d000, 0x11f000, 0x11a001, 0x11e001, 0x11d006, 0x11f006, 0x11b001, 0x11f001
  .long 0x10d002, 0x11d000, 0x11f000, 0x11c001, 0x106002, 0x11d006, 0x11f006, 0x11d001
  .long 0x11c000, 0x11e000, 0x11a001, 0x11e001, 0x11c006, 0x11e006, 0x11b001, 0x11f001
  .long 0x10d002, 0x11d000, 0x11f000, 0x11c001, 0x106002, 0x11d006, 0x11f006, 0x11d001
  .long 0x11c000, 0x11e000, 0x11a001, 0x11e001, 0x11c006, 0x11e006, 0x11b001, 0x11f001
  .long 0x10d002, 0x11c006, 0x11e000, 0x11f006, 0x106002, 0x11d000, 0x11e006, 0x11a001
  .long 0x11c000, 0x11d006, 0x11f000, 0x11b001, 0x11c001, 0x11d001, 0x10000a, 0x10000a
  .long 0x11e001, 0x11f001, 0x10000a, 0x10000a, 0x10d002, 0x11c006, 0x11e000, 0x11f006
  .long 0x106002, 0x11d000, 0x11e006, 0x11a001, 0x11c000, 0x11d006, 0x11f000, 0x11b001
  .long 0x11c001, 0x11d001, 0x10000a, 0x10000a, 0x11e001, 0x11f001, 0x10000a, 0x10000a
  .long 0x10d002, 0x11c006, 0x11e000, 0x11f006, 0x106002, 0x11d000, 0x11e006, 0x11a001
  .long 0x11c000, 0x11d006, 0x11f000, 0x11b001, 0x11c001, 0x11d001, 0x10000a, 0x10000a
  .long 0x11e001, 0x11f001, 0x10000a, 0x10000a, 0x10d002, 0x11c006, 0x11e000, 0x11f006
  .long 0x106002, 0x11d000, 0x11e006, 0x11a001, 0x11c000, 0x11d006, 0x11f000, 0x11b001
  .long 0x11c001, 0x11d001, 0x10000a, 0x10000a, 0x11e001, 0x11f001, 0x10000a, 0x10000a
  .size task_table, 9664
.section .rodata,"a"
.p2align 6
.amdhsa_kernel parallel_sum__memory_aug_recurrent_mem_tr__mixer_gmlp__prompt_kernel
  .amdhsa_next_free_vgpr 512
  .amdhsa_next_free_sgpr 102
  .amdhsa_accum_offset 256
  .amdhsa_group_segment_fixed_size 0
  .amdhsa_kernarg_size 120
  .amdhsa_user_sgpr_count 2
  .amdhsa_user_sgpr_kernarg_segment_ptr 1
  .amdhsa_system_sgpr_workgroup_id_x 1
.end_amdhsa_kernel
```
